```python
import torch

def _softmax(x, axis=-1):
    return torch.softmax(x, dim=axis)
def _gelu(x):
    return torch.nn.functional.gelu(x, approximate="tanh")
def _silu(x):
    return torch.nn.functional.silu(x)
def _sigmoid(x):
    return torch.sigmoid(x)
def _layernorm(x, axis=-1, eps=1e-5):
    m = x.mean(dim=axis, keepdim=True)
    v = x.var(dim=axis, keepdim=True, unbiased=False)
    return (x - m) / torch.sqrt(v + eps)
def _scatter_add(tgt, idx, src, axis=0):
    return tgt.clone().index_add_(axis, idx, src)
def _segment_sum(src, seg, n):
    out = torch.zeros((n,) + src.shape[1:], dtype=src.dtype)
    return out.index_add_(0, seg, src)
def _pad(x, pw):
    flat = tuple(v for pair in reversed(pw) for v in pair)
    return torch.nn.functional.pad(x, flat)

kernel_name = 'recurrent_scan__ssm_conv_h3__dense_activation_silu__prompt'

def setup_inputs():

    _w = (lambda a: (lambda t: t.to(torch.bfloat16) if t.is_floating_point() else t)(torch.as_tensor(a)))
    def _A_setup():
        B, S, D = 1, 2048, 576
        ks = 4
        return {
            "q": _w((lambda *s: torch.randn(*s, dtype=torch.bfloat16) * 0.05)(B, S, D)),
            "k": _w((lambda *s: torch.randn(*s, dtype=torch.bfloat16) * 0.8)(B, S, D)),
            "v": _w((lambda *s: torch.randn(*s, dtype=torch.bfloat16) * 0.8)(B, S, D)),
            "shift_k": _w((lambda *s: torch.randn(*s, dtype=torch.bfloat16) * 0.8)(D, ks) * 0.5),
            "ssm_k": _w((lambda *s: torch.randn(*s, dtype=torch.bfloat16) * 0.8)(D, S) * (1.0 / S ** 0.5)),
            "ssm_D": _w((lambda *s: torch.randn(*s, dtype=torch.bfloat16) * 0.8)(D)),
        }
    _A_in = _A_setup()

    def _B_setup():
        B, S, D, F = 1, 2048, 576, 4608
        return {
            "x": _w((lambda *s: torch.randn(*s, dtype=torch.bfloat16) * 0.05)(B, S, D)),
            "w1": _w((lambda *s: torch.randn(*s, dtype=torch.bfloat16) * 0.8)(D, F) * (D ** -0.5)),
            "w2": _w((lambda *s: torch.randn(*s, dtype=torch.bfloat16) * 0.2)(F, D) * (F ** -0.5)),
        }
    _B_in = _B_setup()

    return {
        "A_q": _A_in["q"],
        "A_k": _A_in["k"],
        "A_v": _A_in["v"],
        "A_shift_k": _A_in["shift_k"],
        "A_ssm_k": _A_in["ssm_k"],
        "A_ssm_D": _A_in["ssm_D"],
        "B_x": _B_in["x"],
        "B_w1": _B_in["w1"],
        "B_w2": _B_in["w2"],
    }

def reference(A_q, A_k, A_v, A_shift_k, A_ssm_k, A_ssm_D, B_x, B_w1, B_w2):
    def _A_ref(q, k, v, shift_k, ssm_k, ssm_D):
        B, S, D = q.shape
        ks = shift_k.shape[-1]
        k_pad = _pad(k, ((0, 0), (ks - 1, 0), (0, 0)))
        k_shift = torch.zeros_like(k)
        for t in range(ks):
            k_shift = k_shift + k_pad[:, t:t + S, :] * shift_k[:, ks - 1 - t][None, None, :]
        kv = k_shift * v
        L = 2 * S
        kv_pad = _pad(kv, ((0, 0), (0, S), (0, 0)))
        kf_pad = _pad(ssm_k, ((0, 0), (0, S)))
        kv_f = (lambda x, axes=(-2,-1): torch.fft.rfft2(x.float(), dim=axes))(kv_pad[:, None, :, :], axes=(1, 2))
        kf_f = (lambda x, axes=(-2,-1): torch.fft.rfft2(x.float(), dim=axes))(kf_pad[:, None, :], axes=(1, 2))
        kf_f = (lambda x, *d: x.permute(*d))(kf_f, 1, 2, 0)
        y_f = kv_f * kf_f[None, :, :, :]
        y = (lambda x, s, axes=(-2,-1): torch.fft.irfft2(x, s=s, dim=axes).to(torch.bfloat16))(y_f, (1, L), axes=(1, 2))[:, 0, :S, :]
        y = y + kv * ssm_D[None, None, :]
        return q * y

    def _B_ref(x, w1, w2):
        h = torch.einsum("bsd,df->bsf", x, w1)
        h = _silu(h)
        out = torch.einsum("bsf,fd->bsd", h, w2)
        return out

    x = A_q
    xn = _layernorm(x, axis=-1)
    s = _A_ref(xn, A_k, A_v, A_shift_k, A_ssm_k, A_ssm_D)
    g = _silu(_B_ref(xn, B_w1, B_w2))
    return x + s * g
```

```asm
; @launch grid=(256,1,1) block=(256,1,1) lds=163840
.amdgcn_target "amdgcn-amd-amdhsa--gfx950"
.text
.globl recurrent_scan__ssm_conv_h3__dense_activation_silu__prompt_kernel
.p2align 8
.type recurrent_scan__ssm_conv_h3__dense_activation_silu__prompt_kernel,@function
recurrent_scan__ssm_conv_h3__dense_activation_silu__prompt_kernel:
  s_cmp_ge_u32 s2, 256
  s_cbranch_scc1 K_END
  s_load_dwordx4 s[4:7], s[0:1], 0
  s_load_dwordx4 s[40:43], s[0:1], 16
  s_load_dwordx4 s[36:39], s[0:1], 32
  s_load_dwordx4 s[44:47], s[0:1], 56
  s_load_dwordx4 s[48:51], s[0:1], 72
  s_load_dwordx2 s[32:33], s[0:1], 88
  s_getpc_b64 s[84:85]
K_PC:
  v_lshrrev_b32 v1, 6, v0
  v_and_b32 v2, 63, v0
  s_lshr_b32 s86, s2, 3
  s_lshl_b32 s86, s86, 2
  v_add_u32 v3, s86, v1
  s_mov_b32 s87, (K_CODE_END - K_PC + 8191) / 8192
  v_cvt_f32_u32 v4, v3
  v_cvt_f32_u32 v5, s87
  v_rcp_f32 v5, v5
  v_add_f32 v4, 0.5, v4
  v_mul_f32 v4, v4, v5
  v_cvt_u32_f32 v4, v4
  v_mul_lo_u32 v4, v4, s87
  v_sub_u32 v3, v3, v4
  v_lshlrev_b32 v3, 13, v3
  v_lshl_add_u32 v3, v2, 7, v3
  v_min_u32 v3, K_CODE_END - K_PC - 4, v3
  global_load_dword v98, v3, s[84:85]
  s_nop 0
  v_readfirstlane_b32 s24, v1
  s_and_b32 s34, s2, 7
  s_lshr_b32 s35, s2, 3
  s_lshr_b32 s93, s35, 0
  s_mov_b32 s25, s34
  s_mov_b32 s26, s35
  v_lshlrev_b32 v35, 4, v2
  v_lshrrev_b32 v36, 4, v2
  v_and_b32 v37, 15, v2
  v_and_b32 v106, 7, v2
  v_lshrrev_b32 v107, 3, v2
  s_lshl_b32 s34, s24, 4
  v_add_u32 v109, s34, v107
  v_mul_u32_u24 v109, 1152, v109
  v_lshl_add_u32 v109, v106, 4, v109
  s_mul_i32 s34, s26, 73728
  v_lshlrev_b32 v70, 1, v36
  v_xor_b32 v70, v37, v70
  v_xor_b32 v71, 8, v70
  s_lshl_b32 s95, s24, 8
  v_lshl_add_u32 v70, v70, 4, s95
  v_lshl_add_u32 v71, v71, 4, s95
  s_mov_b32 s35, 9216
  v_mul_lo_u32 v72, v36, s35
  v_add_u32 v70, v70, v72
  v_add_u32 v71, v71, v72
  v_mov_b32 v4, v70
  v_add_u32 v5, 35840, v70
  v_add_u32 v6, 71680, v71
  v_add_u32 v7, 107520, v71
  v_add_u32 v8, 147456, v70
  v_add_u32 v9, 183296, v70
  v_add_u32 v10, 219136, v71
  v_add_u32 v11, 254976, v71
  v_lshrrev_b32 v73, 1, v2
  v_and_b32 v74, 0x13, v73
  v_bfe_u32 v75, v73, 2, 1
  v_lshl_or_b32 v74, v75, 3, v74
  v_bfe_u32 v75, v73, 3, 1
  v_lshl_or_b32 v74, v75, 2, v74
  v_mul_lo_u32 v74, v74, s35
  v_and_b32 v75, 1, v2
  v_lshl_add_u32 v74, v75, 4, v74
  s_lshl_b32 s95, s24, 5
  s_add_u32 s95, s95, 1024
  v_add_u32 v12, s95, v74
  s_mul_i32 s29, s25, 1152
  s_mul_i32 s30, s25, 663552
  s_mul_i32 s28, s24, 18432
  s_add_u32 s28, s28, 73728
  v_add_u32 v58, 0, v0
  v_min_u32 v58, 161, v58
  v_mul_u32_u24 v55, 7282, v58
  v_lshrrev_b32 v55, 16, v55
  v_mul_u32_u24 v56, 9, v55
  v_sub_u32 v56, v58, v56
  s_mul_i32 s35, s93, 18
  v_add_u32 v55, s35, v55
  v_mul_u32_u24 v55, 9216, v55
  v_lshl_add_u32 v92, v56, 7, v55
  v_lshlrev_b32 v95, 7, v58
  s_mul_i32 s35, s35, 1152
  s_add_u32 s92, s35, s30
  s_sub_u32 s100, s2, 144
  v_mul_u32_u24 v40, 911, v0
  v_lshrrev_b32 v40, 16, v40
  v_mul_u32_u24 v41, 72, v40
  v_sub_u32 v41, v0, v41
  v_mul_u32_u24 v42, 112, v40
  v_add_u32 v42, s100, v42
  v_cmp_lt_u32 vcc, 255, v42
  v_mov_b32 v43, s100
  v_mul_u32_u24 v44, 7282, v41
  v_cndmask_b32 v42, v42, v43, vcc
  v_cndmask_b32 v40, v40, 0, vcc
  v_lshrrev_b32 v43, 16, v44
  v_mul_u32_u24 v44, 9, v43
  v_sub_u32 v44, v41, v44
  v_lshrrev_b32 v45, 3, v42
  v_lshlrev_b32 v45, 6, v45
  v_lshl_add_u32 v45, v43, 3, v45
  v_and_b32 v46, 7, v42
  v_mul_u32_u24 v46, 144, v46
  v_lshl_add_u32 v46, v44, 4, v46
  v_mul_u32_u24 v47, 1152, v45
  v_add_u32 v47, v47, v46
  v_add_u32 v48, 4608, v47
  v_bfrev_b32 v49, 1
  v_add_u32 v50, 4294963840, v47
  v_cmp_gt_u32 vcc, 3, v45
  v_mov_b32 v53, v53
  v_mov_b32 v53, v53
  v_cndmask_b32 v50, v50, v49, vcc
  v_add_u32 v51, 4294964992, v47
  v_cmp_gt_u32 vcc, 2, v45
  v_mov_b32 v53, v53
  v_mov_b32 v53, v53
  v_cndmask_b32 v51, v51, v49, vcc
  v_add_u32 v52, 4294966144, v47
  v_cmp_gt_u32 vcc, 1, v45
  v_mov_b32 v53, v53
  v_mov_b32 v53, v53
  v_cndmask_b32 v52, v52, v49, vcc
  v_lshlrev_b32 v46, 2, v46
  v_mul_u32_u24 v99, 10368, v40
  v_mul_u32_u24 v53, 1152, v44
  v_add_u32 v99, v99, v53
  v_lshlrev_b32 v53, 4, v43
  v_sub_u32 v99, v99, v53
  v_add_u32 v99, 112, v99
  v_add_u32 v53, 0, v0
  v_lshrrev_b32 v54, 3, v53
  v_and_b32 v53, 7, v53
  v_mul_u32_u24 v100, 144, v54
  v_lshl_add_u32 v100, v53, 4, v100
  v_lshlrev_b32 v103, 12, v54
  v_lshl_add_u32 v103, v53, 4, v103
  v_add_u32 v53, 256, v0
  v_lshrrev_b32 v54, 3, v53
  v_and_b32 v53, 7, v53
  v_mul_u32_u24 v101, 144, v54
  v_lshl_add_u32 v101, v53, 4, v101
  v_lshlrev_b32 v104, 12, v54
  v_lshl_add_u32 v104, v53, 4, v104
  v_add_u32 v53, 512, v0
  v_min_u32 v53, 575, v53
  v_lshrrev_b32 v54, 3, v53
  v_and_b32 v53, 7, v53
  v_mul_u32_u24 v102, 144, v54
  v_lshl_add_u32 v102, v53, 4, v102
  v_lshlrev_b32 v105, 12, v54
  v_lshl_add_u32 v105, v53, 4, v105
  s_waitcnt lgkmcnt(0)
  s_mov_b32 s8, s44
  s_mov_b32 s9, s45
  s_mov_b32 s10, 5308416
  s_mov_b32 s11, 0x00020000
  s_mov_b32 s12, s46
  s_mov_b32 s13, s47
  s_mov_b32 s14, 5308416
  s_mov_b32 s15, 0x00020000
  s_mov_b32 s44, s50
  s_mov_b32 s45, s51
  s_mov_b32 s46, 256
  s_mov_b32 s47, 0x00020000
  v_mov_b32 v89, 0
  s_or_b32 s35, s2, s24
  s_cmp_lg_u32 s35, 0
  s_cbranch_scc1 K_NONONCE
  s_memrealtime s[100:101]
  s_waitcnt lgkmcnt(0)
  s_or_b32 s100, s100, 1
  v_mov_b32 v60, s100
  s_mov_b64 exec, 1
  buffer_store_dword v60, v89, s[44:47], 0 offen sc1
  s_mov_b64 exec, -1
K_NONONCE:
  s_mov_b32 s56, s6
  s_mov_b32 s57, s7
  s_mov_b32 s58, 2359296
  s_mov_b32 s59, 0x00020000
  s_mov_b32 s60, s40
  s_mov_b32 s61, s41
  s_mov_b32 s62, 2359296
  s_mov_b32 s63, 0x00020000
  s_mov_b32 s64, s42
  s_mov_b32 s65, s43
  s_mov_b32 s66, 4608
  s_mov_b32 s67, 0x00020000
  s_cmp_lt_u32 s2, 144
  s_cbranch_scc1 K_NOKVL
  buffer_load_dword v98, v92, s[8:11], s29 offen
  buffer_load_dword v98, v95, s[12:15], s92 offen
  buffer_load_dwordx4 a[0:3], v50, s[56:59], 0 offen
  buffer_load_dwordx4 a[4:7], v51, s[56:59], 0 offen
  buffer_load_dwordx4 a[8:11], v52, s[56:59], 0 offen
  buffer_load_dwordx4 a[12:15], v47, s[56:59], 0 offen
  buffer_load_dwordx4 a[16:19], v47, s[56:59], 0 offen offset:1152
  buffer_load_dwordx4 a[20:23], v47, s[56:59], 0 offen offset:2304
  buffer_load_dwordx4 a[24:27], v47, s[56:59], 0 offen offset:3456
  buffer_load_dwordx4 a[28:31], v48, s[56:59], 0 offen
  buffer_load_dwordx4 a[32:35], v48, s[56:59], 0 offen offset:1152
  buffer_load_dwordx4 a[36:39], v48, s[56:59], 0 offen offset:2304
  buffer_load_dwordx4 a[40:43], v48, s[56:59], 0 offen offset:3456
  buffer_load_dwordx4 a[44:47], v47, s[60:63], 0 offen nt
  buffer_load_dwordx4 a[48:51], v47, s[60:63], 0 offen offset:1152 nt
  buffer_load_dwordx4 a[52:55], v47, s[60:63], 0 offen offset:2304 nt
  buffer_load_dwordx4 a[56:59], v47, s[60:63], 0 offen offset:3456 nt
  buffer_load_dwordx4 a[60:63], v48, s[60:63], 0 offen nt
  buffer_load_dwordx4 a[64:67], v48, s[60:63], 0 offen offset:1152 nt
  buffer_load_dwordx4 a[68:71], v48, s[60:63], 0 offen offset:2304 nt
  buffer_load_dwordx4 a[72:75], v48, s[60:63], 0 offen offset:3456 nt
  buffer_load_dwordx4 a[76:79], v46, s[64:67], 0 offen
  buffer_load_dwordx4 a[80:83], v46, s[64:67], 0 offen offset:16
  buffer_load_dwordx4 a[84:87], v46, s[64:67], 0 offen offset:32
  buffer_load_dwordx4 a[88:91], v46, s[64:67], 0 offen offset:48
K_NOKVL:
  s_add_u32 s27, s29, 0
  s_add_u32 m0, s28, 8192
  s_nop 0
  buffer_load_dwordx4 v12, s[8:11], s27 offen lds
  s_add_u32 m0, s28, 0
  s_nop 0
  buffer_load_dwordx4 v4, s[8:11], s27 offen lds
  buffer_load_dwordx4 v6, s[8:11], s27 offen offset:2048 lds
  s_add_u32 m0, s28, 4096
  s_nop 0
  buffer_load_dwordx4 v8, s[8:11], s27 offen lds
  buffer_load_dwordx4 v10, s[8:11], s27 offen offset:2048 lds
  s_add_u32 m0, s28, 0
  s_nop 0
  buffer_load_dwordx4 v5, s[8:11], s27 offen offset:1024 lds
  buffer_load_dwordx4 v7, s[8:11], s27 offen offset:3072 lds
  s_add_u32 m0, s28, 4096
  s_nop 0
  buffer_load_dwordx4 v9, s[8:11], s27 offen offset:1024 lds
  buffer_load_dwordx4 v11, s[8:11], s27 offen offset:3072 lds
  s_mov_b32 s52, s4
  s_mov_b32 s53, s5
  s_mov_b32 s54, 2359296
  s_mov_b32 s55, 0x00020000
  buffer_load_dwordx4 v[112:115], v109, s[52:55], s34 offen
  buffer_load_dwordx4 v[116:119], v109, s[52:55], s34 offen offset:128
  buffer_load_dwordx4 v[120:123], v109, s[52:55], s34 offen offset:256
  buffer_load_dwordx4 v[124:127], v109, s[52:55], s34 offen offset:384
  buffer_load_dwordx4 v[128:131], v109, s[52:55], s34 offen offset:512
  buffer_load_dwordx4 v[132:135], v109, s[52:55], s34 offen offset:640
  buffer_load_dwordx4 v[136:139], v109, s[52:55], s34 offen offset:768
  buffer_load_dwordx4 v[140:143], v109, s[52:55], s34 offen offset:896
  buffer_load_dwordx4 v[144:147], v109, s[52:55], s34 offen offset:1024
  s_add_u32 s34, s34, 9216
  buffer_load_dwordx4 v[148:151], v109, s[52:55], s34 offen
  buffer_load_dwordx4 v[152:155], v109, s[52:55], s34 offen offset:128
  buffer_load_dwordx4 v[156:159], v109, s[52:55], s34 offen offset:256
  buffer_load_dwordx4 v[160:163], v109, s[52:55], s34 offen offset:384
  buffer_load_dwordx4 v[164:167], v109, s[52:55], s34 offen offset:512
  buffer_load_dwordx4 v[168:171], v109, s[52:55], s34 offen offset:640
  buffer_load_dwordx4 v[172:175], v109, s[52:55], s34 offen offset:768
  buffer_load_dwordx4 v[176:179], v109, s[52:55], s34 offen offset:896
  buffer_load_dwordx4 v[180:183], v109, s[52:55], s34 offen offset:1024
  s_mov_b32 s16, s32
  s_mov_b32 s17, s33
  s_mov_b32 s18, 23658496
  s_mov_b32 s19, 0x00020000
  s_mov_b32 s20, s36
  s_mov_b32 s21, s37
  s_mov_b32 s22, 2359296
  s_mov_b32 s23, 0x00020000
  v_lshlrev_b32 v70, 1, v36
  v_xor_b32 v70, v37, v70
  v_xor_b32 v71, 8, v70
  s_lshl_b32 s95, s24, 8
  v_lshl_add_u32 v70, v70, 4, s95
  v_lshl_add_u32 v71, v71, 4, s95
  s_mov_b32 s35, 1152
  v_mul_lo_u32 v72, v36, s35
  v_add_u32 v70, v70, v72
  v_add_u32 v71, v71, v72
  v_mov_b32 v13, v70
  v_add_u32 v14, 3584, v70
  v_add_u32 v15, 7168, v71
  v_add_u32 v16, 10752, v71
  v_add_u32 v17, 18432, v70
  v_add_u32 v18, 22016, v70
  v_add_u32 v19, 25600, v71
  v_add_u32 v20, 29184, v71
  v_lshrrev_b32 v73, 1, v2
  v_and_b32 v74, 0x13, v73
  v_bfe_u32 v75, v73, 2, 1
  v_lshl_or_b32 v74, v75, 3, v74
  v_bfe_u32 v75, v73, 3, 1
  v_lshl_or_b32 v74, v75, 2, v74
  v_mul_lo_u32 v74, v74, s35
  v_and_b32 v75, 1, v2
  v_lshl_add_u32 v74, v75, 4, v74
  s_lshl_b32 s95, s24, 5
  s_add_u32 s95, s95, 1024
  v_add_u32 v21, s95, v74
  v_lshrrev_b32 v70, 2, v37
  v_and_b32 v71, 3, v2
  v_lshl_add_u32 v72, v36, 3, v70
  v_lshlrev_b32 v72, 8, v72
  v_lshlrev_b32 v73, 3, v71
  v_add_u32 v72, v72, v73
  v_add_u32 v72, s28, v72
  v_and_b32 v74, 1, v36
  v_lshlrev_b32 v74, 3, v74
  v_lshl_add_u32 v74, v70, 1, v74
  v_xor_b32 v75, 0, v74
  v_lshl_add_u32 v22, v75, 4, v72
  v_xor_b32 v75, 2, v74
  v_lshl_add_u32 v23, v75, 4, v72
  v_xor_b32 v75, 4, v74
  v_lshl_add_u32 v24, v75, 4, v72
  v_xor_b32 v75, 6, v74
  v_lshl_add_u32 v25, v75, 4, v72
  v_xor_b32 v75, 8, v74
  v_lshl_add_u32 v26, v75, 4, v72
  v_xor_b32 v75, 10, v74
  v_lshl_add_u32 v27, v75, 4, v72
  v_xor_b32 v75, 12, v74
  v_lshl_add_u32 v28, v75, 4, v72
  v_xor_b32 v75, 14, v74
  v_lshl_add_u32 v29, v75, 4, v72
  v_lshrrev_b32 v75, 1, v36
  v_lshlrev_b32 v75, 4, v75
  v_and_b32 v76, 1, v36
  v_lshl_add_u32 v75, v76, 2, v75
  v_add_u32 v75, v75, v70
  v_lshl_add_u32 v75, v75, 5, v73
  s_add_u32 s35, s28, 8192
  v_add_u32 v30, s35, v75
  v_mov_b32 v31, v35
  v_add_u32 v32, 36864, v35
  v_lshlrev_b32 v70, 1, v36
  v_xor_b32 v71, v37, v70
  v_lshl_add_u32 v71, v36, 4, v71
  v_lshlrev_b32 v80, 4, v71
  v_xor_b32 v81, 16, v80
  v_add_u32 v82, 36864, v80
  v_add_u32 v83, 36864, v81
  v_lshlrev_b32 v75, 4, v37
  v_lshrrev_b32 v76, 1, v36
  v_lshl_add_u32 v75, v76, 8, v75
  v_and_b32 v76, 1, v36
  v_lshl_add_u32 v75, v76, 3, v75
  s_lshl_b32 s35, s24, 12
  v_add_u32 v33, s35, v75
  s_lshr_b32 s35, s24, 1
  s_lshl_b32 s35, s35, 10
  s_and_b32 s34, s24, 1
  s_lshl_b32 s34, s34, 9
  s_add_u32 s35, s35, s34
  s_add_u32 s35, s35, 16384
  v_add_u32 v34, s35, v75
  v_and_b32 v60, 3, v106
  v_lshrrev_b32 v61, 2, v106
  v_lshl_add_u32 v90, v60, 1, v61
  v_xor_b32 v90, v107, v90
  v_lshlrev_b32 v90, 4, v90
  v_lshl_add_u32 v90, v60, 8, v90
  v_lshl_add_u32 v90, v61, 10, v90
  s_mul_i32 s34, s24, 18432
  v_add_u32 v90, s34, v90
  s_lshl_b32 s34, s24, 7
  s_add_u32 s34, s34, 159744
  v_lshl_add_u32 v91, v107, 3, s34
  v_add_u32 v111, 160768, v35
  s_lshl_b32 s34, s24, 2
  v_add_u32 v110, s34, v111
  v_mov_b32 v78, 0
  ds_write_b32 v110, v78
  s_cmp_lt_u32 s2, 144
  s_cbranch_scc1 K_NOKV
  s_waitcnt vmcnt(27)
  v_accvgpr_read_b32 v55, a0
  v_accvgpr_read_b32 v56, a4
  v_accvgpr_read_b32 v57, a8
  v_accvgpr_read_b32 v58, a12
  v_accvgpr_read_b32 v59, a16
  v_accvgpr_read_b32 v60, a20
  v_accvgpr_read_b32 v61, a24
  v_accvgpr_read_b32 v62, a28
  v_accvgpr_read_b32 v63, a32
  v_accvgpr_read_b32 v64, a36
  v_accvgpr_read_b32 v65, a40
  v_accvgpr_read_b32 v66, a44
  v_accvgpr_read_b32 v67, a48
  v_accvgpr_read_b32 v68, a52
  v_accvgpr_read_b32 v69, a56
  v_accvgpr_read_b32 v70, a60
  v_accvgpr_read_b32 v71, a64
  v_accvgpr_read_b32 v72, a68
  v_accvgpr_read_b32 v73, a72
  v_accvgpr_read_b32 v74, a76
  v_accvgpr_read_b32 v75, a77
  v_accvgpr_read_b32 v76, a78
  v_accvgpr_read_b32 v77, a79
  v_and_b32 v40, 0xffff, v74
  v_lshrrev_b32 v41, 16, v74
  v_and_b32 v42, 0xffff, v75
  v_lshrrev_b32 v43, 16, v75
  v_dot2_f32_bf16 v184, v55, v43, 0
  v_dot2_f32_bf16 v185, v56, v43, 0
  v_dot2_f32_bf16 v186, v57, v43, 0
  v_dot2_f32_bf16 v187, v58, v43, 0
  v_dot2_f32_bf16 v188, v59, v43, 0
  v_dot2_f32_bf16 v189, v60, v43, 0
  v_dot2_f32_bf16 v190, v61, v43, 0
  v_dot2_f32_bf16 v191, v62, v43, 0
  v_dot2_f32_bf16 v184, v56, v42, v184
  v_dot2_f32_bf16 v185, v57, v42, v185
  v_dot2_f32_bf16 v186, v58, v42, v186
  v_dot2_f32_bf16 v187, v59, v42, v187
  v_dot2_f32_bf16 v188, v60, v42, v188
  v_dot2_f32_bf16 v189, v61, v42, v189
  v_dot2_f32_bf16 v190, v62, v42, v190
  v_dot2_f32_bf16 v191, v63, v42, v191
  v_dot2_f32_bf16 v184, v57, v41, v184
  v_dot2_f32_bf16 v185, v58, v41, v185
  v_dot2_f32_bf16 v186, v59, v41, v186
  v_dot2_f32_bf16 v187, v60, v41, v187
  v_dot2_f32_bf16 v188, v61, v41, v188
  v_dot2_f32_bf16 v189, v62, v41, v189
  v_dot2_f32_bf16 v190, v63, v41, v190
  v_dot2_f32_bf16 v191, v64, v41, v191
  v_dot2_f32_bf16 v184, v58, v40, v184
  v_dot2_f32_bf16 v185, v59, v40, v185
  v_dot2_f32_bf16 v186, v60, v40, v186
  v_dot2_f32_bf16 v187, v61, v40, v187
  v_dot2_f32_bf16 v188, v62, v40, v188
  v_dot2_f32_bf16 v189, v63, v40, v189
  v_dot2_f32_bf16 v190, v64, v40, v190
  v_dot2_f32_bf16 v191, v65, v40, v191
  v_lshlrev_b32 v44, 16, v66
  v_lshlrev_b32 v45, 16, v67
  v_lshlrev_b32 v46, 16, v68
  v_lshlrev_b32 v47, 16, v69
  v_lshlrev_b32 v48, 16, v70
  v_lshlrev_b32 v49, 16, v71
  v_lshlrev_b32 v50, 16, v72
  v_lshlrev_b32 v51, 16, v73
  v_mul_f32 v184, v184, v44
  v_mul_f32 v185, v185, v45
  v_mul_f32 v186, v186, v46
  v_mul_f32 v187, v187, v47
  v_mul_f32 v188, v188, v48
  v_mul_f32 v189, v189, v49
  v_mul_f32 v190, v190, v50
  v_mul_f32 v191, v191, v51
  v_cvt_pk_bf16_f32 v192, v191, v190
  v_cvt_pk_bf16_f32 v193, v189, v188
  v_cvt_pk_bf16_f32 v194, v187, v186
  v_cvt_pk_bf16_f32 v195, v185, v184
  ds_write_b128 v99, v[192:195] offset:0
  v_lshlrev_b32 v40, 16, v76
  v_and_b32 v41, 0xffff0000, v76
  v_lshlrev_b32 v42, 16, v77
  v_and_b32 v43, 0xffff0000, v77
  v_dot2_f32_bf16 v184, v55, v43, 0
  v_dot2_f32_bf16 v185, v56, v43, 0
  v_dot2_f32_bf16 v186, v57, v43, 0
  v_dot2_f32_bf16 v187, v58, v43, 0
  v_dot2_f32_bf16 v188, v59, v43, 0
  v_dot2_f32_bf16 v189, v60, v43, 0
  v_dot2_f32_bf16 v190, v61, v43, 0
  v_dot2_f32_bf16 v191, v62, v43, 0
  v_dot2_f32_bf16 v184, v56, v42, v184
  v_dot2_f32_bf16 v185, v57, v42, v185
  v_dot2_f32_bf16 v186, v58, v42, v186
  v_dot2_f32_bf16 v187, v59, v42, v187
  v_dot2_f32_bf16 v188, v60, v42, v188
  v_dot2_f32_bf16 v189, v61, v42, v189
  v_dot2_f32_bf16 v190, v62, v42, v190
  v_dot2_f32_bf16 v191, v63, v42, v191
  v_dot2_f32_bf16 v184, v57, v41, v184
  v_dot2_f32_bf16 v185, v58, v41, v185
  v_dot2_f32_bf16 v186, v59, v41, v186
  v_dot2_f32_bf16 v187, v60, v41, v187
  v_dot2_f32_bf16 v188, v61, v41, v188
  v_dot2_f32_bf16 v189, v62, v41, v189
  v_dot2_f32_bf16 v190, v63, v41, v190
  v_dot2_f32_bf16 v191, v64, v41, v191
  v_dot2_f32_bf16 v184, v58, v40, v184
  v_dot2_f32_bf16 v185, v59, v40, v185
  v_dot2_f32_bf16 v186, v60, v40, v186
  v_dot2_f32_bf16 v187, v61, v40, v187
  v_dot2_f32_bf16 v188, v62, v40, v188
  v_dot2_f32_bf16 v189, v63, v40, v189
  v_dot2_f32_bf16 v190, v64, v40, v190
  v_dot2_f32_bf16 v191, v65, v40, v191
  v_and_b32 v44, 0xffff0000, v66
  v_and_b32 v45, 0xffff0000, v67
  v_and_b32 v46, 0xffff0000, v68
  v_and_b32 v47, 0xffff0000, v69
  v_and_b32 v48, 0xffff0000, v70
  v_and_b32 v49, 0xffff0000, v71
  v_and_b32 v50, 0xffff0000, v72
  v_and_b32 v51, 0xffff0000, v73
  v_mul_f32 v184, v184, v44
  v_mul_f32 v185, v185, v45
  v_mul_f32 v186, v186, v46
  v_mul_f32 v187, v187, v47
  v_mul_f32 v188, v188, v48
  v_mul_f32 v189, v189, v49
  v_mul_f32 v190, v190, v50
  v_mul_f32 v191, v191, v51
  v_cvt_pk_bf16_f32 v196, v191, v190
  v_cvt_pk_bf16_f32 v197, v189, v188
  v_cvt_pk_bf16_f32 v198, v187, v186
  v_cvt_pk_bf16_f32 v199, v185, v184
  ds_write_b128 v99, v[196:199] offset:144
  v_accvgpr_read_b32 v55, a1
  v_accvgpr_read_b32 v56, a5
  v_accvgpr_read_b32 v57, a9
  v_accvgpr_read_b32 v58, a13
  v_accvgpr_read_b32 v59, a17
  v_accvgpr_read_b32 v60, a21
  v_accvgpr_read_b32 v61, a25
  v_accvgpr_read_b32 v62, a29
  v_accvgpr_read_b32 v63, a33
  v_accvgpr_read_b32 v64, a37
  v_accvgpr_read_b32 v65, a41
  v_accvgpr_read_b32 v66, a45
  v_accvgpr_read_b32 v67, a49
  v_accvgpr_read_b32 v68, a53
  v_accvgpr_read_b32 v69, a57
  v_accvgpr_read_b32 v70, a61
  v_accvgpr_read_b32 v71, a65
  v_accvgpr_read_b32 v72, a69
  v_accvgpr_read_b32 v73, a73
  v_accvgpr_read_b32 v74, a80
  v_accvgpr_read_b32 v75, a81
  v_accvgpr_read_b32 v76, a82
  v_accvgpr_read_b32 v77, a83
  v_and_b32 v40, 0xffff, v74
  v_lshrrev_b32 v41, 16, v74
  v_and_b32 v42, 0xffff, v75
  v_lshrrev_b32 v43, 16, v75
  v_dot2_f32_bf16 v184, v55, v43, 0
  v_dot2_f32_bf16 v185, v56, v43, 0
  v_dot2_f32_bf16 v186, v57, v43, 0
  v_dot2_f32_bf16 v187, v58, v43, 0
  v_dot2_f32_bf16 v188, v59, v43, 0
  v_dot2_f32_bf16 v189, v60, v43, 0
  v_dot2_f32_bf16 v190, v61, v43, 0
  v_dot2_f32_bf16 v191, v62, v43, 0
  v_dot2_f32_bf16 v184, v56, v42, v184
  v_dot2_f32_bf16 v185, v57, v42, v185
  v_dot2_f32_bf16 v186, v58, v42, v186
  v_dot2_f32_bf16 v187, v59, v42, v187
  v_dot2_f32_bf16 v188, v60, v42, v188
  v_dot2_f32_bf16 v189, v61, v42, v189
  v_dot2_f32_bf16 v190, v62, v42, v190
  v_dot2_f32_bf16 v191, v63, v42, v191
  v_dot2_f32_bf16 v184, v57, v41, v184
  v_dot2_f32_bf16 v185, v58, v41, v185
  v_dot2_f32_bf16 v186, v59, v41, v186
  v_dot2_f32_bf16 v187, v60, v41, v187
  v_dot2_f32_bf16 v188, v61, v41, v188
  v_dot2_f32_bf16 v189, v62, v41, v189
  v_dot2_f32_bf16 v190, v63, v41, v190
  v_dot2_f32_bf16 v191, v64, v41, v191
  v_dot2_f32_bf16 v184, v58, v40, v184
  v_dot2_f32_bf16 v185, v59, v40, v185
  v_dot2_f32_bf16 v186, v60, v40, v186
  v_dot2_f32_bf16 v187, v61, v40, v187
  v_dot2_f32_bf16 v188, v62, v40, v188
  v_dot2_f32_bf16 v189, v63, v40, v189
  v_dot2_f32_bf16 v190, v64, v40, v190
  v_dot2_f32_bf16 v191, v65, v40, v191
  v_lshlrev_b32 v44, 16, v66
  v_lshlrev_b32 v45, 16, v67
  v_lshlrev_b32 v46, 16, v68
  v_lshlrev_b32 v47, 16, v69
  v_lshlrev_b32 v48, 16, v70
  v_lshlrev_b32 v49, 16, v71
  v_lshlrev_b32 v50, 16, v72
  v_lshlrev_b32 v51, 16, v73
  v_mul_f32 v184, v184, v44
  v_mul_f32 v185, v185, v45
  v_mul_f32 v186, v186, v46
  v_mul_f32 v187, v187, v47
  v_mul_f32 v188, v188, v48
  v_mul_f32 v189, v189, v49
  v_mul_f32 v190, v190, v50
  v_mul_f32 v191, v191, v51
  v_cvt_pk_bf16_f32 v192, v191, v190
  v_cvt_pk_bf16_f32 v193, v189, v188
  v_cvt_pk_bf16_f32 v194, v187, v186
  v_cvt_pk_bf16_f32 v195, v185, v184
  ds_write_b128 v99, v[192:195] offset:288
  v_lshlrev_b32 v40, 16, v76
  v_and_b32 v41, 0xffff0000, v76
  v_lshlrev_b32 v42, 16, v77
  v_and_b32 v43, 0xffff0000, v77
  v_dot2_f32_bf16 v184, v55, v43, 0
  v_dot2_f32_bf16 v185, v56, v43, 0
  v_dot2_f32_bf16 v186, v57, v43, 0
  v_dot2_f32_bf16 v187, v58, v43, 0
  v_dot2_f32_bf16 v188, v59, v43, 0
  v_dot2_f32_bf16 v189, v60, v43, 0
  v_dot2_f32_bf16 v190, v61, v43, 0
  v_dot2_f32_bf16 v191, v62, v43, 0
  v_dot2_f32_bf16 v184, v56, v42, v184
  v_dot2_f32_bf16 v185, v57, v42, v185
  v_dot2_f32_bf16 v186, v58, v42, v186
  v_dot2_f32_bf16 v187, v59, v42, v187
  v_dot2_f32_bf16 v188, v60, v42, v188
  v_dot2_f32_bf16 v189, v61, v42, v189
  v_dot2_f32_bf16 v190, v62, v42, v190
  v_dot2_f32_bf16 v191, v63, v42, v191
  v_dot2_f32_bf16 v184, v57, v41, v184
  v_dot2_f32_bf16 v185, v58, v41, v185
  v_dot2_f32_bf16 v186, v59, v41, v186
  v_dot2_f32_bf16 v187, v60, v41, v187
  v_dot2_f32_bf16 v188, v61, v41, v188
  v_dot2_f32_bf16 v189, v62, v41, v189
  v_dot2_f32_bf16 v190, v63, v41, v190
  v_dot2_f32_bf16 v191, v64, v41, v191
  v_dot2_f32_bf16 v184, v58, v40, v184
  v_dot2_f32_bf16 v185, v59, v40, v185
  v_dot2_f32_bf16 v186, v60, v40, v186
  v_dot2_f32_bf16 v187, v61, v40, v187
  v_dot2_f32_bf16 v188, v62, v40, v188
  v_dot2_f32_bf16 v189, v63, v40, v189
  v_dot2_f32_bf16 v190, v64, v40, v190
  v_dot2_f32_bf16 v191, v65, v40, v191
  v_and_b32 v44, 0xffff0000, v66
  v_and_b32 v45, 0xffff0000, v67
  v_and_b32 v46, 0xffff0000, v68
  v_and_b32 v47, 0xffff0000, v69
  v_and_b32 v48, 0xffff0000, v70
  v_and_b32 v49, 0xffff0000, v71
  v_and_b32 v50, 0xffff0000, v72
  v_and_b32 v51, 0xffff0000, v73
  v_mul_f32 v184, v184, v44
  v_mul_f32 v185, v185, v45
  v_mul_f32 v186, v186, v46
  v_mul_f32 v187, v187, v47
  v_mul_f32 v188, v188, v48
  v_mul_f32 v189, v189, v49
  v_mul_f32 v190, v190, v50
  v_mul_f32 v191, v191, v51
  v_cvt_pk_bf16_f32 v196, v191, v190
  v_cvt_pk_bf16_f32 v197, v189, v188
  v_cvt_pk_bf16_f32 v198, v187, v186
  v_cvt_pk_bf16_f32 v199, v185, v184
  ds_write_b128 v99, v[196:199] offset:432
  v_accvgpr_read_b32 v55, a2
  v_accvgpr_read_b32 v56, a6
  v_accvgpr_read_b32 v57, a10
  v_accvgpr_read_b32 v58, a14
  v_accvgpr_read_b32 v59, a18
  v_accvgpr_read_b32 v60, a22
  v_accvgpr_read_b32 v61, a26
  v_accvgpr_read_b32 v62, a30
  v_accvgpr_read_b32 v63, a34
  v_accvgpr_read_b32 v64, a38
  v_accvgpr_read_b32 v65, a42
  v_accvgpr_read_b32 v66, a46
  v_accvgpr_read_b32 v67, a50
  v_accvgpr_read_b32 v68, a54
  v_accvgpr_read_b32 v69, a58
  v_accvgpr_read_b32 v70, a62
  v_accvgpr_read_b32 v71, a66
  v_accvgpr_read_b32 v72, a70
  v_accvgpr_read_b32 v73, a74
  v_accvgpr_read_b32 v74, a84
  v_accvgpr_read_b32 v75, a85
  v_accvgpr_read_b32 v76, a86
  v_accvgpr_read_b32 v77, a87
  v_and_b32 v40, 0xffff, v74
  v_lshrrev_b32 v41, 16, v74
  v_and_b32 v42, 0xffff, v75
  v_lshrrev_b32 v43, 16, v75
  v_dot2_f32_bf16 v184, v55, v43, 0
  v_dot2_f32_bf16 v185, v56, v43, 0
  v_dot2_f32_bf16 v186, v57, v43, 0
  v_dot2_f32_bf16 v187, v58, v43, 0
  v_dot2_f32_bf16 v188, v59, v43, 0
  v_dot2_f32_bf16 v189, v60, v43, 0
  v_dot2_f32_bf16 v190, v61, v43, 0
  v_dot2_f32_bf16 v191, v62, v43, 0
  v_dot2_f32_bf16 v184, v56, v42, v184
  v_dot2_f32_bf16 v185, v57, v42, v185
  v_dot2_f32_bf16 v186, v58, v42, v186
  v_dot2_f32_bf16 v187, v59, v42, v187
  v_dot2_f32_bf16 v188, v60, v42, v188
  v_dot2_f32_bf16 v189, v61, v42, v189
  v_dot2_f32_bf16 v190, v62, v42, v190
  v_dot2_f32_bf16 v191, v63, v42, v191
  v_dot2_f32_bf16 v184, v57, v41, v184
  v_dot2_f32_bf16 v185, v58, v41, v185
  v_dot2_f32_bf16 v186, v59, v41, v186
  v_dot2_f32_bf16 v187, v60, v41, v187
  v_dot2_f32_bf16 v188, v61, v41, v188
  v_dot2_f32_bf16 v189, v62, v41, v189
  v_dot2_f32_bf16 v190, v63, v41, v190
  v_dot2_f32_bf16 v191, v64, v41, v191
  v_dot2_f32_bf16 v184, v58, v40, v184
  v_dot2_f32_bf16 v185, v59, v40, v185
  v_dot2_f32_bf16 v186, v60, v40, v186
  v_dot2_f32_bf16 v187, v61, v40, v187
  v_dot2_f32_bf16 v188, v62, v40, v188
  v_dot2_f32_bf16 v189, v63, v40, v189
  v_dot2_f32_bf16 v190, v64, v40, v190
  v_dot2_f32_bf16 v191, v65, v40, v191
  v_lshlrev_b32 v44, 16, v66
  v_lshlrev_b32 v45, 16, v67
  v_lshlrev_b32 v46, 16, v68
  v_lshlrev_b32 v47, 16, v69
  v_lshlrev_b32 v48, 16, v70
  v_lshlrev_b32 v49, 16, v71
  v_lshlrev_b32 v50, 16, v72
  v_lshlrev_b32 v51, 16, v73
  v_mul_f32 v184, v184, v44
  v_mul_f32 v185, v185, v45
  v_mul_f32 v186, v186, v46
  v_mul_f32 v187, v187, v47
  v_mul_f32 v188, v188, v48
  v_mul_f32 v189, v189, v49
  v_mul_f32 v190, v190, v50
  v_mul_f32 v191, v191, v51
  v_cvt_pk_bf16_f32 v192, v191, v190
  v_cvt_pk_bf16_f32 v193, v189, v188
  v_cvt_pk_bf16_f32 v194, v187, v186
  v_cvt_pk_bf16_f32 v195, v185, v184
  ds_write_b128 v99, v[192:195] offset:576
  v_lshlrev_b32 v40, 16, v76
  v_and_b32 v41, 0xffff0000, v76
  v_lshlrev_b32 v42, 16, v77
  v_and_b32 v43, 0xffff0000, v77
  v_dot2_f32_bf16 v184, v55, v43, 0
  v_dot2_f32_bf16 v185, v56, v43, 0
  v_dot2_f32_bf16 v186, v57, v43, 0
  v_dot2_f32_bf16 v187, v58, v43, 0
  v_dot2_f32_bf16 v188, v59, v43, 0
  v_dot2_f32_bf16 v189, v60, v43, 0
  v_dot2_f32_bf16 v190, v61, v43, 0
  v_dot2_f32_bf16 v191, v62, v43, 0
  v_dot2_f32_bf16 v184, v56, v42, v184
  v_dot2_f32_bf16 v185, v57, v42, v185
  v_dot2_f32_bf16 v186, v58, v42, v186
  v_dot2_f32_bf16 v187, v59, v42, v187
  v_dot2_f32_bf16 v188, v60, v42, v188
  v_dot2_f32_bf16 v189, v61, v42, v189
  v_dot2_f32_bf16 v190, v62, v42, v190
  v_dot2_f32_bf16 v191, v63, v42, v191
  v_dot2_f32_bf16 v184, v57, v41, v184
  v_dot2_f32_bf16 v185, v58, v41, v185
  v_dot2_f32_bf16 v186, v59, v41, v186
  v_dot2_f32_bf16 v187, v60, v41, v187
  v_dot2_f32_bf16 v188, v61, v41, v188
  v_dot2_f32_bf16 v189, v62, v41, v189
  v_dot2_f32_bf16 v190, v63, v41, v190
  v_dot2_f32_bf16 v191, v64, v41, v191
  v_dot2_f32_bf16 v184, v58, v40, v184
  v_dot2_f32_bf16 v185, v59, v40, v185
  v_dot2_f32_bf16 v186, v60, v40, v186
  v_dot2_f32_bf16 v187, v61, v40, v187
  v_dot2_f32_bf16 v188, v62, v40, v188
  v_dot2_f32_bf16 v189, v63, v40, v189
  v_dot2_f32_bf16 v190, v64, v40, v190
  v_dot2_f32_bf16 v191, v65, v40, v191
  v_and_b32 v44, 0xffff0000, v66
  v_and_b32 v45, 0xffff0000, v67
  v_and_b32 v46, 0xffff0000, v68
  v_and_b32 v47, 0xffff0000, v69
  v_and_b32 v48, 0xffff0000, v70
  v_and_b32 v49, 0xffff0000, v71
  v_and_b32 v50, 0xffff0000, v72
  v_and_b32 v51, 0xffff0000, v73
  v_mul_f32 v184, v184, v44
  v_mul_f32 v185, v185, v45
  v_mul_f32 v186, v186, v46
  v_mul_f32 v187, v187, v47
  v_mul_f32 v188, v188, v48
  v_mul_f32 v189, v189, v49
  v_mul_f32 v190, v190, v50
  v_mul_f32 v191, v191, v51
  v_cvt_pk_bf16_f32 v196, v191, v190
  v_cvt_pk_bf16_f32 v197, v189, v188
  v_cvt_pk_bf16_f32 v198, v187, v186
  v_cvt_pk_bf16_f32 v199, v185, v184
  ds_write_b128 v99, v[196:199] offset:720
  v_accvgpr_read_b32 v55, a3
  v_accvgpr_read_b32 v56, a7
  v_accvgpr_read_b32 v57, a11
  v_accvgpr_read_b32 v58, a15
  v_accvgpr_read_b32 v59, a19
  v_accvgpr_read_b32 v60, a23
  v_accvgpr_read_b32 v61, a27
  v_accvgpr_read_b32 v62, a31
  v_accvgpr_read_b32 v63, a35
  v_accvgpr_read_b32 v64, a39
  v_accvgpr_read_b32 v65, a43
  v_accvgpr_read_b32 v66, a47
  v_accvgpr_read_b32 v67, a51
  v_accvgpr_read_b32 v68, a55
  v_accvgpr_read_b32 v69, a59
  v_accvgpr_read_b32 v70, a63
  v_accvgpr_read_b32 v71, a67
  v_accvgpr_read_b32 v72, a71
  v_accvgpr_read_b32 v73, a75
  v_accvgpr_read_b32 v74, a88
  v_accvgpr_read_b32 v75, a89
  v_accvgpr_read_b32 v76, a90
  v_accvgpr_read_b32 v77, a91
  v_and_b32 v40, 0xffff, v74
  v_lshrrev_b32 v41, 16, v74
  v_and_b32 v42, 0xffff, v75
  v_lshrrev_b32 v43, 16, v75
  v_dot2_f32_bf16 v184, v55, v43, 0
  v_dot2_f32_bf16 v185, v56, v43, 0
  v_dot2_f32_bf16 v186, v57, v43, 0
  v_dot2_f32_bf16 v187, v58, v43, 0
  v_dot2_f32_bf16 v188, v59, v43, 0
  v_dot2_f32_bf16 v189, v60, v43, 0
  v_dot2_f32_bf16 v190, v61, v43, 0
  v_dot2_f32_bf16 v191, v62, v43, 0
  v_dot2_f32_bf16 v184, v56, v42, v184
  v_dot2_f32_bf16 v185, v57, v42, v185
  v_dot2_f32_bf16 v186, v58, v42, v186
  v_dot2_f32_bf16 v187, v59, v42, v187
  v_dot2_f32_bf16 v188, v60, v42, v188
  v_dot2_f32_bf16 v189, v61, v42, v189
  v_dot2_f32_bf16 v190, v62, v42, v190
  v_dot2_f32_bf16 v191, v63, v42, v191
  v_dot2_f32_bf16 v184, v57, v41, v184
  v_dot2_f32_bf16 v185, v58, v41, v185
  v_dot2_f32_bf16 v186, v59, v41, v186
  v_dot2_f32_bf16 v187, v60, v41, v187
  v_dot2_f32_bf16 v188, v61, v41, v188
  v_dot2_f32_bf16 v189, v62, v41, v189
  v_dot2_f32_bf16 v190, v63, v41, v190
  v_dot2_f32_bf16 v191, v64, v41, v191
  v_dot2_f32_bf16 v184, v58, v40, v184
  v_dot2_f32_bf16 v185, v59, v40, v185
  v_dot2_f32_bf16 v186, v60, v40, v186
  v_dot2_f32_bf16 v187, v61, v40, v187
  v_dot2_f32_bf16 v188, v62, v40, v188
  v_dot2_f32_bf16 v189, v63, v40, v189
  v_dot2_f32_bf16 v190, v64, v40, v190
  v_dot2_f32_bf16 v191, v65, v40, v191
  v_lshlrev_b32 v44, 16, v66
  v_lshlrev_b32 v45, 16, v67
  v_lshlrev_b32 v46, 16, v68
  v_lshlrev_b32 v47, 16, v69
  v_lshlrev_b32 v48, 16, v70
  v_lshlrev_b32 v49, 16, v71
  v_lshlrev_b32 v50, 16, v72
  v_lshlrev_b32 v51, 16, v73
  v_mul_f32 v184, v184, v44
  v_mul_f32 v185, v185, v45
  v_mul_f32 v186, v186, v46
  v_mul_f32 v187, v187, v47
  v_mul_f32 v188, v188, v48
  v_mul_f32 v189, v189, v49
  v_mul_f32 v190, v190, v50
  v_mul_f32 v191, v191, v51
  v_cvt_pk_bf16_f32 v192, v191, v190
  v_cvt_pk_bf16_f32 v193, v189, v188
  v_cvt_pk_bf16_f32 v194, v187, v186
  v_cvt_pk_bf16_f32 v195, v185, v184
  ds_write_b128 v99, v[192:195] offset:864
  v_lshlrev_b32 v40, 16, v76
  v_and_b32 v41, 0xffff0000, v76
  v_lshlrev_b32 v42, 16, v77
  v_and_b32 v43, 0xffff0000, v77
  v_dot2_f32_bf16 v184, v55, v43, 0
  v_dot2_f32_bf16 v185, v56, v43, 0
  v_dot2_f32_bf16 v186, v57, v43, 0
  v_dot2_f32_bf16 v187, v58, v43, 0
  v_dot2_f32_bf16 v188, v59, v43, 0
  v_dot2_f32_bf16 v189, v60, v43, 0
  v_dot2_f32_bf16 v190, v61, v43, 0
  v_dot2_f32_bf16 v191, v62, v43, 0
  v_dot2_f32_bf16 v184, v56, v42, v184
  v_dot2_f32_bf16 v185, v57, v42, v185
  v_dot2_f32_bf16 v186, v58, v42, v186
  v_dot2_f32_bf16 v187, v59, v42, v187
  v_dot2_f32_bf16 v188, v60, v42, v188
  v_dot2_f32_bf16 v189, v61, v42, v189
  v_dot2_f32_bf16 v190, v62, v42, v190
  v_dot2_f32_bf16 v191, v63, v42, v191
  v_dot2_f32_bf16 v184, v57, v41, v184
  v_dot2_f32_bf16 v185, v58, v41, v185
  v_dot2_f32_bf16 v186, v59, v41, v186
  v_dot2_f32_bf16 v187, v60, v41, v187
  v_dot2_f32_bf16 v188, v61, v41, v188
  v_dot2_f32_bf16 v189, v62, v41, v189
  v_dot2_f32_bf16 v190, v63, v41, v190
  v_dot2_f32_bf16 v191, v64, v41, v191
  v_dot2_f32_bf16 v184, v58, v40, v184
  v_dot2_f32_bf16 v185, v59, v40, v185
  v_dot2_f32_bf16 v186, v60, v40, v186
  v_dot2_f32_bf16 v187, v61, v40, v187
  v_dot2_f32_bf16 v188, v62, v40, v188
  v_dot2_f32_bf16 v189, v63, v40, v189
  v_dot2_f32_bf16 v190, v64, v40, v190
  v_dot2_f32_bf16 v191, v65, v40, v191
  v_and_b32 v44, 0xffff0000, v66
  v_and_b32 v45, 0xffff0000, v67
  v_and_b32 v46, 0xffff0000, v68
  v_and_b32 v47, 0xffff0000, v69
  v_and_b32 v48, 0xffff0000, v70
  v_and_b32 v49, 0xffff0000, v71
  v_and_b32 v50, 0xffff0000, v72
  v_and_b32 v51, 0xffff0000, v73
  v_mul_f32 v184, v184, v44
  v_mul_f32 v185, v185, v45
  v_mul_f32 v186, v186, v46
  v_mul_f32 v187, v187, v47
  v_mul_f32 v188, v188, v48
  v_mul_f32 v189, v189, v49
  v_mul_f32 v190, v190, v50
  v_mul_f32 v191, v191, v51
  v_cvt_pk_bf16_f32 v196, v191, v190
  v_cvt_pk_bf16_f32 v197, v189, v188
  v_cvt_pk_bf16_f32 v198, v187, v186
  v_cvt_pk_bf16_f32 v199, v185, v184
  ds_write_b128 v99, v[196:199] offset:1008
  s_waitcnt lgkmcnt(0)
  s_barrier
  s_add_u32 s101, s100, 0
  s_and_b32 s34, s101, 7
  s_mul_i32 s34, s34, 294912
  s_lshr_b32 s35, s101, 3
  s_lshl_b32 s35, s35, 7
  s_sub_u32 s34, s34, s35
  s_add_u32 s34, s34, 3968
  ds_read_b128 v[56:59], v100 offset:0
  ds_read_b128 v[60:63], v101 offset:0
  ds_read_b128 v[64:67], v102 offset:0
  s_waitcnt lgkmcnt(2)
  buffer_store_dwordx4 v[56:59], v103, s[16:19], s34 offen sc1
  s_waitcnt lgkmcnt(1)
  buffer_store_dwordx4 v[60:63], v104, s[16:19], s34 offen sc1
  s_waitcnt lgkmcnt(0)
  buffer_store_dwordx4 v[64:67], v105, s[16:19], s34 offen sc1
  s_add_u32 s101, s100, 112
  s_and_b32 s34, s101, 7
  s_mul_i32 s34, s34, 294912
  s_lshr_b32 s35, s101, 3
  s_lshl_b32 s35, s35, 7
  s_sub_u32 s34, s34, s35
  s_add_u32 s34, s34, 3968
  ds_read_b128 v[68:71], v100 offset:10368
  ds_read_b128 v[72:75], v101 offset:10368
  ds_read_b128 v[76:79], v102 offset:10368
  s_waitcnt lgkmcnt(2)
  buffer_store_dwordx4 v[68:71], v103, s[16:19], s34 offen sc1
  s_waitcnt lgkmcnt(1)
  buffer_store_dwordx4 v[72:75], v104, s[16:19], s34 offen sc1
  s_waitcnt lgkmcnt(0)
  buffer_store_dwordx4 v[76:79], v105, s[16:19], s34 offen sc1
  s_cmp_ge_u32 s2, 176
  s_cbranch_scc1 KV_NO3
  s_add_u32 s101, s100, 224
  s_and_b32 s34, s101, 7
  s_mul_i32 s34, s34, 294912
  s_lshr_b32 s35, s101, 3
  s_lshl_b32 s35, s35, 7
  s_sub_u32 s34, s34, s35
  s_add_u32 s34, s34, 3968
  ds_read_b128 v[56:59], v100 offset:20736
  ds_read_b128 v[60:63], v101 offset:20736
  ds_read_b128 v[64:67], v102 offset:20736
  s_waitcnt lgkmcnt(2)
  buffer_store_dwordx4 v[56:59], v103, s[16:19], s34 offen sc1
  s_waitcnt lgkmcnt(1)
  buffer_store_dwordx4 v[60:63], v104, s[16:19], s34 offen sc1
  s_waitcnt lgkmcnt(0)
  buffer_store_dwordx4 v[64:67], v105, s[16:19], s34 offen sc1
KV_NO3:
  s_waitcnt lgkmcnt(0)
  s_barrier
K_NOKV:
  s_waitcnt vmcnt(9)
  s_mov_b32 s35, 0x3f803f80
  v_mov_b32 v64, 0
  v_mov_b32 v65, 0
  v_mov_b32 v66, 0
  v_mov_b32 v67, 0
  v_dot2_f32_bf16 v64, v112, s35, v64
  v_dot2_f32_bf16 v66, v112, v112, v66
  v_dot2_f32_bf16 v65, v113, s35, v65
  v_dot2_f32_bf16 v67, v113, v113, v67
  v_dot2_f32_bf16 v64, v114, s35, v64
  v_dot2_f32_bf16 v66, v114, v114, v66
  v_dot2_f32_bf16 v65, v115, s35, v65
  v_dot2_f32_bf16 v67, v115, v115, v67
  v_dot2_f32_bf16 v64, v116, s35, v64
  v_dot2_f32_bf16 v66, v116, v116, v66
  v_dot2_f32_bf16 v65, v117, s35, v65
  v_dot2_f32_bf16 v67, v117, v117, v67
  v_dot2_f32_bf16 v64, v118, s35, v64
  v_dot2_f32_bf16 v66, v118, v118, v66
  v_dot2_f32_bf16 v65, v119, s35, v65
  v_dot2_f32_bf16 v67, v119, v119, v67
  v_dot2_f32_bf16 v64, v120, s35, v64
  v_dot2_f32_bf16 v66, v120, v120, v66
  v_dot2_f32_bf16 v65, v121, s35, v65
  v_dot2_f32_bf16 v67, v121, v121, v67
  v_dot2_f32_bf16 v64, v122, s35, v64
  v_dot2_f32_bf16 v66, v122, v122, v66
  v_dot2_f32_bf16 v65, v123, s35, v65
  v_dot2_f32_bf16 v67, v123, v123, v67
  v_dot2_f32_bf16 v64, v124, s35, v64
  v_dot2_f32_bf16 v66, v124, v124, v66
  v_dot2_f32_bf16 v65, v125, s35, v65
  v_dot2_f32_bf16 v67, v125, v125, v67
  v_dot2_f32_bf16 v64, v126, s35, v64
  v_dot2_f32_bf16 v66, v126, v126, v66
  v_dot2_f32_bf16 v65, v127, s35, v65
  v_dot2_f32_bf16 v67, v127, v127, v67
  v_dot2_f32_bf16 v64, v128, s35, v64
  v_dot2_f32_bf16 v66, v128, v128, v66
  v_dot2_f32_bf16 v65, v129, s35, v65
  v_dot2_f32_bf16 v67, v129, v129, v67
  v_dot2_f32_bf16 v64, v130, s35, v64
  v_dot2_f32_bf16 v66, v130, v130, v66
  v_dot2_f32_bf16 v65, v131, s35, v65
  v_dot2_f32_bf16 v67, v131, v131, v67
  v_dot2_f32_bf16 v64, v132, s35, v64
  v_dot2_f32_bf16 v66, v132, v132, v66
  v_dot2_f32_bf16 v65, v133, s35, v65
  v_dot2_f32_bf16 v67, v133, v133, v67
  v_dot2_f32_bf16 v64, v134, s35, v64
  v_dot2_f32_bf16 v66, v134, v134, v66
  v_dot2_f32_bf16 v65, v135, s35, v65
  v_dot2_f32_bf16 v67, v135, v135, v67
  v_dot2_f32_bf16 v64, v136, s35, v64
  v_dot2_f32_bf16 v66, v136, v136, v66
  v_dot2_f32_bf16 v65, v137, s35, v65
  v_dot2_f32_bf16 v67, v137, v137, v67
  v_dot2_f32_bf16 v64, v138, s35, v64
  v_dot2_f32_bf16 v66, v138, v138, v66
  v_dot2_f32_bf16 v65, v139, s35, v65
  v_dot2_f32_bf16 v67, v139, v139, v67
  v_dot2_f32_bf16 v64, v140, s35, v64
  v_dot2_f32_bf16 v66, v140, v140, v66
  v_dot2_f32_bf16 v65, v141, s35, v65
  v_dot2_f32_bf16 v67, v141, v141, v67
  v_dot2_f32_bf16 v64, v142, s35, v64
  v_dot2_f32_bf16 v66, v142, v142, v66
  v_dot2_f32_bf16 v65, v143, s35, v65
  v_dot2_f32_bf16 v67, v143, v143, v67
  v_dot2_f32_bf16 v64, v144, s35, v64
  v_dot2_f32_bf16 v66, v144, v144, v66
  v_dot2_f32_bf16 v65, v145, s35, v65
  v_dot2_f32_bf16 v67, v145, v145, v67
  v_dot2_f32_bf16 v64, v146, s35, v64
  v_dot2_f32_bf16 v66, v146, v146, v66
  v_dot2_f32_bf16 v65, v147, s35, v65
  v_dot2_f32_bf16 v67, v147, v147, v67
  s_nop 2
  v_add_f32 v64, v64, v65
  v_add_f32 v66, v66, v67
  s_nop 1
  v_add_f32_dpp v64, v64, v64 quad_perm:[1,0,3,2] row_mask:0xf bank_mask:0xf
  v_add_f32_dpp v66, v66, v66 quad_perm:[1,0,3,2] row_mask:0xf bank_mask:0xf
  s_nop 1
  v_add_f32_dpp v64, v64, v64 quad_perm:[2,3,0,1] row_mask:0xf bank_mask:0xf
  v_add_f32_dpp v66, v66, v66 quad_perm:[2,3,0,1] row_mask:0xf bank_mask:0xf
  s_nop 1
  v_add_f32_dpp v64, v64, v64 row_half_mirror row_mask:0xf bank_mask:0xf
  v_add_f32_dpp v66, v66, v66 row_half_mirror row_mask:0xf bank_mask:0xf
  v_mul_f32 v64, 0x3ae38e39, v64
  v_mul_f32 v66, 0x3ae38e39, v66
  v_fma_f32 v66, -v64, v64, v66
  v_max_f32 v66, 0, v66
  v_cvt_pk_bf16_f32 v66, v66, v66
  v_lshlrev_b32 v66, 16, v66
  v_add_f32 v66, 0x3727c5ac, v66
  v_cvt_pk_bf16_f32 v66, v66, v66
  v_lshlrev_b32 v66, 16, v66
  v_sqrt_f32 v66, v66
  s_nop 0
  v_cvt_pk_bf16_f32 v66, v66, v66
  v_lshlrev_b32 v66, 16, v66
  v_rcp_f32 v68, v66
  v_cvt_pk_bf16_f32 v64, v64, v64
  v_lshlrev_b32 v64, 16, v64
  v_mul_f32 v69, v64, v68
  v_sub_f32 v69, 0, v69
  v_mul_f32 v74, 0xbfb8aa3b, v68
  v_mul_f32 v75, 0xbfb8aa3b, v69
  v_lshlrev_b32 v70, 16, v112
  v_and_b32 v71, 0xffff0000, v112
  v_fma_f32 v70, v70, v74, v75
  v_fma_f32 v71, v71, v74, v75
  v_cvt_pk_bf16_f32 v112, v70, v71
  v_lshlrev_b32 v72, 16, v113
  v_and_b32 v73, 0xffff0000, v113
  v_fma_f32 v72, v72, v74, v75
  v_fma_f32 v73, v73, v74, v75
  v_cvt_pk_bf16_f32 v113, v72, v73
  v_lshlrev_b32 v70, 16, v114
  v_and_b32 v71, 0xffff0000, v114
  v_fma_f32 v70, v70, v74, v75
  v_fma_f32 v71, v71, v74, v75
  v_cvt_pk_bf16_f32 v114, v70, v71
  v_lshlrev_b32 v72, 16, v115
  v_and_b32 v73, 0xffff0000, v115
  v_fma_f32 v72, v72, v74, v75
  v_fma_f32 v73, v73, v74, v75
  v_cvt_pk_bf16_f32 v115, v72, v73
  ds_write_b128 v90, v[112:115] offset:0
  v_lshlrev_b32 v70, 16, v116
  v_and_b32 v71, 0xffff0000, v116
  v_fma_f32 v70, v70, v74, v75
  v_fma_f32 v71, v71, v74, v75
  v_cvt_pk_bf16_f32 v116, v70, v71
  v_lshlrev_b32 v72, 16, v117
  v_and_b32 v73, 0xffff0000, v117
  v_fma_f32 v72, v72, v74, v75
  v_fma_f32 v73, v73, v74, v75
  v_cvt_pk_bf16_f32 v117, v72, v73
  v_lshlrev_b32 v70, 16, v118
  v_and_b32 v71, 0xffff0000, v118
  v_fma_f32 v70, v70, v74, v75
  v_fma_f32 v71, v71, v74, v75
  v_cvt_pk_bf16_f32 v118, v70, v71
  v_lshlrev_b32 v72, 16, v119
  v_and_b32 v73, 0xffff0000, v119
  v_fma_f32 v72, v72, v74, v75
  v_fma_f32 v73, v73, v74, v75
  v_cvt_pk_bf16_f32 v119, v72, v73
  ds_write_b128 v90, v[116:119] offset:2048
  v_lshlrev_b32 v70, 16, v120
  v_and_b32 v71, 0xffff0000, v120
  v_fma_f32 v70, v70, v74, v75
  v_fma_f32 v71, v71, v74, v75
  v_cvt_pk_bf16_f32 v120, v70, v71
  v_lshlrev_b32 v72, 16, v121
  v_and_b32 v73, 0xffff0000, v121
  v_fma_f32 v72, v72, v74, v75
  v_fma_f32 v73, v73, v74, v75
  v_cvt_pk_bf16_f32 v121, v72, v73
  v_lshlrev_b32 v70, 16, v122
  v_and_b32 v71, 0xffff0000, v122
  v_fma_f32 v70, v70, v74, v75
  v_fma_f32 v71, v71, v74, v75
  v_cvt_pk_bf16_f32 v122, v70, v71
  v_lshlrev_b32 v72, 16, v123
  v_and_b32 v73, 0xffff0000, v123
  v_fma_f32 v72, v72, v74, v75
  v_fma_f32 v73, v73, v74, v75
  v_cvt_pk_bf16_f32 v123, v72, v73
  ds_write_b128 v90, v[120:123] offset:4096
  v_lshlrev_b32 v70, 16, v124
  v_and_b32 v71, 0xffff0000, v124
  v_fma_f32 v70, v70, v74, v75
  v_fma_f32 v71, v71, v74, v75
  v_cvt_pk_bf16_f32 v124, v70, v71
  v_lshlrev_b32 v72, 16, v125
  v_and_b32 v73, 0xffff0000, v125
  v_fma_f32 v72, v72, v74, v75
  v_fma_f32 v73, v73, v74, v75
  v_cvt_pk_bf16_f32 v125, v72, v73
  v_lshlrev_b32 v70, 16, v126
  v_and_b32 v71, 0xffff0000, v126
  v_fma_f32 v70, v70, v74, v75
  v_fma_f32 v71, v71, v74, v75
  v_cvt_pk_bf16_f32 v126, v70, v71
  v_lshlrev_b32 v72, 16, v127
  v_and_b32 v73, 0xffff0000, v127
  v_fma_f32 v72, v72, v74, v75
  v_fma_f32 v73, v73, v74, v75
  v_cvt_pk_bf16_f32 v127, v72, v73
  ds_write_b128 v90, v[124:127] offset:6144
  v_lshlrev_b32 v70, 16, v128
  v_and_b32 v71, 0xffff0000, v128
  v_fma_f32 v70, v70, v74, v75
  v_fma_f32 v71, v71, v74, v75
  v_cvt_pk_bf16_f32 v128, v70, v71
  v_lshlrev_b32 v72, 16, v129
  v_and_b32 v73, 0xffff0000, v129
  v_fma_f32 v72, v72, v74, v75
  v_fma_f32 v73, v73, v74, v75
  v_cvt_pk_bf16_f32 v129, v72, v73
  v_lshlrev_b32 v70, 16, v130
  v_and_b32 v71, 0xffff0000, v130
  v_fma_f32 v70, v70, v74, v75
  v_fma_f32 v71, v71, v74, v75
  v_cvt_pk_bf16_f32 v130, v70, v71
  v_lshlrev_b32 v72, 16, v131
  v_and_b32 v73, 0xffff0000, v131
  v_fma_f32 v72, v72, v74, v75
  v_fma_f32 v73, v73, v74, v75
  v_cvt_pk_bf16_f32 v131, v72, v73
  ds_write_b128 v90, v[128:131] offset:8192
  v_lshlrev_b32 v70, 16, v132
  v_and_b32 v71, 0xffff0000, v132
  v_fma_f32 v70, v70, v74, v75
  v_fma_f32 v71, v71, v74, v75
  v_cvt_pk_bf16_f32 v132, v70, v71
  v_lshlrev_b32 v72, 16, v133
  v_and_b32 v73, 0xffff0000, v133
  v_fma_f32 v72, v72, v74, v75
  v_fma_f32 v73, v73, v74, v75
  v_cvt_pk_bf16_f32 v133, v72, v73
  v_lshlrev_b32 v70, 16, v134
  v_and_b32 v71, 0xffff0000, v134
  v_fma_f32 v70, v70, v74, v75
  v_fma_f32 v71, v71, v74, v75
  v_cvt_pk_bf16_f32 v134, v70, v71
  v_lshlrev_b32 v72, 16, v135
  v_and_b32 v73, 0xffff0000, v135
  v_fma_f32 v72, v72, v74, v75
  v_fma_f32 v73, v73, v74, v75
  v_cvt_pk_bf16_f32 v135, v72, v73
  ds_write_b128 v90, v[132:135] offset:10240
  v_lshlrev_b32 v70, 16, v136
  v_and_b32 v71, 0xffff0000, v136
  v_fma_f32 v70, v70, v74, v75
  v_fma_f32 v71, v71, v74, v75
  v_cvt_pk_bf16_f32 v136, v70, v71
  v_lshlrev_b32 v72, 16, v137
  v_and_b32 v73, 0xffff0000, v137
  v_fma_f32 v72, v72, v74, v75
  v_fma_f32 v73, v73, v74, v75
  v_cvt_pk_bf16_f32 v137, v72, v73
  v_lshlrev_b32 v70, 16, v138
  v_and_b32 v71, 0xffff0000, v138
  v_fma_f32 v70, v70, v74, v75
  v_fma_f32 v71, v71, v74, v75
  v_cvt_pk_bf16_f32 v138, v70, v71
  v_lshlrev_b32 v72, 16, v139
  v_and_b32 v73, 0xffff0000, v139
  v_fma_f32 v72, v72, v74, v75
  v_fma_f32 v73, v73, v74, v75
  v_cvt_pk_bf16_f32 v139, v72, v73
  ds_write_b128 v90, v[136:139] offset:12288
  v_lshlrev_b32 v70, 16, v140
  v_and_b32 v71, 0xffff0000, v140
  v_fma_f32 v70, v70, v74, v75
  v_fma_f32 v71, v71, v74, v75
  v_cvt_pk_bf16_f32 v140, v70, v71
  v_lshlrev_b32 v72, 16, v141
  v_and_b32 v73, 0xffff0000, v141
  v_fma_f32 v72, v72, v74, v75
  v_fma_f32 v73, v73, v74, v75
  v_cvt_pk_bf16_f32 v141, v72, v73
  v_lshlrev_b32 v70, 16, v142
  v_and_b32 v71, 0xffff0000, v142
  v_fma_f32 v70, v70, v74, v75
  v_fma_f32 v71, v71, v74, v75
  v_cvt_pk_bf16_f32 v142, v70, v71
  v_lshlrev_b32 v72, 16, v143
  v_and_b32 v73, 0xffff0000, v143
  v_fma_f32 v72, v72, v74, v75
  v_fma_f32 v73, v73, v74, v75
  v_cvt_pk_bf16_f32 v143, v72, v73
  ds_write_b128 v90, v[140:143] offset:14336
  v_lshlrev_b32 v70, 16, v144
  v_and_b32 v71, 0xffff0000, v144
  v_fma_f32 v70, v70, v74, v75
  v_fma_f32 v71, v71, v74, v75
  v_cvt_pk_bf16_f32 v144, v70, v71
  v_lshlrev_b32 v72, 16, v145
  v_and_b32 v73, 0xffff0000, v145
  v_fma_f32 v72, v72, v74, v75
  v_fma_f32 v73, v73, v74, v75
  v_cvt_pk_bf16_f32 v145, v72, v73
  v_lshlrev_b32 v70, 16, v146
  v_and_b32 v71, 0xffff0000, v146
  v_fma_f32 v70, v70, v74, v75
  v_fma_f32 v71, v71, v74, v75
  v_cvt_pk_bf16_f32 v146, v70, v71
  v_lshlrev_b32 v72, 16, v147
  v_and_b32 v73, 0xffff0000, v147
  v_fma_f32 v72, v72, v74, v75
  v_fma_f32 v73, v73, v74, v75
  v_cvt_pk_bf16_f32 v147, v72, v73
  ds_write_b128 v90, v[144:147] offset:16384
  v_cmp_eq_u32 vcc, 0, v106
  s_and_saveexec_b64 s[34:35], vcc
  ds_write_b64 v91, v[68:69] offset:0
  s_mov_b64 exec, s[34:35]
  s_add_u32 s31, s29, 294912
  s_add_u32 m0, s28, 17408
  s_nop 0
  buffer_load_dwordx4 v12, s[8:11], s31 offen lds
  s_add_u32 m0, s28, 9216
  s_nop 0
  buffer_load_dwordx4 v4, s[8:11], s31 offen lds
  buffer_load_dwordx4 v6, s[8:11], s31 offen offset:2048 lds
  s_add_u32 m0, s28, 13312
  s_nop 0
  buffer_load_dwordx4 v8, s[8:11], s31 offen lds
  buffer_load_dwordx4 v10, s[8:11], s31 offen offset:2048 lds
  s_add_u32 m0, s28, 9216
  s_nop 0
  buffer_load_dwordx4 v5, s[8:11], s31 offen offset:1024 lds
  buffer_load_dwordx4 v7, s[8:11], s31 offen offset:3072 lds
  s_add_u32 m0, s28, 13312
  s_nop 0
  buffer_load_dwordx4 v9, s[8:11], s31 offen offset:1024 lds
  buffer_load_dwordx4 v11, s[8:11], s31 offen offset:3072 lds
  buffer_load_dword v98, v92, s[8:11], s29 offen
  buffer_load_dword v98, v95, s[12:15], s92 offen
  buffer_load_dword v89, v89, s[44:47], 0 offen sc1
  s_waitcnt vmcnt(12)
  s_mov_b32 s35, 0x3f803f80
  v_mov_b32 v64, 0
  v_mov_b32 v65, 0
  v_mov_b32 v66, 0
  v_mov_b32 v67, 0
  v_dot2_f32_bf16 v64, v148, s35, v64
  v_dot2_f32_bf16 v66, v148, v148, v66
  v_dot2_f32_bf16 v65, v149, s35, v65
  v_dot2_f32_bf16 v67, v149, v149, v67
  v_dot2_f32_bf16 v64, v150, s35, v64
  v_dot2_f32_bf16 v66, v150, v150, v66
  v_dot2_f32_bf16 v65, v151, s35, v65
  v_dot2_f32_bf16 v67, v151, v151, v67
  v_dot2_f32_bf16 v64, v152, s35, v64
  v_dot2_f32_bf16 v66, v152, v152, v66
  v_dot2_f32_bf16 v65, v153, s35, v65
  v_dot2_f32_bf16 v67, v153, v153, v67
  v_dot2_f32_bf16 v64, v154, s35, v64
  v_dot2_f32_bf16 v66, v154, v154, v66
  v_dot2_f32_bf16 v65, v155, s35, v65
  v_dot2_f32_bf16 v67, v155, v155, v67
  v_dot2_f32_bf16 v64, v156, s35, v64
  v_dot2_f32_bf16 v66, v156, v156, v66
  v_dot2_f32_bf16 v65, v157, s35, v65
  v_dot2_f32_bf16 v67, v157, v157, v67
  v_dot2_f32_bf16 v64, v158, s35, v64
  v_dot2_f32_bf16 v66, v158, v158, v66
  v_dot2_f32_bf16 v65, v159, s35, v65
  v_dot2_f32_bf16 v67, v159, v159, v67
  v_dot2_f32_bf16 v64, v160, s35, v64
  v_dot2_f32_bf16 v66, v160, v160, v66
  v_dot2_f32_bf16 v65, v161, s35, v65
  v_dot2_f32_bf16 v67, v161, v161, v67
  v_dot2_f32_bf16 v64, v162, s35, v64
  v_dot2_f32_bf16 v66, v162, v162, v66
  v_dot2_f32_bf16 v65, v163, s35, v65
  v_dot2_f32_bf16 v67, v163, v163, v67
  v_dot2_f32_bf16 v64, v164, s35, v64
  v_dot2_f32_bf16 v66, v164, v164, v66
  v_dot2_f32_bf16 v65, v165, s35, v65
  v_dot2_f32_bf16 v67, v165, v165, v67
  v_dot2_f32_bf16 v64, v166, s35, v64
  v_dot2_f32_bf16 v66, v166, v166, v66
  v_dot2_f32_bf16 v65, v167, s35, v65
  v_dot2_f32_bf16 v67, v167, v167, v67
  v_dot2_f32_bf16 v64, v168, s35, v64
  v_dot2_f32_bf16 v66, v168, v168, v66
  v_dot2_f32_bf16 v65, v169, s35, v65
  v_dot2_f32_bf16 v67, v169, v169, v67
  v_dot2_f32_bf16 v64, v170, s35, v64
  v_dot2_f32_bf16 v66, v170, v170, v66
  v_dot2_f32_bf16 v65, v171, s35, v65
  v_dot2_f32_bf16 v67, v171, v171, v67
  v_dot2_f32_bf16 v64, v172, s35, v64
  v_dot2_f32_bf16 v66, v172, v172, v66
  v_dot2_f32_bf16 v65, v173, s35, v65
  v_dot2_f32_bf16 v67, v173, v173, v67
  v_dot2_f32_bf16 v64, v174, s35, v64
  v_dot2_f32_bf16 v66, v174, v174, v66
  v_dot2_f32_bf16 v65, v175, s35, v65
  v_dot2_f32_bf16 v67, v175, v175, v67
  v_dot2_f32_bf16 v64, v176, s35, v64
  v_dot2_f32_bf16 v66, v176, v176, v66
  v_dot2_f32_bf16 v65, v177, s35, v65
  v_dot2_f32_bf16 v67, v177, v177, v67
  v_dot2_f32_bf16 v64, v178, s35, v64
  v_dot2_f32_bf16 v66, v178, v178, v66
  v_dot2_f32_bf16 v65, v179, s35, v65
  v_dot2_f32_bf16 v67, v179, v179, v67
  v_dot2_f32_bf16 v64, v180, s35, v64
  v_dot2_f32_bf16 v66, v180, v180, v66
  v_dot2_f32_bf16 v65, v181, s35, v65
  v_dot2_f32_bf16 v67, v181, v181, v67
  v_dot2_f32_bf16 v64, v182, s35, v64
  v_dot2_f32_bf16 v66, v182, v182, v66
  v_dot2_f32_bf16 v65, v183, s35, v65
  v_dot2_f32_bf16 v67, v183, v183, v67
  s_nop 2
  v_add_f32 v64, v64, v65
  v_add_f32 v66, v66, v67
  s_nop 1
  v_add_f32_dpp v64, v64, v64 quad_perm:[1,0,3,2] row_mask:0xf bank_mask:0xf
  v_add_f32_dpp v66, v66, v66 quad_perm:[1,0,3,2] row_mask:0xf bank_mask:0xf
  s_nop 1
  v_add_f32_dpp v64, v64, v64 quad_perm:[2,3,0,1] row_mask:0xf bank_mask:0xf
  v_add_f32_dpp v66, v66, v66 quad_perm:[2,3,0,1] row_mask:0xf bank_mask:0xf
  s_nop 1
  v_add_f32_dpp v64, v64, v64 row_half_mirror row_mask:0xf bank_mask:0xf
  v_add_f32_dpp v66, v66, v66 row_half_mirror row_mask:0xf bank_mask:0xf
  v_mul_f32 v64, 0x3ae38e39, v64
  v_mul_f32 v66, 0x3ae38e39, v66
  v_fma_f32 v66, -v64, v64, v66
  v_max_f32 v66, 0, v66
  v_cvt_pk_bf16_f32 v66, v66, v66
  v_lshlrev_b32 v66, 16, v66
  v_add_f32 v66, 0x3727c5ac, v66
  v_cvt_pk_bf16_f32 v66, v66, v66
  v_lshlrev_b32 v66, 16, v66
  v_sqrt_f32 v66, v66
  s_nop 0
  v_cvt_pk_bf16_f32 v66, v66, v66
  v_lshlrev_b32 v66, 16, v66
  v_rcp_f32 v68, v66
  v_cvt_pk_bf16_f32 v64, v64, v64
  v_lshlrev_b32 v64, 16, v64
  v_mul_f32 v69, v64, v68
  v_sub_f32 v69, 0, v69
  v_mul_f32 v74, 0xbfb8aa3b, v68
  v_mul_f32 v75, 0xbfb8aa3b, v69
  v_lshlrev_b32 v70, 16, v148
  v_and_b32 v71, 0xffff0000, v148
  v_fma_f32 v70, v70, v74, v75
  v_fma_f32 v71, v71, v74, v75
  v_cvt_pk_bf16_f32 v148, v70, v71
  v_lshlrev_b32 v72, 16, v149
  v_and_b32 v73, 0xffff0000, v149
  v_fma_f32 v72, v72, v74, v75
  v_fma_f32 v73, v73, v74, v75
  v_cvt_pk_bf16_f32 v149, v72, v73
  v_lshlrev_b32 v70, 16, v150
  v_and_b32 v71, 0xffff0000, v150
  v_fma_f32 v70, v70, v74, v75
  v_fma_f32 v71, v71, v74, v75
  v_cvt_pk_bf16_f32 v150, v70, v71
  v_lshlrev_b32 v72, 16, v151
  v_and_b32 v73, 0xffff0000, v151
  v_fma_f32 v72, v72, v74, v75
  v_fma_f32 v73, v73, v74, v75
  v_cvt_pk_bf16_f32 v151, v72, v73
  ds_write_b128 v90, v[148:151] offset:128
  v_lshlrev_b32 v70, 16, v152
  v_and_b32 v71, 0xffff0000, v152
  v_fma_f32 v70, v70, v74, v75
  v_fma_f32 v71, v71, v74, v75
  v_cvt_pk_bf16_f32 v152, v70, v71
  v_lshlrev_b32 v72, 16, v153
  v_and_b32 v73, 0xffff0000, v153
  v_fma_f32 v72, v72, v74, v75
  v_fma_f32 v73, v73, v74, v75
  v_cvt_pk_bf16_f32 v153, v72, v73
  v_lshlrev_b32 v70, 16, v154
  v_and_b32 v71, 0xffff0000, v154
  v_fma_f32 v70, v70, v74, v75
  v_fma_f32 v71, v71, v74, v75
  v_cvt_pk_bf16_f32 v154, v70, v71
  v_lshlrev_b32 v72, 16, v155
  v_and_b32 v73, 0xffff0000, v155
  v_fma_f32 v72, v72, v74, v75
  v_fma_f32 v73, v73, v74, v75
  v_cvt_pk_bf16_f32 v155, v72, v73
  ds_write_b128 v90, v[152:155] offset:2176
  v_lshlrev_b32 v70, 16, v156
  v_and_b32 v71, 0xffff0000, v156
  v_fma_f32 v70, v70, v74, v75
  v_fma_f32 v71, v71, v74, v75
  v_cvt_pk_bf16_f32 v156, v70, v71
  v_lshlrev_b32 v72, 16, v157
  v_and_b32 v73, 0xffff0000, v157
  v_fma_f32 v72, v72, v74, v75
  v_fma_f32 v73, v73, v74, v75
  v_cvt_pk_bf16_f32 v157, v72, v73
  v_lshlrev_b32 v70, 16, v158
  v_and_b32 v71, 0xffff0000, v158
  v_fma_f32 v70, v70, v74, v75
  v_fma_f32 v71, v71, v74, v75
  v_cvt_pk_bf16_f32 v158, v70, v71
  v_lshlrev_b32 v72, 16, v159
  v_and_b32 v73, 0xffff0000, v159
  v_fma_f32 v72, v72, v74, v75
  v_fma_f32 v73, v73, v74, v75
  v_cvt_pk_bf16_f32 v159, v72, v73
  ds_write_b128 v90, v[156:159] offset:4224
  v_lshlrev_b32 v70, 16, v160
  v_and_b32 v71, 0xffff0000, v160
  v_fma_f32 v70, v70, v74, v75
  v_fma_f32 v71, v71, v74, v75
  v_cvt_pk_bf16_f32 v160, v70, v71
  v_lshlrev_b32 v72, 16, v161
  v_and_b32 v73, 0xffff0000, v161
  v_fma_f32 v72, v72, v74, v75
  v_fma_f32 v73, v73, v74, v75
  v_cvt_pk_bf16_f32 v161, v72, v73
  v_lshlrev_b32 v70, 16, v162
  v_and_b32 v71, 0xffff0000, v162
  v_fma_f32 v70, v70, v74, v75
  v_fma_f32 v71, v71, v74, v75
  v_cvt_pk_bf16_f32 v162, v70, v71
  v_lshlrev_b32 v72, 16, v163
  v_and_b32 v73, 0xffff0000, v163
  v_fma_f32 v72, v72, v74, v75
  v_fma_f32 v73, v73, v74, v75
  v_cvt_pk_bf16_f32 v163, v72, v73
  ds_write_b128 v90, v[160:163] offset:6272
  v_lshlrev_b32 v70, 16, v164
  v_and_b32 v71, 0xffff0000, v164
  v_fma_f32 v70, v70, v74, v75
  v_fma_f32 v71, v71, v74, v75
  v_cvt_pk_bf16_f32 v164, v70, v71
  v_lshlrev_b32 v72, 16, v165
  v_and_b32 v73, 0xffff0000, v165
  v_fma_f32 v72, v72, v74, v75
  v_fma_f32 v73, v73, v74, v75
  v_cvt_pk_bf16_f32 v165, v72, v73
  v_lshlrev_b32 v70, 16, v166
  v_and_b32 v71, 0xffff0000, v166
  v_fma_f32 v70, v70, v74, v75
  v_fma_f32 v71, v71, v74, v75
  v_cvt_pk_bf16_f32 v166, v70, v71
  v_lshlrev_b32 v72, 16, v167
  v_and_b32 v73, 0xffff0000, v167
  v_fma_f32 v72, v72, v74, v75
  v_fma_f32 v73, v73, v74, v75
  v_cvt_pk_bf16_f32 v167, v72, v73
  ds_write_b128 v90, v[164:167] offset:8320
  v_lshlrev_b32 v70, 16, v168
  v_and_b32 v71, 0xffff0000, v168
  v_fma_f32 v70, v70, v74, v75
  v_fma_f32 v71, v71, v74, v75
  v_cvt_pk_bf16_f32 v168, v70, v71
  v_lshlrev_b32 v72, 16, v169
  v_and_b32 v73, 0xffff0000, v169
  v_fma_f32 v72, v72, v74, v75
  v_fma_f32 v73, v73, v74, v75
  v_cvt_pk_bf16_f32 v169, v72, v73
  v_lshlrev_b32 v70, 16, v170
  v_and_b32 v71, 0xffff0000, v170
  v_fma_f32 v70, v70, v74, v75
  v_fma_f32 v71, v71, v74, v75
  v_cvt_pk_bf16_f32 v170, v70, v71
  v_lshlrev_b32 v72, 16, v171
  v_and_b32 v73, 0xffff0000, v171
  v_fma_f32 v72, v72, v74, v75
  v_fma_f32 v73, v73, v74, v75
  v_cvt_pk_bf16_f32 v171, v72, v73
  ds_write_b128 v90, v[168:171] offset:10368
  v_lshlrev_b32 v70, 16, v172
  v_and_b32 v71, 0xffff0000, v172
  v_fma_f32 v70, v70, v74, v75
  v_fma_f32 v71, v71, v74, v75
  v_cvt_pk_bf16_f32 v172, v70, v71
  v_lshlrev_b32 v72, 16, v173
  v_and_b32 v73, 0xffff0000, v173
  v_fma_f32 v72, v72, v74, v75
  v_fma_f32 v73, v73, v74, v75
  v_cvt_pk_bf16_f32 v173, v72, v73
  v_lshlrev_b32 v70, 16, v174
  v_and_b32 v71, 0xffff0000, v174
  v_fma_f32 v70, v70, v74, v75
  v_fma_f32 v71, v71, v74, v75
  v_cvt_pk_bf16_f32 v174, v70, v71
  v_lshlrev_b32 v72, 16, v175
  v_and_b32 v73, 0xffff0000, v175
  v_fma_f32 v72, v72, v74, v75
  v_fma_f32 v73, v73, v74, v75
  v_cvt_pk_bf16_f32 v175, v72, v73
  ds_write_b128 v90, v[172:175] offset:12416
  v_lshlrev_b32 v70, 16, v176
  v_and_b32 v71, 0xffff0000, v176
  v_fma_f32 v70, v70, v74, v75
  v_fma_f32 v71, v71, v74, v75
  v_cvt_pk_bf16_f32 v176, v70, v71
  v_lshlrev_b32 v72, 16, v177
  v_and_b32 v73, 0xffff0000, v177
  v_fma_f32 v72, v72, v74, v75
  v_fma_f32 v73, v73, v74, v75
  v_cvt_pk_bf16_f32 v177, v72, v73
  v_lshlrev_b32 v70, 16, v178
  v_and_b32 v71, 0xffff0000, v178
  v_fma_f32 v70, v70, v74, v75
  v_fma_f32 v71, v71, v74, v75
  v_cvt_pk_bf16_f32 v178, v70, v71
  v_lshlrev_b32 v72, 16, v179
  v_and_b32 v73, 0xffff0000, v179
  v_fma_f32 v72, v72, v74, v75
  v_fma_f32 v73, v73, v74, v75
  v_cvt_pk_bf16_f32 v179, v72, v73
  ds_write_b128 v90, v[176:179] offset:14464
  v_lshlrev_b32 v70, 16, v180
  v_and_b32 v71, 0xffff0000, v180
  v_fma_f32 v70, v70, v74, v75
  v_fma_f32 v71, v71, v74, v75
  v_cvt_pk_bf16_f32 v180, v70, v71
  v_lshlrev_b32 v72, 16, v181
  v_and_b32 v73, 0xffff0000, v181
  v_fma_f32 v72, v72, v74, v75
  v_fma_f32 v73, v73, v74, v75
  v_cvt_pk_bf16_f32 v181, v72, v73
  v_lshlrev_b32 v70, 16, v182
  v_and_b32 v71, 0xffff0000, v182
  v_fma_f32 v70, v70, v74, v75
  v_fma_f32 v71, v71, v74, v75
  v_cvt_pk_bf16_f32 v182, v70, v71
  v_lshlrev_b32 v72, 16, v183
  v_and_b32 v73, 0xffff0000, v183
  v_fma_f32 v72, v72, v74, v75
  v_fma_f32 v73, v73, v74, v75
  v_cvt_pk_bf16_f32 v183, v72, v73
  ds_write_b128 v90, v[180:183] offset:16512
  v_cmp_eq_u32 vcc, 0, v106
  s_and_saveexec_b64 s[34:35], vcc
  ds_write_b64 v91, v[68:69] offset:64
  s_mov_b64 exec, s[34:35]
  s_waitcnt lgkmcnt(0)
  s_barrier
  ds_read_b128 a[216:219], v80 offset:0
  ds_read_b128 a[220:223], v80 offset:18432
  ds_read_b128 a[224:227], v82 offset:0
  ds_read_b128 a[228:231], v82 offset:18432
  ds_read_b64_tr_b16 a[176:177], v30 offset:0
  ds_read_b64_tr_b16 a[178:179], v30 offset:256
  ds_read_b64_tr_b16 a[144:145], v22 offset:0
  ds_read_b64_tr_b16 a[148:149], v23 offset:0
  ds_read_b64_tr_b16 a[152:153], v24 offset:0
  ds_read_b64_tr_b16 a[156:157], v25 offset:0
  ds_read_b64_tr_b16 a[160:161], v26 offset:0
  ds_read_b64_tr_b16 a[164:165], v27 offset:0
  ds_read_b64_tr_b16 a[168:169], v28 offset:0
  ds_read_b64_tr_b16 a[172:173], v29 offset:0
  ds_read_b64_tr_b16 a[146:147], v22 offset:1024
  ds_read_b64_tr_b16 a[150:151], v23 offset:1024
  ds_read_b64_tr_b16 a[154:155], v24 offset:1024
  ds_read_b64_tr_b16 a[158:159], v25 offset:1024
  ds_read_b64_tr_b16 a[162:163], v26 offset:1024
  ds_read_b64_tr_b16 a[166:167], v27 offset:1024
  ds_read_b64_tr_b16 a[170:171], v28 offset:1024
  ds_read_b64_tr_b16 a[174:175], v29 offset:1024
  s_waitcnt lgkmcnt(0)
  s_add_u32 s27, s29, 589824
  s_add_u32 m0, s28, 8192
  s_nop 0
  buffer_load_dwordx4 v12, s[8:11], s27 offen lds
  s_add_u32 m0, s28, 0
  s_nop 0
  buffer_load_dwordx4 v4, s[8:11], s27 offen lds
  buffer_load_dwordx4 v6, s[8:11], s27 offen offset:2048 lds
  s_add_u32 m0, s28, 4096
  s_nop 0
  buffer_load_dwordx4 v8, s[8:11], s27 offen lds
  buffer_load_dwordx4 v10, s[8:11], s27 offen offset:2048 lds
  s_add_u32 m0, s28, 0
  s_nop 0
  buffer_load_dwordx4 v5, s[8:11], s27 offen offset:1024 lds
  buffer_load_dwordx4 v7, s[8:11], s27 offen offset:3072 lds
  s_waitcnt vmcnt(14)
  v_mfma_f32_16x16x32_bf16 v[112:115], a[144:147], a[216:219], 0
  s_add_u32 m0, s28, 4096
  ds_read_b64_tr_b16 a[212:213], v30 offset:9216
  ds_read_b64_tr_b16 a[214:215], v30 offset:9472
  v_mfma_f32_16x16x32_bf16 v[116:119], a[144:147], a[220:223], 0
  buffer_load_dwordx4 v9, s[8:11], s27 offen offset:1024 lds
  v_mfma_f32_16x16x32_bf16 v[120:123], a[144:147], a[224:227], 0
  ds_read_b64_tr_b16 a[180:181], v22 offset:9216
  ds_read_b64_tr_b16 a[184:185], v23 offset:9216
  v_mfma_f32_16x16x32_bf16 v[124:127], a[144:147], a[228:231], 0
  ds_read_b64_tr_b16 a[188:189], v24 offset:9216
  ds_read_b64_tr_b16 a[192:193], v25 offset:9216
  v_mfma_f32_16x16x32_bf16 v[128:131], a[148:151], a[216:219], 0
  ds_read_b64_tr_b16 a[196:197], v26 offset:9216
  ds_read_b64_tr_b16 a[200:201], v27 offset:9216
  v_mfma_f32_16x16x32_bf16 v[132:135], a[148:151], a[220:223], 0
  buffer_load_dwordx4 v11, s[8:11], s27 offen offset:3072 lds
  v_mfma_f32_16x16x32_bf16 v[136:139], a[148:151], a[224:227], 0
  ds_read_b64_tr_b16 a[204:205], v28 offset:9216
  ds_read_b64_tr_b16 a[208:209], v29 offset:9216
  v_mfma_f32_16x16x32_bf16 v[140:143], a[148:151], a[228:231], 0
  s_waitcnt vmcnt(12)
  ds_read_b64_tr_b16 a[182:183], v22 offset:10240
  ds_read_b64_tr_b16 a[186:187], v23 offset:10240
  v_mfma_f32_16x16x32_bf16 v[144:147], a[152:155], a[216:219], 0
  ds_read_b64_tr_b16 a[190:191], v24 offset:10240
  ds_read_b64_tr_b16 a[194:195], v25 offset:10240
  s_waitcnt lgkmcnt(4)
  s_add_u32 s31, s29, 884736
  s_add_u32 m0, s28, 17408
  v_mfma_f32_16x16x32_bf16 v[148:151], a[152:155], a[220:223], 0
  buffer_load_dwordx4 v12, s[8:11], s31 offen lds
  v_mfma_f32_16x16x32_bf16 v[152:155], a[152:155], a[224:227], 0
  ds_read_b64_tr_b16 a[198:199], v26 offset:10240
  ds_read_b64_tr_b16 a[202:203], v27 offset:10240
  v_mfma_f32_16x16x32_bf16 v[156:159], a[152:155], a[228:231], 0
  ds_read_b64_tr_b16 a[206:207], v28 offset:10240
  ds_read_b64_tr_b16 a[210:211], v29 offset:10240
  v_mfma_f32_16x16x32_bf16 v[160:163], a[156:159], a[216:219], 0
  ds_read_b128 a[232:235], v81 offset:1024
  s_add_u32 m0, s28, 9216
  v_mfma_f32_16x16x32_bf16 v[164:167], a[156:159], a[220:223], 0
  buffer_load_dwordx4 v4, s[8:11], s31 offen lds
  v_mfma_f32_16x16x32_bf16 v[168:171], a[156:159], a[224:227], 0
  ds_read_b128 a[236:239], v81 offset:19456
  v_mfma_f32_16x16x32_bf16 v[172:175], a[156:159], a[228:231], 0
  ds_read_b128 a[240:243], v83 offset:1024
  v_mfma_f32_16x16x32_bf16 v[176:179], a[160:163], a[216:219], 0
  s_waitcnt lgkmcnt(3)
  ds_read_b128 a[244:247], v83 offset:19456
  v_mfma_f32_16x16x32_bf16 v[180:183], a[160:163], a[220:223], 0
  buffer_load_dwordx4 v6, s[8:11], s31 offen offset:2048 lds
  v_mfma_f32_16x16x32_bf16 v[184:187], a[160:163], a[224:227], 0
  v_mfma_f32_16x16x32_bf16 v[188:191], a[160:163], a[228:231], 0
  v_mfma_f32_16x16x32_bf16 v[192:195], a[164:167], a[216:219], 0
  s_add_u32 m0, s28, 13312
  v_mfma_f32_16x16x32_bf16 v[196:199], a[164:167], a[220:223], 0
  buffer_load_dwordx4 v8, s[8:11], s31 offen lds
  v_mfma_f32_16x16x32_bf16 v[200:203], a[164:167], a[224:227], 0
  v_mfma_f32_16x16x32_bf16 v[204:207], a[164:167], a[228:231], 0
  v_mfma_f32_16x16x32_bf16 v[208:211], a[168:171], a[216:219], 0
  v_mfma_f32_16x16x32_bf16 v[212:215], a[168:171], a[220:223], 0
  buffer_load_dwordx4 v10, s[8:11], s31 offen offset:2048 lds
  v_mfma_f32_16x16x32_bf16 v[216:219], a[168:171], a[224:227], 0
  v_mfma_f32_16x16x32_bf16 v[220:223], a[168:171], a[228:231], 0
  v_mfma_f32_16x16x32_bf16 v[224:227], a[172:175], a[216:219], 0
  s_add_u32 m0, s28, 9216
  v_mfma_f32_16x16x32_bf16 v[228:231], a[172:175], a[220:223], 0
  buffer_load_dwordx4 v5, s[8:11], s31 offen offset:1024 lds
  v_mfma_f32_16x16x32_bf16 v[232:235], a[172:175], a[224:227], 0
  v_mfma_f32_16x16x32_bf16 v[236:239], a[172:175], a[228:231], 0
  v_mfma_f32_16x16x32_bf16 v[240:243], a[176:179], a[216:219], 0
  v_mfma_f32_16x16x32_bf16 v[244:247], a[176:179], a[220:223], 0
  buffer_load_dwordx4 v7, s[8:11], s31 offen offset:3072 lds
  v_mfma_f32_16x16x32_bf16 v[248:251], a[176:179], a[224:227], 0
  v_mfma_f32_16x16x32_bf16 v[252:255], a[176:179], a[228:231], 0
  s_waitcnt lgkmcnt(0)
  s_waitcnt vmcnt(11)
  v_mfma_f32_16x16x32_bf16 v[112:115], a[180:183], a[232:235], v[112:115]
  s_add_u32 m0, s28, 13312
  ds_read_b64_tr_b16 a[176:177], v30 offset:0
  ds_read_b64_tr_b16 a[178:179], v30 offset:256
  v_mfma_f32_16x16x32_bf16 v[116:119], a[180:183], a[236:239], v[116:119]
  buffer_load_dwordx4 v9, s[8:11], s31 offen offset:1024 lds
  v_mfma_f32_16x16x32_bf16 v[120:123], a[180:183], a[240:243], v[120:123]
  ds_read_b64_tr_b16 a[144:145], v22 offset:0
  ds_read_b64_tr_b16 a[148:149], v23 offset:0
  v_mfma_f32_16x16x32_bf16 v[124:127], a[180:183], a[244:247], v[124:127]
  ds_read_b64_tr_b16 a[152:153], v24 offset:0
  ds_read_b64_tr_b16 a[156:157], v25 offset:0
  v_mfma_f32_16x16x32_bf16 v[128:131], a[184:187], a[232:235], v[128:131]
  ds_read_b64_tr_b16 a[160:161], v26 offset:0
  ds_read_b64_tr_b16 a[164:165], v27 offset:0
  v_mfma_f32_16x16x32_bf16 v[132:135], a[184:187], a[236:239], v[132:135]
  buffer_load_dwordx4 v11, s[8:11], s31 offen offset:3072 lds
  v_mfma_f32_16x16x32_bf16 v[136:139], a[184:187], a[240:243], v[136:139]
  ds_read_b64_tr_b16 a[168:169], v28 offset:0
  ds_read_b64_tr_b16 a[172:173], v29 offset:0
  v_mfma_f32_16x16x32_bf16 v[140:143], a[184:187], a[244:247], v[140:143]
  s_waitcnt vmcnt(9)
  ds_read_b64_tr_b16 a[146:147], v22 offset:1024
  ds_read_b64_tr_b16 a[150:151], v23 offset:1024
  v_mfma_f32_16x16x32_bf16 v[144:147], a[188:191], a[232:235], v[144:147]
  ds_read_b64_tr_b16 a[154:155], v24 offset:1024
  ds_read_b64_tr_b16 a[158:159], v25 offset:1024
  s_waitcnt lgkmcnt(4)
  s_add_u32 s27, s29, 1179648
  s_add_u32 m0, s28, 8192
  v_mfma_f32_16x16x32_bf16 v[148:151], a[188:191], a[236:239], v[148:151]
  buffer_load_dwordx4 v12, s[8:11], s27 offen lds
  v_mfma_f32_16x16x32_bf16 v[152:155], a[188:191], a[240:243], v[152:155]
  ds_read_b64_tr_b16 a[162:163], v26 offset:1024
  ds_read_b64_tr_b16 a[166:167], v27 offset:1024
  v_mfma_f32_16x16x32_bf16 v[156:159], a[188:191], a[244:247], v[156:159]
  ds_read_b64_tr_b16 a[170:171], v28 offset:1024
  ds_read_b64_tr_b16 a[174:175], v29 offset:1024
  v_mfma_f32_16x16x32_bf16 v[160:163], a[192:195], a[232:235], v[160:163]
  ds_read_b128 a[216:219], v80 offset:2048
  s_add_u32 m0, s28, 0
  v_mfma_f32_16x16x32_bf16 v[164:167], a[192:195], a[236:239], v[164:167]
  buffer_load_dwordx4 v4, s[8:11], s27 offen lds
  v_mfma_f32_16x16x32_bf16 v[168:171], a[192:195], a[240:243], v[168:171]
  ds_read_b128 a[220:223], v80 offset:20480
  v_mfma_f32_16x16x32_bf16 v[172:175], a[192:195], a[244:247], v[172:175]
  ds_read_b128 a[224:227], v82 offset:2048
  v_mfma_f32_16x16x32_bf16 v[176:179], a[196:199], a[232:235], v[176:179]
  s_waitcnt lgkmcnt(3)
  ds_read_b128 a[228:231], v82 offset:20480
  v_mfma_f32_16x16x32_bf16 v[180:183], a[196:199], a[236:239], v[180:183]
  buffer_load_dwordx4 v6, s[8:11], s27 offen offset:2048 lds
  v_mfma_f32_16x16x32_bf16 v[184:187], a[196:199], a[240:243], v[184:187]
  v_mfma_f32_16x16x32_bf16 v[188:191], a[196:199], a[244:247], v[188:191]
  v_mfma_f32_16x16x32_bf16 v[192:195], a[200:203], a[232:235], v[192:195]
  s_add_u32 m0, s28, 4096
  v_mfma_f32_16x16x32_bf16 v[196:199], a[200:203], a[236:239], v[196:199]
  buffer_load_dwordx4 v8, s[8:11], s27 offen lds
  v_mfma_f32_16x16x32_bf16 v[200:203], a[200:203], a[240:243], v[200:203]
  v_mfma_f32_16x16x32_bf16 v[204:207], a[200:203], a[244:247], v[204:207]
  v_mfma_f32_16x16x32_bf16 v[208:211], a[204:207], a[232:235], v[208:211]
  v_mfma_f32_16x16x32_bf16 v[212:215], a[204:207], a[236:239], v[212:215]
  buffer_load_dwordx4 v10, s[8:11], s27 offen offset:2048 lds
  v_mfma_f32_16x16x32_bf16 v[216:219], a[204:207], a[240:243], v[216:219]
  v_mfma_f32_16x16x32_bf16 v[220:223], a[204:207], a[244:247], v[220:223]
  v_mfma_f32_16x16x32_bf16 v[224:227], a[208:211], a[232:235], v[224:227]
  s_add_u32 m0, s28, 0
  v_mfma_f32_16x16x32_bf16 v[228:231], a[208:211], a[236:239], v[228:231]
  buffer_load_dwordx4 v5, s[8:11], s27 offen offset:1024 lds
  v_mfma_f32_16x16x32_bf16 v[232:235], a[208:211], a[240:243], v[232:235]
  v_mfma_f32_16x16x32_bf16 v[236:239], a[208:211], a[244:247], v[236:239]
  v_mfma_f32_16x16x32_bf16 v[240:243], a[212:215], a[232:235], v[240:243]
  v_mfma_f32_16x16x32_bf16 v[244:247], a[212:215], a[236:239], v[244:247]
  buffer_load_dwordx4 v7, s[8:11], s27 offen offset:3072 lds
  v_mfma_f32_16x16x32_bf16 v[248:251], a[212:215], a[240:243], v[248:251]
  v_mfma_f32_16x16x32_bf16 v[252:255], a[212:215], a[244:247], v[252:255]
  s_waitcnt lgkmcnt(0)
  s_waitcnt vmcnt(11)
  v_mfma_f32_16x16x32_bf16 v[112:115], a[144:147], a[216:219], v[112:115]
  s_add_u32 m0, s28, 4096
  ds_read_b64_tr_b16 a[212:213], v30 offset:9216
  ds_read_b64_tr_b16 a[214:215], v30 offset:9472
  v_mfma_f32_16x16x32_bf16 v[116:119], a[144:147], a[220:223], v[116:119]
  buffer_load_dwordx4 v9, s[8:11], s27 offen offset:1024 lds
  v_mfma_f32_16x16x32_bf16 v[120:123], a[144:147], a[224:227], v[120:123]
  ds_read_b64_tr_b16 a[180:181], v22 offset:9216
  ds_read_b64_tr_b16 a[184:185], v23 offset:9216
  v_mfma_f32_16x16x32_bf16 v[124:127], a[144:147], a[228:231], v[124:127]
  ds_read_b64_tr_b16 a[188:189], v24 offset:9216
  ds_read_b64_tr_b16 a[192:193], v25 offset:9216
  v_mfma_f32_16x16x32_bf16 v[128:131], a[148:151], a[216:219], v[128:131]
  ds_read_b64_tr_b16 a[196:197], v26 offset:9216
  ds_read_b64_tr_b16 a[200:201], v27 offset:9216
  v_mfma_f32_16x16x32_bf16 v[132:135], a[148:151], a[220:223], v[132:135]
  buffer_load_dwordx4 v11, s[8:11], s27 offen offset:3072 lds
  v_mfma_f32_16x16x32_bf16 v[136:139], a[148:151], a[224:227], v[136:139]
  ds_read_b64_tr_b16 a[204:205], v28 offset:9216
  ds_read_b64_tr_b16 a[208:209], v29 offset:9216
  v_mfma_f32_16x16x32_bf16 v[140:143], a[148:151], a[228:231], v[140:143]
  s_waitcnt vmcnt(9)
  ds_read_b64_tr_b16 a[182:183], v22 offset:10240
  ds_read_b64_tr_b16 a[186:187], v23 offset:10240
  v_mfma_f32_16x16x32_bf16 v[144:147], a[152:155], a[216:219], v[144:147]
  ds_read_b64_tr_b16 a[190:191], v24 offset:10240
  ds_read_b64_tr_b16 a[194:195], v25 offset:10240
  s_waitcnt lgkmcnt(4)
  s_add_u32 s31, s29, 1474560
  s_add_u32 m0, s28, 17408
  v_mfma_f32_16x16x32_bf16 v[148:151], a[152:155], a[220:223], v[148:151]
  buffer_load_dwordx4 v12, s[8:11], s31 offen lds
  v_mfma_f32_16x16x32_bf16 v[152:155], a[152:155], a[224:227], v[152:155]
  ds_read_b64_tr_b16 a[198:199], v26 offset:10240
  ds_read_b64_tr_b16 a[202:203], v27 offset:10240
  v_mfma_f32_16x16x32_bf16 v[156:159], a[152:155], a[228:231], v[156:159]
  ds_read_b64_tr_b16 a[206:207], v28 offset:10240
  ds_read_b64_tr_b16 a[210:211], v29 offset:10240
  v_mfma_f32_16x16x32_bf16 v[160:163], a[156:159], a[216:219], v[160:163]
  ds_read_b128 a[232:235], v81 offset:3072
  s_add_u32 m0, s28, 9216
  v_mfma_f32_16x16x32_bf16 v[164:167], a[156:159], a[220:223], v[164:167]
  buffer_load_dwordx4 v4, s[8:11], s31 offen lds
  v_mfma_f32_16x16x32_bf16 v[168:171], a[156:159], a[224:227], v[168:171]
  ds_read_b128 a[236:239], v81 offset:21504
  v_mfma_f32_16x16x32_bf16 v[172:175], a[156:159], a[228:231], v[172:175]
  ds_read_b128 a[240:243], v83 offset:3072
  v_mfma_f32_16x16x32_bf16 v[176:179], a[160:163], a[216:219], v[176:179]
  s_waitcnt lgkmcnt(3)
  ds_read_b128 a[244:247], v83 offset:21504
  v_mfma_f32_16x16x32_bf16 v[180:183], a[160:163], a[220:223], v[180:183]
  buffer_load_dwordx4 v6, s[8:11], s31 offen offset:2048 lds
  v_mfma_f32_16x16x32_bf16 v[184:187], a[160:163], a[224:227], v[184:187]
  v_mfma_f32_16x16x32_bf16 v[188:191], a[160:163], a[228:231], v[188:191]
  v_mfma_f32_16x16x32_bf16 v[192:195], a[164:167], a[216:219], v[192:195]
  s_add_u32 m0, s28, 13312
  v_mfma_f32_16x16x32_bf16 v[196:199], a[164:167], a[220:223], v[196:199]
  buffer_load_dwordx4 v8, s[8:11], s31 offen lds
  v_mfma_f32_16x16x32_bf16 v[200:203], a[164:167], a[224:227], v[200:203]
  v_mfma_f32_16x16x32_bf16 v[204:207], a[164:167], a[228:231], v[204:207]
  v_mfma_f32_16x16x32_bf16 v[208:211], a[168:171], a[216:219], v[208:211]
  v_mfma_f32_16x16x32_bf16 v[212:215], a[168:171], a[220:223], v[212:215]
  buffer_load_dwordx4 v10, s[8:11], s31 offen offset:2048 lds
  v_mfma_f32_16x16x32_bf16 v[216:219], a[168:171], a[224:227], v[216:219]
  v_mfma_f32_16x16x32_bf16 v[220:223], a[168:171], a[228:231], v[220:223]
  v_mfma_f32_16x16x32_bf16 v[224:227], a[172:175], a[216:219], v[224:227]
  s_add_u32 m0, s28, 9216
  v_mfma_f32_16x16x32_bf16 v[228:231], a[172:175], a[220:223], v[228:231]
  buffer_load_dwordx4 v5, s[8:11], s31 offen offset:1024 lds
  v_mfma_f32_16x16x32_bf16 v[232:235], a[172:175], a[224:227], v[232:235]
  v_mfma_f32_16x16x32_bf16 v[236:239], a[172:175], a[228:231], v[236:239]
  v_mfma_f32_16x16x32_bf16 v[240:243], a[176:179], a[216:219], v[240:243]
  v_mfma_f32_16x16x32_bf16 v[244:247], a[176:179], a[220:223], v[244:247]
  buffer_load_dwordx4 v7, s[8:11], s31 offen offset:3072 lds
  v_mfma_f32_16x16x32_bf16 v[248:251], a[176:179], a[224:227], v[248:251]
  v_mfma_f32_16x16x32_bf16 v[252:255], a[176:179], a[228:231], v[252:255]
  s_waitcnt lgkmcnt(0)
  s_waitcnt vmcnt(11)
  v_mfma_f32_16x16x32_bf16 v[112:115], a[180:183], a[232:235], v[112:115]
  s_add_u32 m0, s28, 13312
  ds_read_b64_tr_b16 a[176:177], v30 offset:0
  ds_read_b64_tr_b16 a[178:179], v30 offset:256
  v_mfma_f32_16x16x32_bf16 v[116:119], a[180:183], a[236:239], v[116:119]
  buffer_load_dwordx4 v9, s[8:11], s31 offen offset:1024 lds
  v_mfma_f32_16x16x32_bf16 v[120:123], a[180:183], a[240:243], v[120:123]
  ds_read_b64_tr_b16 a[144:145], v22 offset:0
  ds_read_b64_tr_b16 a[148:149], v23 offset:0
  v_mfma_f32_16x16x32_bf16 v[124:127], a[180:183], a[244:247], v[124:127]
  ds_read_b64_tr_b16 a[152:153], v24 offset:0
  ds_read_b64_tr_b16 a[156:157], v25 offset:0
  v_mfma_f32_16x16x32_bf16 v[128:131], a[184:187], a[232:235], v[128:131]
  ds_read_b64_tr_b16 a[160:161], v26 offset:0
  ds_read_b64_tr_b16 a[164:165], v27 offset:0
  v_mfma_f32_16x16x32_bf16 v[132:135], a[184:187], a[236:239], v[132:135]
  buffer_load_dwordx4 v11, s[8:11], s31 offen offset:3072 lds
  v_mfma_f32_16x16x32_bf16 v[136:139], a[184:187], a[240:243], v[136:139]
  ds_read_b64_tr_b16 a[168:169], v28 offset:0
  ds_read_b64_tr_b16 a[172:173], v29 offset:0
  v_mfma_f32_16x16x32_bf16 v[140:143], a[184:187], a[244:247], v[140:143]
  s_waitcnt vmcnt(9)
  ds_read_b64_tr_b16 a[146:147], v22 offset:1024
  ds_read_b64_tr_b16 a[150:151], v23 offset:1024
  v_mfma_f32_16x16x32_bf16 v[144:147], a[188:191], a[232:235], v[144:147]
  ds_read_b64_tr_b16 a[154:155], v24 offset:1024
  ds_read_b64_tr_b16 a[158:159], v25 offset:1024
  s_waitcnt lgkmcnt(4)
  s_add_u32 s27, s29, 1769472
  s_add_u32 m0, s28, 8192
  v_mfma_f32_16x16x32_bf16 v[148:151], a[188:191], a[236:239], v[148:151]
  buffer_load_dwordx4 v12, s[8:11], s27 offen lds
  v_mfma_f32_16x16x32_bf16 v[152:155], a[188:191], a[240:243], v[152:155]
  ds_read_b64_tr_b16 a[162:163], v26 offset:1024
  ds_read_b64_tr_b16 a[166:167], v27 offset:1024
  v_mfma_f32_16x16x32_bf16 v[156:159], a[188:191], a[244:247], v[156:159]
  ds_read_b64_tr_b16 a[170:171], v28 offset:1024
  ds_read_b64_tr_b16 a[174:175], v29 offset:1024
  v_mfma_f32_16x16x32_bf16 v[160:163], a[192:195], a[232:235], v[160:163]
  ds_read_b128 a[216:219], v80 offset:4096
  s_add_u32 m0, s28, 0
  v_mfma_f32_16x16x32_bf16 v[164:167], a[192:195], a[236:239], v[164:167]
  buffer_load_dwordx4 v4, s[8:11], s27 offen lds
  v_mfma_f32_16x16x32_bf16 v[168:171], a[192:195], a[240:243], v[168:171]
  ds_read_b128 a[220:223], v80 offset:22528
  v_mfma_f32_16x16x32_bf16 v[172:175], a[192:195], a[244:247], v[172:175]
  ds_read_b128 a[224:227], v82 offset:4096
  v_mfma_f32_16x16x32_bf16 v[176:179], a[196:199], a[232:235], v[176:179]
  s_waitcnt lgkmcnt(3)
  ds_read_b128 a[228:231], v82 offset:22528
  v_mfma_f32_16x16x32_bf16 v[180:183], a[196:199], a[236:239], v[180:183]
  buffer_load_dwordx4 v6, s[8:11], s27 offen offset:2048 lds
  v_mfma_f32_16x16x32_bf16 v[184:187], a[196:199], a[240:243], v[184:187]
  v_mfma_f32_16x16x32_bf16 v[188:191], a[196:199], a[244:247], v[188:191]
  v_mfma_f32_16x16x32_bf16 v[192:195], a[200:203], a[232:235], v[192:195]
  s_add_u32 m0, s28, 4096
  v_mfma_f32_16x16x32_bf16 v[196:199], a[200:203], a[236:239], v[196:199]
  buffer_load_dwordx4 v8, s[8:11], s27 offen lds
  v_mfma_f32_16x16x32_bf16 v[200:203], a[200:203], a[240:243], v[200:203]
  v_mfma_f32_16x16x32_bf16 v[204:207], a[200:203], a[244:247], v[204:207]
  v_mfma_f32_16x16x32_bf16 v[208:211], a[204:207], a[232:235], v[208:211]
  v_mfma_f32_16x16x32_bf16 v[212:215], a[204:207], a[236:239], v[212:215]
  buffer_load_dwordx4 v10, s[8:11], s27 offen offset:2048 lds
  v_mfma_f32_16x16x32_bf16 v[216:219], a[204:207], a[240:243], v[216:219]
  v_mfma_f32_16x16x32_bf16 v[220:223], a[204:207], a[244:247], v[220:223]
  v_mfma_f32_16x16x32_bf16 v[224:227], a[208:211], a[232:235], v[224:227]
  s_add_u32 m0, s28, 0
  v_mfma_f32_16x16x32_bf16 v[228:231], a[208:211], a[236:239], v[228:231]
  buffer_load_dwordx4 v5, s[8:11], s27 offen offset:1024 lds
  v_mfma_f32_16x16x32_bf16 v[232:235], a[208:211], a[240:243], v[232:235]
  v_mfma_f32_16x16x32_bf16 v[236:239], a[208:211], a[244:247], v[236:239]
  v_mfma_f32_16x16x32_bf16 v[240:243], a[212:215], a[232:235], v[240:243]
  v_mfma_f32_16x16x32_bf16 v[244:247], a[212:215], a[236:239], v[244:247]
  buffer_load_dwordx4 v7, s[8:11], s27 offen offset:3072 lds
  v_mfma_f32_16x16x32_bf16 v[248:251], a[212:215], a[240:243], v[248:251]
  v_mfma_f32_16x16x32_bf16 v[252:255], a[212:215], a[244:247], v[252:255]
  s_waitcnt lgkmcnt(0)
  s_waitcnt vmcnt(11)
  v_mfma_f32_16x16x32_bf16 v[112:115], a[144:147], a[216:219], v[112:115]
  s_add_u32 m0, s28, 4096
  ds_read_b64_tr_b16 a[212:213], v30 offset:9216
  ds_read_b64_tr_b16 a[214:215], v30 offset:9472
  v_mfma_f32_16x16x32_bf16 v[116:119], a[144:147], a[220:223], v[116:119]
  buffer_load_dwordx4 v9, s[8:11], s27 offen offset:1024 lds
  v_mfma_f32_16x16x32_bf16 v[120:123], a[144:147], a[224:227], v[120:123]
  ds_read_b64_tr_b16 a[180:181], v22 offset:9216
  ds_read_b64_tr_b16 a[184:185], v23 offset:9216
  v_mfma_f32_16x16x32_bf16 v[124:127], a[144:147], a[228:231], v[124:127]
  ds_read_b64_tr_b16 a[188:189], v24 offset:9216
  ds_read_b64_tr_b16 a[192:193], v25 offset:9216
  v_mfma_f32_16x16x32_bf16 v[128:131], a[148:151], a[216:219], v[128:131]
  ds_read_b64_tr_b16 a[196:197], v26 offset:9216
  ds_read_b64_tr_b16 a[200:201], v27 offset:9216
  v_mfma_f32_16x16x32_bf16 v[132:135], a[148:151], a[220:223], v[132:135]
  buffer_load_dwordx4 v11, s[8:11], s27 offen offset:3072 lds
  v_mfma_f32_16x16x32_bf16 v[136:139], a[148:151], a[224:227], v[136:139]
  ds_read_b64_tr_b16 a[204:205], v28 offset:9216
  ds_read_b64_tr_b16 a[208:209], v29 offset:9216
  v_mfma_f32_16x16x32_bf16 v[140:143], a[148:151], a[228:231], v[140:143]
  s_waitcnt vmcnt(9)
  ds_read_b64_tr_b16 a[182:183], v22 offset:10240
  ds_read_b64_tr_b16 a[186:187], v23 offset:10240
  v_mfma_f32_16x16x32_bf16 v[144:147], a[152:155], a[216:219], v[144:147]
  ds_read_b64_tr_b16 a[190:191], v24 offset:10240
  ds_read_b64_tr_b16 a[194:195], v25 offset:10240
  s_waitcnt lgkmcnt(4)
  s_add_u32 s31, s29, 2064384
  s_add_u32 m0, s28, 17408
  v_mfma_f32_16x16x32_bf16 v[148:151], a[152:155], a[220:223], v[148:151]
  buffer_load_dwordx4 v12, s[8:11], s31 offen lds
  v_mfma_f32_16x16x32_bf16 v[152:155], a[152:155], a[224:227], v[152:155]
  ds_read_b64_tr_b16 a[198:199], v26 offset:10240
  ds_read_b64_tr_b16 a[202:203], v27 offset:10240
  v_mfma_f32_16x16x32_bf16 v[156:159], a[152:155], a[228:231], v[156:159]
  ds_read_b64_tr_b16 a[206:207], v28 offset:10240
  ds_read_b64_tr_b16 a[210:211], v29 offset:10240
  v_mfma_f32_16x16x32_bf16 v[160:163], a[156:159], a[216:219], v[160:163]
  ds_read_b128 a[232:235], v81 offset:5120
  s_add_u32 m0, s28, 9216
  v_mfma_f32_16x16x32_bf16 v[164:167], a[156:159], a[220:223], v[164:167]
  buffer_load_dwordx4 v4, s[8:11], s31 offen lds
  v_mfma_f32_16x16x32_bf16 v[168:171], a[156:159], a[224:227], v[168:171]
  ds_read_b128 a[236:239], v81 offset:23552
  v_mfma_f32_16x16x32_bf16 v[172:175], a[156:159], a[228:231], v[172:175]
  ds_read_b128 a[240:243], v83 offset:5120
  v_mfma_f32_16x16x32_bf16 v[176:179], a[160:163], a[216:219], v[176:179]
  s_waitcnt lgkmcnt(3)
  ds_read_b128 a[244:247], v83 offset:23552
  v_mfma_f32_16x16x32_bf16 v[180:183], a[160:163], a[220:223], v[180:183]
  buffer_load_dwordx4 v6, s[8:11], s31 offen offset:2048 lds
  v_mfma_f32_16x16x32_bf16 v[184:187], a[160:163], a[224:227], v[184:187]
  v_mfma_f32_16x16x32_bf16 v[188:191], a[160:163], a[228:231], v[188:191]
  v_mfma_f32_16x16x32_bf16 v[192:195], a[164:167], a[216:219], v[192:195]
  s_add_u32 m0, s28, 13312
  v_mfma_f32_16x16x32_bf16 v[196:199], a[164:167], a[220:223], v[196:199]
  buffer_load_dwordx4 v8, s[8:11], s31 offen lds
  v_mfma_f32_16x16x32_bf16 v[200:203], a[164:167], a[224:227], v[200:203]
  v_mfma_f32_16x16x32_bf16 v[204:207], a[164:167], a[228:231], v[204:207]
  v_mfma_f32_16x16x32_bf16 v[208:211], a[168:171], a[216:219], v[208:211]
  v_mfma_f32_16x16x32_bf16 v[212:215], a[168:171], a[220:223], v[212:215]
  buffer_load_dwordx4 v10, s[8:11], s31 offen offset:2048 lds
  v_mfma_f32_16x16x32_bf16 v[216:219], a[168:171], a[224:227], v[216:219]
  v_mfma_f32_16x16x32_bf16 v[220:223], a[168:171], a[228:231], v[220:223]
  v_mfma_f32_16x16x32_bf16 v[224:227], a[172:175], a[216:219], v[224:227]
  s_add_u32 m0, s28, 9216
  v_mfma_f32_16x16x32_bf16 v[228:231], a[172:175], a[220:223], v[228:231]
  buffer_load_dwordx4 v5, s[8:11], s31 offen offset:1024 lds
  v_mfma_f32_16x16x32_bf16 v[232:235], a[172:175], a[224:227], v[232:235]
  v_mfma_f32_16x16x32_bf16 v[236:239], a[172:175], a[228:231], v[236:239]
  v_mfma_f32_16x16x32_bf16 v[240:243], a[176:179], a[216:219], v[240:243]
  v_mfma_f32_16x16x32_bf16 v[244:247], a[176:179], a[220:223], v[244:247]
  buffer_load_dwordx4 v7, s[8:11], s31 offen offset:3072 lds
  v_mfma_f32_16x16x32_bf16 v[248:251], a[176:179], a[224:227], v[248:251]
  v_mfma_f32_16x16x32_bf16 v[252:255], a[176:179], a[228:231], v[252:255]
  s_waitcnt lgkmcnt(0)
  s_waitcnt vmcnt(11)
  v_mfma_f32_16x16x32_bf16 v[112:115], a[180:183], a[232:235], v[112:115]
  s_add_u32 m0, s28, 13312
  ds_read_b64_tr_b16 a[176:177], v30 offset:0
  ds_read_b64_tr_b16 a[178:179], v30 offset:256
  v_mfma_f32_16x16x32_bf16 v[116:119], a[180:183], a[236:239], v[116:119]
  buffer_load_dwordx4 v9, s[8:11], s31 offen offset:1024 lds
  v_mfma_f32_16x16x32_bf16 v[120:123], a[180:183], a[240:243], v[120:123]
  ds_read_b64_tr_b16 a[144:145], v22 offset:0
  ds_read_b64_tr_b16 a[148:149], v23 offset:0
  v_mfma_f32_16x16x32_bf16 v[124:127], a[180:183], a[244:247], v[124:127]
  ds_read_b64_tr_b16 a[152:153], v24 offset:0
  ds_read_b64_tr_b16 a[156:157], v25 offset:0
  v_mfma_f32_16x16x32_bf16 v[128:131], a[184:187], a[232:235], v[128:131]
  ds_read_b64_tr_b16 a[160:161], v26 offset:0
  ds_read_b64_tr_b16 a[164:165], v27 offset:0
  v_mfma_f32_16x16x32_bf16 v[132:135], a[184:187], a[236:239], v[132:135]
  buffer_load_dwordx4 v11, s[8:11], s31 offen offset:3072 lds
  v_mfma_f32_16x16x32_bf16 v[136:139], a[184:187], a[240:243], v[136:139]
  ds_read_b64_tr_b16 a[168:169], v28 offset:0
  ds_read_b64_tr_b16 a[172:173], v29 offset:0
  v_mfma_f32_16x16x32_bf16 v[140:143], a[184:187], a[244:247], v[140:143]
  s_waitcnt vmcnt(9)
  ds_read_b64_tr_b16 a[146:147], v22 offset:1024
  ds_read_b64_tr_b16 a[150:151], v23 offset:1024
  v_mfma_f32_16x16x32_bf16 v[144:147], a[188:191], a[232:235], v[144:147]
  ds_read_b64_tr_b16 a[154:155], v24 offset:1024
  ds_read_b64_tr_b16 a[158:159], v25 offset:1024
  s_waitcnt lgkmcnt(4)
  s_add_u32 s27, s29, 2359296
  s_add_u32 m0, s28, 8192
  v_mfma_f32_16x16x32_bf16 v[148:151], a[188:191], a[236:239], v[148:151]
  buffer_load_dwordx4 v12, s[8:11], s27 offen lds
  v_mfma_f32_16x16x32_bf16 v[152:155], a[188:191], a[240:243], v[152:155]
  ds_read_b64_tr_b16 a[162:163], v26 offset:1024
  ds_read_b64_tr_b16 a[166:167], v27 offset:1024
  v_mfma_f32_16x16x32_bf16 v[156:159], a[188:191], a[244:247], v[156:159]
  ds_read_b64_tr_b16 a[170:171], v28 offset:1024
  ds_read_b64_tr_b16 a[174:175], v29 offset:1024
  v_mfma_f32_16x16x32_bf16 v[160:163], a[192:195], a[232:235], v[160:163]
  ds_read_b128 a[216:219], v80 offset:6144
  s_add_u32 m0, s28, 0
  v_mfma_f32_16x16x32_bf16 v[164:167], a[192:195], a[236:239], v[164:167]
  buffer_load_dwordx4 v4, s[8:11], s27 offen lds
  v_mfma_f32_16x16x32_bf16 v[168:171], a[192:195], a[240:243], v[168:171]
  ds_read_b128 a[220:223], v80 offset:24576
  v_mfma_f32_16x16x32_bf16 v[172:175], a[192:195], a[244:247], v[172:175]
  ds_read_b128 a[224:227], v82 offset:6144
  v_mfma_f32_16x16x32_bf16 v[176:179], a[196:199], a[232:235], v[176:179]
  s_waitcnt lgkmcnt(3)
  ds_read_b128 a[228:231], v82 offset:24576
  v_mfma_f32_16x16x32_bf16 v[180:183], a[196:199], a[236:239], v[180:183]
  buffer_load_dwordx4 v6, s[8:11], s27 offen offset:2048 lds
  v_mfma_f32_16x16x32_bf16 v[184:187], a[196:199], a[240:243], v[184:187]
  v_mfma_f32_16x16x32_bf16 v[188:191], a[196:199], a[244:247], v[188:191]
  v_mfma_f32_16x16x32_bf16 v[192:195], a[200:203], a[232:235], v[192:195]
  s_add_u32 m0, s28, 4096
  v_mfma_f32_16x16x32_bf16 v[196:199], a[200:203], a[236:239], v[196:199]
  buffer_load_dwordx4 v8, s[8:11], s27 offen lds
  v_mfma_f32_16x16x32_bf16 v[200:203], a[200:203], a[240:243], v[200:203]
  v_mfma_f32_16x16x32_bf16 v[204:207], a[200:203], a[244:247], v[204:207]
  v_mfma_f32_16x16x32_bf16 v[208:211], a[204:207], a[232:235], v[208:211]
  v_mfma_f32_16x16x32_bf16 v[212:215], a[204:207], a[236:239], v[212:215]
  buffer_load_dwordx4 v10, s[8:11], s27 offen offset:2048 lds
  v_mfma_f32_16x16x32_bf16 v[216:219], a[204:207], a[240:243], v[216:219]
  v_mfma_f32_16x16x32_bf16 v[220:223], a[204:207], a[244:247], v[220:223]
  v_mfma_f32_16x16x32_bf16 v[224:227], a[208:211], a[232:235], v[224:227]
  s_add_u32 m0, s28, 0
  v_mfma_f32_16x16x32_bf16 v[228:231], a[208:211], a[236:239], v[228:231]
  buffer_load_dwordx4 v5, s[8:11], s27 offen offset:1024 lds
  v_mfma_f32_16x16x32_bf16 v[232:235], a[208:211], a[240:243], v[232:235]
  v_mfma_f32_16x16x32_bf16 v[236:239], a[208:211], a[244:247], v[236:239]
  v_mfma_f32_16x16x32_bf16 v[240:243], a[212:215], a[232:235], v[240:243]
  v_mfma_f32_16x16x32_bf16 v[244:247], a[212:215], a[236:239], v[244:247]
  buffer_load_dwordx4 v7, s[8:11], s27 offen offset:3072 lds
  v_mfma_f32_16x16x32_bf16 v[248:251], a[212:215], a[240:243], v[248:251]
  v_mfma_f32_16x16x32_bf16 v[252:255], a[212:215], a[244:247], v[252:255]
  s_waitcnt lgkmcnt(0)
  s_waitcnt vmcnt(11)
  v_mfma_f32_16x16x32_bf16 v[112:115], a[144:147], a[216:219], v[112:115]
  s_add_u32 m0, s28, 4096
  ds_read_b64_tr_b16 a[212:213], v30 offset:9216
  ds_read_b64_tr_b16 a[214:215], v30 offset:9472
  v_mfma_f32_16x16x32_bf16 v[116:119], a[144:147], a[220:223], v[116:119]
  buffer_load_dwordx4 v9, s[8:11], s27 offen offset:1024 lds
  v_mfma_f32_16x16x32_bf16 v[120:123], a[144:147], a[224:227], v[120:123]
  ds_read_b64_tr_b16 a[180:181], v22 offset:9216
  ds_read_b64_tr_b16 a[184:185], v23 offset:9216
  v_mfma_f32_16x16x32_bf16 v[124:127], a[144:147], a[228:231], v[124:127]
  ds_read_b64_tr_b16 a[188:189], v24 offset:9216
  ds_read_b64_tr_b16 a[192:193], v25 offset:9216
  v_mfma_f32_16x16x32_bf16 v[128:131], a[148:151], a[216:219], v[128:131]
  ds_read_b64_tr_b16 a[196:197], v26 offset:9216
  ds_read_b64_tr_b16 a[200:201], v27 offset:9216
  v_mfma_f32_16x16x32_bf16 v[132:135], a[148:151], a[220:223], v[132:135]
  buffer_load_dwordx4 v11, s[8:11], s27 offen offset:3072 lds
  v_mfma_f32_16x16x32_bf16 v[136:139], a[148:151], a[224:227], v[136:139]
  ds_read_b64_tr_b16 a[204:205], v28 offset:9216
  ds_read_b64_tr_b16 a[208:209], v29 offset:9216
  v_mfma_f32_16x16x32_bf16 v[140:143], a[148:151], a[228:231], v[140:143]
  s_waitcnt vmcnt(9)
  ds_read_b64_tr_b16 a[182:183], v22 offset:10240
  ds_read_b64_tr_b16 a[186:187], v23 offset:10240
  v_mfma_f32_16x16x32_bf16 v[144:147], a[152:155], a[216:219], v[144:147]
  ds_read_b64_tr_b16 a[190:191], v24 offset:10240
  ds_read_b64_tr_b16 a[194:195], v25 offset:10240
  s_waitcnt lgkmcnt(4)
  s_add_u32 s31, s29, 2654208
  s_add_u32 m0, s28, 17408
  v_mfma_f32_16x16x32_bf16 v[148:151], a[152:155], a[220:223], v[148:151]
  buffer_load_dwordx4 v12, s[8:11], s31 offen lds
  v_mfma_f32_16x16x32_bf16 v[152:155], a[152:155], a[224:227], v[152:155]
  ds_read_b64_tr_b16 a[198:199], v26 offset:10240
  ds_read_b64_tr_b16 a[202:203], v27 offset:10240
  v_mfma_f32_16x16x32_bf16 v[156:159], a[152:155], a[228:231], v[156:159]
  ds_read_b64_tr_b16 a[206:207], v28 offset:10240
  ds_read_b64_tr_b16 a[210:211], v29 offset:10240
  v_mfma_f32_16x16x32_bf16 v[160:163], a[156:159], a[216:219], v[160:163]
  ds_read_b128 a[232:235], v81 offset:7168
  s_add_u32 m0, s28, 9216
  v_mfma_f32_16x16x32_bf16 v[164:167], a[156:159], a[220:223], v[164:167]
  buffer_load_dwordx4 v4, s[8:11], s31 offen lds
  v_mfma_f32_16x16x32_bf16 v[168:171], a[156:159], a[224:227], v[168:171]
  ds_read_b128 a[236:239], v81 offset:25600
  v_mfma_f32_16x16x32_bf16 v[172:175], a[156:159], a[228:231], v[172:175]
  ds_read_b128 a[240:243], v83 offset:7168
  v_mfma_f32_16x16x32_bf16 v[176:179], a[160:163], a[216:219], v[176:179]
  s_waitcnt lgkmcnt(3)
  ds_read_b128 a[244:247], v83 offset:25600
  v_mfma_f32_16x16x32_bf16 v[180:183], a[160:163], a[220:223], v[180:183]
  buffer_load_dwordx4 v6, s[8:11], s31 offen offset:2048 lds
  v_mfma_f32_16x16x32_bf16 v[184:187], a[160:163], a[224:227], v[184:187]
  v_mfma_f32_16x16x32_bf16 v[188:191], a[160:163], a[228:231], v[188:191]
  v_mfma_f32_16x16x32_bf16 v[192:195], a[164:167], a[216:219], v[192:195]
  s_add_u32 m0, s28, 13312
  v_mfma_f32_16x16x32_bf16 v[196:199], a[164:167], a[220:223], v[196:199]
  buffer_load_dwordx4 v8, s[8:11], s31 offen lds
  v_mfma_f32_16x16x32_bf16 v[200:203], a[164:167], a[224:227], v[200:203]
  v_mfma_f32_16x16x32_bf16 v[204:207], a[164:167], a[228:231], v[204:207]
  v_mfma_f32_16x16x32_bf16 v[208:211], a[168:171], a[216:219], v[208:211]
  v_mfma_f32_16x16x32_bf16 v[212:215], a[168:171], a[220:223], v[212:215]
  buffer_load_dwordx4 v10, s[8:11], s31 offen offset:2048 lds
  v_mfma_f32_16x16x32_bf16 v[216:219], a[168:171], a[224:227], v[216:219]
  v_mfma_f32_16x16x32_bf16 v[220:223], a[168:171], a[228:231], v[220:223]
  v_mfma_f32_16x16x32_bf16 v[224:227], a[172:175], a[216:219], v[224:227]
  s_add_u32 m0, s28, 9216
  v_mfma_f32_16x16x32_bf16 v[228:231], a[172:175], a[220:223], v[228:231]
  buffer_load_dwordx4 v5, s[8:11], s31 offen offset:1024 lds
  v_mfma_f32_16x16x32_bf16 v[232:235], a[172:175], a[224:227], v[232:235]
  v_mfma_f32_16x16x32_bf16 v[236:239], a[172:175], a[228:231], v[236:239]
  v_mfma_f32_16x16x32_bf16 v[240:243], a[176:179], a[216:219], v[240:243]
  v_mfma_f32_16x16x32_bf16 v[244:247], a[176:179], a[220:223], v[244:247]
  buffer_load_dwordx4 v7, s[8:11], s31 offen offset:3072 lds
  v_mfma_f32_16x16x32_bf16 v[248:251], a[176:179], a[224:227], v[248:251]
  v_mfma_f32_16x16x32_bf16 v[252:255], a[176:179], a[228:231], v[252:255]
  s_waitcnt lgkmcnt(0)
  s_waitcnt vmcnt(11)
  v_mfma_f32_16x16x32_bf16 v[112:115], a[180:183], a[232:235], v[112:115]
  s_add_u32 m0, s28, 13312
  ds_read_b64_tr_b16 a[176:177], v30 offset:0
  ds_read_b64_tr_b16 a[178:179], v30 offset:256
  v_mfma_f32_16x16x32_bf16 v[116:119], a[180:183], a[236:239], v[116:119]
  buffer_load_dwordx4 v9, s[8:11], s31 offen offset:1024 lds
  v_mfma_f32_16x16x32_bf16 v[120:123], a[180:183], a[240:243], v[120:123]
  ds_read_b64_tr_b16 a[144:145], v22 offset:0
  ds_read_b64_tr_b16 a[148:149], v23 offset:0
  v_mfma_f32_16x16x32_bf16 v[124:127], a[180:183], a[244:247], v[124:127]
  ds_read_b64_tr_b16 a[152:153], v24 offset:0
  ds_read_b64_tr_b16 a[156:157], v25 offset:0
  v_mfma_f32_16x16x32_bf16 v[128:131], a[184:187], a[232:235], v[128:131]
  ds_read_b64_tr_b16 a[160:161], v26 offset:0
  ds_read_b64_tr_b16 a[164:165], v27 offset:0
  v_mfma_f32_16x16x32_bf16 v[132:135], a[184:187], a[236:239], v[132:135]
  buffer_load_dwordx4 v11, s[8:11], s31 offen offset:3072 lds
  v_mfma_f32_16x16x32_bf16 v[136:139], a[184:187], a[240:243], v[136:139]
  ds_read_b64_tr_b16 a[168:169], v28 offset:0
  ds_read_b64_tr_b16 a[172:173], v29 offset:0
  v_mfma_f32_16x16x32_bf16 v[140:143], a[184:187], a[244:247], v[140:143]
  s_waitcnt vmcnt(9)
  ds_read_b64_tr_b16 a[146:147], v22 offset:1024
  ds_read_b64_tr_b16 a[150:151], v23 offset:1024
  v_mfma_f32_16x16x32_bf16 v[144:147], a[188:191], a[232:235], v[144:147]
  ds_read_b64_tr_b16 a[154:155], v24 offset:1024
  ds_read_b64_tr_b16 a[158:159], v25 offset:1024
  s_waitcnt lgkmcnt(4)
  s_add_u32 s27, s29, 2949120
  s_add_u32 m0, s28, 8192
  v_mfma_f32_16x16x32_bf16 v[148:151], a[188:191], a[236:239], v[148:151]
  buffer_load_dwordx4 v12, s[8:11], s27 offen lds
  v_mfma_f32_16x16x32_bf16 v[152:155], a[188:191], a[240:243], v[152:155]
  ds_read_b64_tr_b16 a[162:163], v26 offset:1024
  ds_read_b64_tr_b16 a[166:167], v27 offset:1024
  v_mfma_f32_16x16x32_bf16 v[156:159], a[188:191], a[244:247], v[156:159]
  ds_read_b64_tr_b16 a[170:171], v28 offset:1024
  ds_read_b64_tr_b16 a[174:175], v29 offset:1024
  v_mfma_f32_16x16x32_bf16 v[160:163], a[192:195], a[232:235], v[160:163]
  ds_read_b128 a[216:219], v80 offset:8192
  s_add_u32 m0, s28, 0
  v_mfma_f32_16x16x32_bf16 v[164:167], a[192:195], a[236:239], v[164:167]
  buffer_load_dwordx4 v4, s[8:11], s27 offen lds
  v_mfma_f32_16x16x32_bf16 v[168:171], a[192:195], a[240:243], v[168:171]
  ds_read_b128 a[220:223], v80 offset:26624
  v_mfma_f32_16x16x32_bf16 v[172:175], a[192:195], a[244:247], v[172:175]
  ds_read_b128 a[224:227], v82 offset:8192
  v_mfma_f32_16x16x32_bf16 v[176:179], a[196:199], a[232:235], v[176:179]
  s_waitcnt lgkmcnt(3)
  ds_read_b128 a[228:231], v82 offset:26624
  v_mfma_f32_16x16x32_bf16 v[180:183], a[196:199], a[236:239], v[180:183]
  buffer_load_dwordx4 v6, s[8:11], s27 offen offset:2048 lds
  v_mfma_f32_16x16x32_bf16 v[184:187], a[196:199], a[240:243], v[184:187]
  v_mfma_f32_16x16x32_bf16 v[188:191], a[196:199], a[244:247], v[188:191]
  v_mfma_f32_16x16x32_bf16 v[192:195], a[200:203], a[232:235], v[192:195]
  s_add_u32 m0, s28, 4096
  v_mfma_f32_16x16x32_bf16 v[196:199], a[200:203], a[236:239], v[196:199]
  buffer_load_dwordx4 v8, s[8:11], s27 offen lds
  v_mfma_f32_16x16x32_bf16 v[200:203], a[200:203], a[240:243], v[200:203]
  v_mfma_f32_16x16x32_bf16 v[204:207], a[200:203], a[244:247], v[204:207]
  v_mfma_f32_16x16x32_bf16 v[208:211], a[204:207], a[232:235], v[208:211]
  v_mfma_f32_16x16x32_bf16 v[212:215], a[204:207], a[236:239], v[212:215]
  buffer_load_dwordx4 v10, s[8:11], s27 offen offset:2048 lds
  v_mfma_f32_16x16x32_bf16 v[216:219], a[204:207], a[240:243], v[216:219]
  v_mfma_f32_16x16x32_bf16 v[220:223], a[204:207], a[244:247], v[220:223]
  v_mfma_f32_16x16x32_bf16 v[224:227], a[208:211], a[232:235], v[224:227]
  s_add_u32 m0, s28, 0
  v_mfma_f32_16x16x32_bf16 v[228:231], a[208:211], a[236:239], v[228:231]
  buffer_load_dwordx4 v5, s[8:11], s27 offen offset:1024 lds
  v_mfma_f32_16x16x32_bf16 v[232:235], a[208:211], a[240:243], v[232:235]
  v_mfma_f32_16x16x32_bf16 v[236:239], a[208:211], a[244:247], v[236:239]
  v_mfma_f32_16x16x32_bf16 v[240:243], a[212:215], a[232:235], v[240:243]
  v_mfma_f32_16x16x32_bf16 v[244:247], a[212:215], a[236:239], v[244:247]
  buffer_load_dwordx4 v7, s[8:11], s27 offen offset:3072 lds
  v_mfma_f32_16x16x32_bf16 v[248:251], a[212:215], a[240:243], v[248:251]
  v_mfma_f32_16x16x32_bf16 v[252:255], a[212:215], a[244:247], v[252:255]
  s_waitcnt lgkmcnt(0)
  s_waitcnt vmcnt(11)
  v_mfma_f32_16x16x32_bf16 v[112:115], a[144:147], a[216:219], v[112:115]
  s_add_u32 m0, s28, 4096
  ds_read_b64_tr_b16 a[212:213], v30 offset:9216
  ds_read_b64_tr_b16 a[214:215], v30 offset:9472
  v_mfma_f32_16x16x32_bf16 v[116:119], a[144:147], a[220:223], v[116:119]
  buffer_load_dwordx4 v9, s[8:11], s27 offen offset:1024 lds
  v_mfma_f32_16x16x32_bf16 v[120:123], a[144:147], a[224:227], v[120:123]
  ds_read_b64_tr_b16 a[180:181], v22 offset:9216
  ds_read_b64_tr_b16 a[184:185], v23 offset:9216
  v_mfma_f32_16x16x32_bf16 v[124:127], a[144:147], a[228:231], v[124:127]
  ds_read_b64_tr_b16 a[188:189], v24 offset:9216
  ds_read_b64_tr_b16 a[192:193], v25 offset:9216
  v_mfma_f32_16x16x32_bf16 v[128:131], a[148:151], a[216:219], v[128:131]
  ds_read_b64_tr_b16 a[196:197], v26 offset:9216
  ds_read_b64_tr_b16 a[200:201], v27 offset:9216
  v_mfma_f32_16x16x32_bf16 v[132:135], a[148:151], a[220:223], v[132:135]
  buffer_load_dwordx4 v11, s[8:11], s27 offen offset:3072 lds
  v_mfma_f32_16x16x32_bf16 v[136:139], a[148:151], a[224:227], v[136:139]
  ds_read_b64_tr_b16 a[204:205], v28 offset:9216
  ds_read_b64_tr_b16 a[208:209], v29 offset:9216
  v_mfma_f32_16x16x32_bf16 v[140:143], a[148:151], a[228:231], v[140:143]
  s_waitcnt vmcnt(9)
  ds_read_b64_tr_b16 a[182:183], v22 offset:10240
  ds_read_b64_tr_b16 a[186:187], v23 offset:10240
  v_mfma_f32_16x16x32_bf16 v[144:147], a[152:155], a[216:219], v[144:147]
  ds_read_b64_tr_b16 a[190:191], v24 offset:10240
  ds_read_b64_tr_b16 a[194:195], v25 offset:10240
  s_waitcnt lgkmcnt(4)
  s_add_u32 s31, s29, 3244032
  s_add_u32 m0, s28, 17408
  v_mfma_f32_16x16x32_bf16 v[148:151], a[152:155], a[220:223], v[148:151]
  buffer_load_dwordx4 v12, s[8:11], s31 offen lds
  v_mfma_f32_16x16x32_bf16 v[152:155], a[152:155], a[224:227], v[152:155]
  ds_read_b64_tr_b16 a[198:199], v26 offset:10240
  ds_read_b64_tr_b16 a[202:203], v27 offset:10240
  v_mfma_f32_16x16x32_bf16 v[156:159], a[152:155], a[228:231], v[156:159]
  ds_read_b64_tr_b16 a[206:207], v28 offset:10240
  ds_read_b64_tr_b16 a[210:211], v29 offset:10240
  v_mfma_f32_16x16x32_bf16 v[160:163], a[156:159], a[216:219], v[160:163]
  ds_read_b128 a[232:235], v81 offset:9216
  s_add_u32 m0, s28, 9216
  v_mfma_f32_16x16x32_bf16 v[164:167], a[156:159], a[220:223], v[164:167]
  buffer_load_dwordx4 v4, s[8:11], s31 offen lds
  v_mfma_f32_16x16x32_bf16 v[168:171], a[156:159], a[224:227], v[168:171]
  ds_read_b128 a[236:239], v81 offset:27648
  v_mfma_f32_16x16x32_bf16 v[172:175], a[156:159], a[228:231], v[172:175]
  ds_read_b128 a[240:243], v83 offset:9216
  v_mfma_f32_16x16x32_bf16 v[176:179], a[160:163], a[216:219], v[176:179]
  s_waitcnt lgkmcnt(3)
  ds_read_b128 a[244:247], v83 offset:27648
  v_mfma_f32_16x16x32_bf16 v[180:183], a[160:163], a[220:223], v[180:183]
  buffer_load_dwordx4 v6, s[8:11], s31 offen offset:2048 lds
  v_mfma_f32_16x16x32_bf16 v[184:187], a[160:163], a[224:227], v[184:187]
  v_mfma_f32_16x16x32_bf16 v[188:191], a[160:163], a[228:231], v[188:191]
  v_mfma_f32_16x16x32_bf16 v[192:195], a[164:167], a[216:219], v[192:195]
  s_add_u32 m0, s28, 13312
  v_mfma_f32_16x16x32_bf16 v[196:199], a[164:167], a[220:223], v[196:199]
  buffer_load_dwordx4 v8, s[8:11], s31 offen lds
  v_mfma_f32_16x16x32_bf16 v[200:203], a[164:167], a[224:227], v[200:203]
  v_mfma_f32_16x16x32_bf16 v[204:207], a[164:167], a[228:231], v[204:207]
  v_mfma_f32_16x16x32_bf16 v[208:211], a[168:171], a[216:219], v[208:211]
  v_mfma_f32_16x16x32_bf16 v[212:215], a[168:171], a[220:223], v[212:215]
  buffer_load_dwordx4 v10, s[8:11], s31 offen offset:2048 lds
  v_mfma_f32_16x16x32_bf16 v[216:219], a[168:171], a[224:227], v[216:219]
  v_mfma_f32_16x16x32_bf16 v[220:223], a[168:171], a[228:231], v[220:223]
  v_mfma_f32_16x16x32_bf16 v[224:227], a[172:175], a[216:219], v[224:227]
  s_add_u32 m0, s28, 9216
  v_mfma_f32_16x16x32_bf16 v[228:231], a[172:175], a[220:223], v[228:231]
  buffer_load_dwordx4 v5, s[8:11], s31 offen offset:1024 lds
  v_mfma_f32_16x16x32_bf16 v[232:235], a[172:175], a[224:227], v[232:235]
  v_mfma_f32_16x16x32_bf16 v[236:239], a[172:175], a[228:231], v[236:239]
  v_mfma_f32_16x16x32_bf16 v[240:243], a[176:179], a[216:219], v[240:243]
  v_mfma_f32_16x16x32_bf16 v[244:247], a[176:179], a[220:223], v[244:247]
  buffer_load_dwordx4 v7, s[8:11], s31 offen offset:3072 lds
  v_mfma_f32_16x16x32_bf16 v[248:251], a[176:179], a[224:227], v[248:251]
  v_mfma_f32_16x16x32_bf16 v[252:255], a[176:179], a[228:231], v[252:255]
  s_waitcnt lgkmcnt(0)
  s_waitcnt vmcnt(11)
  v_mfma_f32_16x16x32_bf16 v[112:115], a[180:183], a[232:235], v[112:115]
  s_add_u32 m0, s28, 13312
  ds_read_b64_tr_b16 a[176:177], v30 offset:0
  ds_read_b64_tr_b16 a[178:179], v30 offset:256
  v_mfma_f32_16x16x32_bf16 v[116:119], a[180:183], a[236:239], v[116:119]
  buffer_load_dwordx4 v9, s[8:11], s31 offen offset:1024 lds
  v_mfma_f32_16x16x32_bf16 v[120:123], a[180:183], a[240:243], v[120:123]
  ds_read_b64_tr_b16 a[144:145], v22 offset:0
  ds_read_b64_tr_b16 a[148:149], v23 offset:0
  v_mfma_f32_16x16x32_bf16 v[124:127], a[180:183], a[244:247], v[124:127]
  ds_read_b64_tr_b16 a[152:153], v24 offset:0
  ds_read_b64_tr_b16 a[156:157], v25 offset:0
  v_mfma_f32_16x16x32_bf16 v[128:131], a[184:187], a[232:235], v[128:131]
  ds_read_b64_tr_b16 a[160:161], v26 offset:0
  ds_read_b64_tr_b16 a[164:165], v27 offset:0
  v_mfma_f32_16x16x32_bf16 v[132:135], a[184:187], a[236:239], v[132:135]
  buffer_load_dwordx4 v11, s[8:11], s31 offen offset:3072 lds
  v_mfma_f32_16x16x32_bf16 v[136:139], a[184:187], a[240:243], v[136:139]
  ds_read_b64_tr_b16 a[168:169], v28 offset:0
  ds_read_b64_tr_b16 a[172:173], v29 offset:0
  v_mfma_f32_16x16x32_bf16 v[140:143], a[184:187], a[244:247], v[140:143]
  s_waitcnt vmcnt(9)
  ds_read_b64_tr_b16 a[146:147], v22 offset:1024
  ds_read_b64_tr_b16 a[150:151], v23 offset:1024
  v_mfma_f32_16x16x32_bf16 v[144:147], a[188:191], a[232:235], v[144:147]
  ds_read_b64_tr_b16 a[154:155], v24 offset:1024
  ds_read_b64_tr_b16 a[158:159], v25 offset:1024
  s_waitcnt lgkmcnt(4)
  s_add_u32 s27, s29, 3538944
  s_add_u32 m0, s28, 8192
  v_mfma_f32_16x16x32_bf16 v[148:151], a[188:191], a[236:239], v[148:151]
  buffer_load_dwordx4 v12, s[8:11], s27 offen lds
  v_mfma_f32_16x16x32_bf16 v[152:155], a[188:191], a[240:243], v[152:155]
  ds_read_b64_tr_b16 a[162:163], v26 offset:1024
  ds_read_b64_tr_b16 a[166:167], v27 offset:1024
  v_mfma_f32_16x16x32_bf16 v[156:159], a[188:191], a[244:247], v[156:159]
  ds_read_b64_tr_b16 a[170:171], v28 offset:1024
  ds_read_b64_tr_b16 a[174:175], v29 offset:1024
  v_mfma_f32_16x16x32_bf16 v[160:163], a[192:195], a[232:235], v[160:163]
  ds_read_b128 a[216:219], v80 offset:10240
  s_add_u32 m0, s28, 0
  v_mfma_f32_16x16x32_bf16 v[164:167], a[192:195], a[236:239], v[164:167]
  buffer_load_dwordx4 v4, s[8:11], s27 offen lds
  v_mfma_f32_16x16x32_bf16 v[168:171], a[192:195], a[240:243], v[168:171]
  ds_read_b128 a[220:223], v80 offset:28672
  v_mfma_f32_16x16x32_bf16 v[172:175], a[192:195], a[244:247], v[172:175]
  ds_read_b128 a[224:227], v82 offset:10240
  v_mfma_f32_16x16x32_bf16 v[176:179], a[196:199], a[232:235], v[176:179]
  s_waitcnt lgkmcnt(3)
  ds_read_b128 a[228:231], v82 offset:28672
  v_mfma_f32_16x16x32_bf16 v[180:183], a[196:199], a[236:239], v[180:183]
  buffer_load_dwordx4 v6, s[8:11], s27 offen offset:2048 lds
  v_mfma_f32_16x16x32_bf16 v[184:187], a[196:199], a[240:243], v[184:187]
  v_mfma_f32_16x16x32_bf16 v[188:191], a[196:199], a[244:247], v[188:191]
  v_mfma_f32_16x16x32_bf16 v[192:195], a[200:203], a[232:235], v[192:195]
  s_add_u32 m0, s28, 4096
  v_mfma_f32_16x16x32_bf16 v[196:199], a[200:203], a[236:239], v[196:199]
  buffer_load_dwordx4 v8, s[8:11], s27 offen lds
  v_mfma_f32_16x16x32_bf16 v[200:203], a[200:203], a[240:243], v[200:203]
  v_mfma_f32_16x16x32_bf16 v[204:207], a[200:203], a[244:247], v[204:207]
  v_mfma_f32_16x16x32_bf16 v[208:211], a[204:207], a[232:235], v[208:211]
  v_mfma_f32_16x16x32_bf16 v[212:215], a[204:207], a[236:239], v[212:215]
  buffer_load_dwordx4 v10, s[8:11], s27 offen offset:2048 lds
  v_mfma_f32_16x16x32_bf16 v[216:219], a[204:207], a[240:243], v[216:219]
  v_mfma_f32_16x16x32_bf16 v[220:223], a[204:207], a[244:247], v[220:223]
  v_mfma_f32_16x16x32_bf16 v[224:227], a[208:211], a[232:235], v[224:227]
  s_add_u32 m0, s28, 0
  v_mfma_f32_16x16x32_bf16 v[228:231], a[208:211], a[236:239], v[228:231]
  buffer_load_dwordx4 v5, s[8:11], s27 offen offset:1024 lds
  v_mfma_f32_16x16x32_bf16 v[232:235], a[208:211], a[240:243], v[232:235]
  v_mfma_f32_16x16x32_bf16 v[236:239], a[208:211], a[244:247], v[236:239]
  v_mfma_f32_16x16x32_bf16 v[240:243], a[212:215], a[232:235], v[240:243]
  v_mfma_f32_16x16x32_bf16 v[244:247], a[212:215], a[236:239], v[244:247]
  buffer_load_dwordx4 v7, s[8:11], s27 offen offset:3072 lds
  v_mfma_f32_16x16x32_bf16 v[248:251], a[212:215], a[240:243], v[248:251]
  v_mfma_f32_16x16x32_bf16 v[252:255], a[212:215], a[244:247], v[252:255]
  s_waitcnt lgkmcnt(0)
  s_nop 0
  v_readfirstlane_b32 s94, v89
  s_cmp_lg_u32 s94, 0
  s_cbranch_scc1 K_HAVE_NONCEM
  s_mov_b32 s34, 1048576
K_NONCE_SPINM:
  v_mov_b32 v89, 0
  buffer_load_dword v89, v89, s[44:47], 0 offen sc1
  s_waitcnt vmcnt(0)
  v_readfirstlane_b32 s94, v89
  s_sub_u32 s34, s34, 1
  s_cbranch_scc1 K_HAVE_NONCEM
  s_cmp_lg_u32 s94, 0
  s_cbranch_scc1 K_HAVE_NONCEM
  s_sleep 1
  s_branch K_NONCE_SPINM
K_HAVE_NONCEM:
  s_waitcnt vmcnt(11)
  v_mfma_f32_16x16x32_bf16 v[112:115], a[144:147], a[216:219], v[112:115]
  s_add_u32 m0, s28, 4096
  ds_read_b64_tr_b16 a[212:213], v30 offset:9216
  ds_read_b64_tr_b16 a[214:215], v30 offset:9472
  v_mfma_f32_16x16x32_bf16 v[116:119], a[144:147], a[220:223], v[116:119]
  buffer_load_dwordx4 v9, s[8:11], s27 offen offset:1024 lds
  v_mfma_f32_16x16x32_bf16 v[120:123], a[144:147], a[224:227], v[120:123]
  ds_read_b64_tr_b16 a[180:181], v22 offset:9216
  ds_read_b64_tr_b16 a[184:185], v23 offset:9216
  v_mfma_f32_16x16x32_bf16 v[124:127], a[144:147], a[228:231], v[124:127]
  ds_read_b64_tr_b16 a[188:189], v24 offset:9216
  ds_read_b64_tr_b16 a[192:193], v25 offset:9216
  v_mfma_f32_16x16x32_bf16 v[128:131], a[148:151], a[216:219], v[128:131]
  ds_read_b64_tr_b16 a[196:197], v26 offset:9216
  ds_read_b64_tr_b16 a[200:201], v27 offset:9216
  v_mfma_f32_16x16x32_bf16 v[132:135], a[148:151], a[220:223], v[132:135]
  buffer_load_dwordx4 v11, s[8:11], s27 offen offset:3072 lds
  v_mfma_f32_16x16x32_bf16 v[136:139], a[148:151], a[224:227], v[136:139]
  ds_read_b64_tr_b16 a[204:205], v28 offset:9216
  ds_read_b64_tr_b16 a[208:209], v29 offset:9216
  v_mfma_f32_16x16x32_bf16 v[140:143], a[148:151], a[228:231], v[140:143]
  s_waitcnt vmcnt(9)
  ds_read_b64_tr_b16 a[182:183], v22 offset:10240
  ds_read_b64_tr_b16 a[186:187], v23 offset:10240
  v_mfma_f32_16x16x32_bf16 v[144:147], a[152:155], a[216:219], v[144:147]
  ds_read_b64_tr_b16 a[190:191], v24 offset:10240
  ds_read_b64_tr_b16 a[194:195], v25 offset:10240
  s_waitcnt lgkmcnt(4)
  s_add_u32 s31, s29, 3833856
  s_add_u32 m0, s28, 17408
  v_mfma_f32_16x16x32_bf16 v[148:151], a[152:155], a[220:223], v[148:151]
  buffer_load_dwordx4 v12, s[8:11], s31 offen lds
  v_mfma_f32_16x16x32_bf16 v[152:155], a[152:155], a[224:227], v[152:155]
  ds_read_b64_tr_b16 a[198:199], v26 offset:10240
  ds_read_b64_tr_b16 a[202:203], v27 offset:10240
  v_mfma_f32_16x16x32_bf16 v[156:159], a[152:155], a[228:231], v[156:159]
  ds_read_b64_tr_b16 a[206:207], v28 offset:10240
  ds_read_b64_tr_b16 a[210:211], v29 offset:10240
  v_mfma_f32_16x16x32_bf16 v[160:163], a[156:159], a[216:219], v[160:163]
  ds_read_b128 a[232:235], v81 offset:11264
  s_add_u32 m0, s28, 9216
  v_mfma_f32_16x16x32_bf16 v[164:167], a[156:159], a[220:223], v[164:167]
  buffer_load_dwordx4 v4, s[8:11], s31 offen lds
  v_mfma_f32_16x16x32_bf16 v[168:171], a[156:159], a[224:227], v[168:171]
  ds_read_b128 a[236:239], v81 offset:29696
  v_mfma_f32_16x16x32_bf16 v[172:175], a[156:159], a[228:231], v[172:175]
  ds_read_b128 a[240:243], v83 offset:11264
  v_mfma_f32_16x16x32_bf16 v[176:179], a[160:163], a[216:219], v[176:179]
  s_waitcnt lgkmcnt(3)
  ds_read_b128 a[244:247], v83 offset:29696
  v_mfma_f32_16x16x32_bf16 v[180:183], a[160:163], a[220:223], v[180:183]
  buffer_load_dwordx4 v6, s[8:11], s31 offen offset:2048 lds
  v_mfma_f32_16x16x32_bf16 v[184:187], a[160:163], a[224:227], v[184:187]
  v_mfma_f32_16x16x32_bf16 v[188:191], a[160:163], a[228:231], v[188:191]
  v_mfma_f32_16x16x32_bf16 v[192:195], a[164:167], a[216:219], v[192:195]
  s_add_u32 m0, s28, 13312
  v_mfma_f32_16x16x32_bf16 v[196:199], a[164:167], a[220:223], v[196:199]
  buffer_load_dwordx4 v8, s[8:11], s31 offen lds
  v_mfma_f32_16x16x32_bf16 v[200:203], a[164:167], a[224:227], v[200:203]
  v_mfma_f32_16x16x32_bf16 v[204:207], a[164:167], a[228:231], v[204:207]
  v_mfma_f32_16x16x32_bf16 v[208:211], a[168:171], a[216:219], v[208:211]
  v_mfma_f32_16x16x32_bf16 v[212:215], a[168:171], a[220:223], v[212:215]
  buffer_load_dwordx4 v10, s[8:11], s31 offen offset:2048 lds
  v_mfma_f32_16x16x32_bf16 v[216:219], a[168:171], a[224:227], v[216:219]
  v_mfma_f32_16x16x32_bf16 v[220:223], a[168:171], a[228:231], v[220:223]
  v_mfma_f32_16x16x32_bf16 v[224:227], a[172:175], a[216:219], v[224:227]
  s_add_u32 m0, s28, 9216
  v_mfma_f32_16x16x32_bf16 v[228:231], a[172:175], a[220:223], v[228:231]
  buffer_load_dwordx4 v5, s[8:11], s31 offen offset:1024 lds
  v_mfma_f32_16x16x32_bf16 v[232:235], a[172:175], a[224:227], v[232:235]
  v_mfma_f32_16x16x32_bf16 v[236:239], a[172:175], a[228:231], v[236:239]
  v_mfma_f32_16x16x32_bf16 v[240:243], a[176:179], a[216:219], v[240:243]
  v_mfma_f32_16x16x32_bf16 v[244:247], a[176:179], a[220:223], v[244:247]
  buffer_load_dwordx4 v7, s[8:11], s31 offen offset:3072 lds
  v_mfma_f32_16x16x32_bf16 v[248:251], a[176:179], a[224:227], v[248:251]
  v_mfma_f32_16x16x32_bf16 v[252:255], a[176:179], a[228:231], v[252:255]
  s_waitcnt lgkmcnt(0)
  s_waitcnt vmcnt(11)
  v_mfma_f32_16x16x32_bf16 v[112:115], a[180:183], a[232:235], v[112:115]
  s_add_u32 m0, s28, 13312
  ds_read_b64_tr_b16 a[176:177], v30 offset:0
  ds_read_b64_tr_b16 a[178:179], v30 offset:256
  v_mfma_f32_16x16x32_bf16 v[116:119], a[180:183], a[236:239], v[116:119]
  buffer_load_dwordx4 v9, s[8:11], s31 offen offset:1024 lds
  v_mfma_f32_16x16x32_bf16 v[120:123], a[180:183], a[240:243], v[120:123]
  ds_read_b64_tr_b16 a[144:145], v22 offset:0
  ds_read_b64_tr_b16 a[148:149], v23 offset:0
  v_mfma_f32_16x16x32_bf16 v[124:127], a[180:183], a[244:247], v[124:127]
  ds_read_b64_tr_b16 a[152:153], v24 offset:0
  ds_read_b64_tr_b16 a[156:157], v25 offset:0
  v_mfma_f32_16x16x32_bf16 v[128:131], a[184:187], a[232:235], v[128:131]
  ds_read_b64_tr_b16 a[160:161], v26 offset:0
  ds_read_b64_tr_b16 a[164:165], v27 offset:0
  v_mfma_f32_16x16x32_bf16 v[132:135], a[184:187], a[236:239], v[132:135]
  buffer_load_dwordx4 v11, s[8:11], s31 offen offset:3072 lds
  v_mfma_f32_16x16x32_bf16 v[136:139], a[184:187], a[240:243], v[136:139]
  ds_read_b64_tr_b16 a[168:169], v28 offset:0
  ds_read_b64_tr_b16 a[172:173], v29 offset:0
  v_mfma_f32_16x16x32_bf16 v[140:143], a[184:187], a[244:247], v[140:143]
  s_waitcnt vmcnt(9)
  ds_read_b64_tr_b16 a[146:147], v22 offset:1024
  ds_read_b64_tr_b16 a[150:151], v23 offset:1024
  v_mfma_f32_16x16x32_bf16 v[144:147], a[188:191], a[232:235], v[144:147]
  ds_read_b64_tr_b16 a[154:155], v24 offset:1024
  ds_read_b64_tr_b16 a[158:159], v25 offset:1024
  s_waitcnt lgkmcnt(4)
  s_add_u32 s27, s29, 4128768
  s_add_u32 m0, s28, 8192
  v_mfma_f32_16x16x32_bf16 v[148:151], a[188:191], a[236:239], v[148:151]
  buffer_load_dwordx4 v12, s[8:11], s27 offen lds
  v_mfma_f32_16x16x32_bf16 v[152:155], a[188:191], a[240:243], v[152:155]
  ds_read_b64_tr_b16 a[162:163], v26 offset:1024
  ds_read_b64_tr_b16 a[166:167], v27 offset:1024
  v_mfma_f32_16x16x32_bf16 v[156:159], a[188:191], a[244:247], v[156:159]
  ds_read_b64_tr_b16 a[170:171], v28 offset:1024
  ds_read_b64_tr_b16 a[174:175], v29 offset:1024
  v_mfma_f32_16x16x32_bf16 v[160:163], a[192:195], a[232:235], v[160:163]
  ds_read_b128 a[216:219], v80 offset:12288
  s_add_u32 m0, s28, 0
  v_mfma_f32_16x16x32_bf16 v[164:167], a[192:195], a[236:239], v[164:167]
  buffer_load_dwordx4 v4, s[8:11], s27 offen lds
  v_mfma_f32_16x16x32_bf16 v[168:171], a[192:195], a[240:243], v[168:171]
  ds_read_b128 a[220:223], v80 offset:30720
  v_mfma_f32_16x16x32_bf16 v[172:175], a[192:195], a[244:247], v[172:175]
  ds_read_b128 a[224:227], v82 offset:12288
  v_mfma_f32_16x16x32_bf16 v[176:179], a[196:199], a[232:235], v[176:179]
  s_waitcnt lgkmcnt(3)
  ds_read_b128 a[228:231], v82 offset:30720
  v_mfma_f32_16x16x32_bf16 v[180:183], a[196:199], a[236:239], v[180:183]
  buffer_load_dwordx4 v6, s[8:11], s27 offen offset:2048 lds
  v_mfma_f32_16x16x32_bf16 v[184:187], a[196:199], a[240:243], v[184:187]
  v_mfma_f32_16x16x32_bf16 v[188:191], a[196:199], a[244:247], v[188:191]
  v_mfma_f32_16x16x32_bf16 v[192:195], a[200:203], a[232:235], v[192:195]
  s_add_u32 m0, s28, 4096
  v_mfma_f32_16x16x32_bf16 v[196:199], a[200:203], a[236:239], v[196:199]
  buffer_load_dwordx4 v8, s[8:11], s27 offen lds
  v_mfma_f32_16x16x32_bf16 v[200:203], a[200:203], a[240:243], v[200:203]
  v_mfma_f32_16x16x32_bf16 v[204:207], a[200:203], a[244:247], v[204:207]
  v_mfma_f32_16x16x32_bf16 v[208:211], a[204:207], a[232:235], v[208:211]
  v_mfma_f32_16x16x32_bf16 v[212:215], a[204:207], a[236:239], v[212:215]
  buffer_load_dwordx4 v10, s[8:11], s27 offen offset:2048 lds
  v_mfma_f32_16x16x32_bf16 v[216:219], a[204:207], a[240:243], v[216:219]
  v_mfma_f32_16x16x32_bf16 v[220:223], a[204:207], a[244:247], v[220:223]
  v_mfma_f32_16x16x32_bf16 v[224:227], a[208:211], a[232:235], v[224:227]
  s_add_u32 m0, s28, 0
  v_mfma_f32_16x16x32_bf16 v[228:231], a[208:211], a[236:239], v[228:231]
  buffer_load_dwordx4 v5, s[8:11], s27 offen offset:1024 lds
  v_mfma_f32_16x16x32_bf16 v[232:235], a[208:211], a[240:243], v[232:235]
  v_mfma_f32_16x16x32_bf16 v[236:239], a[208:211], a[244:247], v[236:239]
  v_mfma_f32_16x16x32_bf16 v[240:243], a[212:215], a[232:235], v[240:243]
  v_mfma_f32_16x16x32_bf16 v[244:247], a[212:215], a[236:239], v[244:247]
  buffer_load_dwordx4 v7, s[8:11], s27 offen offset:3072 lds
  v_mfma_f32_16x16x32_bf16 v[248:251], a[212:215], a[240:243], v[248:251]
  v_mfma_f32_16x16x32_bf16 v[252:255], a[212:215], a[244:247], v[252:255]
  s_waitcnt lgkmcnt(0)
  s_waitcnt vmcnt(11)
  v_mfma_f32_16x16x32_bf16 v[112:115], a[144:147], a[216:219], v[112:115]
  s_add_u32 m0, s28, 4096
  ds_read_b64_tr_b16 a[212:213], v30 offset:9216
  ds_read_b64_tr_b16 a[214:215], v30 offset:9472
  v_mfma_f32_16x16x32_bf16 v[116:119], a[144:147], a[220:223], v[116:119]
  buffer_load_dwordx4 v9, s[8:11], s27 offen offset:1024 lds
  v_mfma_f32_16x16x32_bf16 v[120:123], a[144:147], a[224:227], v[120:123]
  ds_read_b64_tr_b16 a[180:181], v22 offset:9216
  ds_read_b64_tr_b16 a[184:185], v23 offset:9216
  v_mfma_f32_16x16x32_bf16 v[124:127], a[144:147], a[228:231], v[124:127]
  ds_read_b64_tr_b16 a[188:189], v24 offset:9216
  ds_read_b64_tr_b16 a[192:193], v25 offset:9216
  v_mfma_f32_16x16x32_bf16 v[128:131], a[148:151], a[216:219], v[128:131]
  ds_read_b64_tr_b16 a[196:197], v26 offset:9216
  ds_read_b64_tr_b16 a[200:201], v27 offset:9216
  v_mfma_f32_16x16x32_bf16 v[132:135], a[148:151], a[220:223], v[132:135]
  buffer_load_dwordx4 v11, s[8:11], s27 offen offset:3072 lds
  v_mfma_f32_16x16x32_bf16 v[136:139], a[148:151], a[224:227], v[136:139]
  ds_read_b64_tr_b16 a[204:205], v28 offset:9216
  ds_read_b64_tr_b16 a[208:209], v29 offset:9216
  v_mfma_f32_16x16x32_bf16 v[140:143], a[148:151], a[228:231], v[140:143]
  s_waitcnt vmcnt(9)
  ds_read_b64_tr_b16 a[182:183], v22 offset:10240
  ds_read_b64_tr_b16 a[186:187], v23 offset:10240
  v_mfma_f32_16x16x32_bf16 v[144:147], a[152:155], a[216:219], v[144:147]
  ds_read_b64_tr_b16 a[190:191], v24 offset:10240
  ds_read_b64_tr_b16 a[194:195], v25 offset:10240
  s_waitcnt lgkmcnt(4)
  s_add_u32 s31, s29, 4423680
  s_add_u32 m0, s28, 17408
  v_mfma_f32_16x16x32_bf16 v[148:151], a[152:155], a[220:223], v[148:151]
  buffer_load_dwordx4 v12, s[8:11], s31 offen lds
  v_mfma_f32_16x16x32_bf16 v[152:155], a[152:155], a[224:227], v[152:155]
  ds_read_b64_tr_b16 a[198:199], v26 offset:10240
  ds_read_b64_tr_b16 a[202:203], v27 offset:10240
  v_mfma_f32_16x16x32_bf16 v[156:159], a[152:155], a[228:231], v[156:159]
  ds_read_b64_tr_b16 a[206:207], v28 offset:10240
  ds_read_b64_tr_b16 a[210:211], v29 offset:10240
  v_mfma_f32_16x16x32_bf16 v[160:163], a[156:159], a[216:219], v[160:163]
  ds_read_b128 a[232:235], v81 offset:13312
  s_add_u32 m0, s28, 9216
  v_mfma_f32_16x16x32_bf16 v[164:167], a[156:159], a[220:223], v[164:167]
  buffer_load_dwordx4 v4, s[8:11], s31 offen lds
  v_mfma_f32_16x16x32_bf16 v[168:171], a[156:159], a[224:227], v[168:171]
  ds_read_b128 a[236:239], v81 offset:31744
  v_mfma_f32_16x16x32_bf16 v[172:175], a[156:159], a[228:231], v[172:175]
  ds_read_b128 a[240:243], v83 offset:13312
  v_mfma_f32_16x16x32_bf16 v[176:179], a[160:163], a[216:219], v[176:179]
  s_waitcnt lgkmcnt(3)
  ds_read_b128 a[244:247], v83 offset:31744
  v_mfma_f32_16x16x32_bf16 v[180:183], a[160:163], a[220:223], v[180:183]
  buffer_load_dwordx4 v6, s[8:11], s31 offen offset:2048 lds
  v_mfma_f32_16x16x32_bf16 v[184:187], a[160:163], a[224:227], v[184:187]
  v_mfma_f32_16x16x32_bf16 v[188:191], a[160:163], a[228:231], v[188:191]
  v_mfma_f32_16x16x32_bf16 v[192:195], a[164:167], a[216:219], v[192:195]
  s_add_u32 m0, s28, 13312
  v_mfma_f32_16x16x32_bf16 v[196:199], a[164:167], a[220:223], v[196:199]
  buffer_load_dwordx4 v8, s[8:11], s31 offen lds
  v_mfma_f32_16x16x32_bf16 v[200:203], a[164:167], a[224:227], v[200:203]
  v_mfma_f32_16x16x32_bf16 v[204:207], a[164:167], a[228:231], v[204:207]
  v_mfma_f32_16x16x32_bf16 v[208:211], a[168:171], a[216:219], v[208:211]
  v_mfma_f32_16x16x32_bf16 v[212:215], a[168:171], a[220:223], v[212:215]
  buffer_load_dwordx4 v10, s[8:11], s31 offen offset:2048 lds
  v_mfma_f32_16x16x32_bf16 v[216:219], a[168:171], a[224:227], v[216:219]
  v_mfma_f32_16x16x32_bf16 v[220:223], a[168:171], a[228:231], v[220:223]
  v_mfma_f32_16x16x32_bf16 v[224:227], a[172:175], a[216:219], v[224:227]
  s_add_u32 m0, s28, 9216
  v_mfma_f32_16x16x32_bf16 v[228:231], a[172:175], a[220:223], v[228:231]
  buffer_load_dwordx4 v5, s[8:11], s31 offen offset:1024 lds
  v_mfma_f32_16x16x32_bf16 v[232:235], a[172:175], a[224:227], v[232:235]
  v_mfma_f32_16x16x32_bf16 v[236:239], a[172:175], a[228:231], v[236:239]
  v_mfma_f32_16x16x32_bf16 v[240:243], a[176:179], a[216:219], v[240:243]
  v_mfma_f32_16x16x32_bf16 v[244:247], a[176:179], a[220:223], v[244:247]
  buffer_load_dwordx4 v7, s[8:11], s31 offen offset:3072 lds
  v_mfma_f32_16x16x32_bf16 v[248:251], a[176:179], a[224:227], v[248:251]
  v_mfma_f32_16x16x32_bf16 v[252:255], a[176:179], a[228:231], v[252:255]
  s_waitcnt lgkmcnt(0)
  s_waitcnt vmcnt(11)
  v_mfma_f32_16x16x32_bf16 v[112:115], a[180:183], a[232:235], v[112:115]
  s_add_u32 m0, s28, 13312
  ds_read_b64_tr_b16 a[176:177], v30 offset:0
  ds_read_b64_tr_b16 a[178:179], v30 offset:256
  v_mfma_f32_16x16x32_bf16 v[116:119], a[180:183], a[236:239], v[116:119]
  buffer_load_dwordx4 v9, s[8:11], s31 offen offset:1024 lds
  v_mfma_f32_16x16x32_bf16 v[120:123], a[180:183], a[240:243], v[120:123]
  ds_read_b64_tr_b16 a[144:145], v22 offset:0
  ds_read_b64_tr_b16 a[148:149], v23 offset:0
  v_mfma_f32_16x16x32_bf16 v[124:127], a[180:183], a[244:247], v[124:127]
  ds_read_b64_tr_b16 a[152:153], v24 offset:0
  ds_read_b64_tr_b16 a[156:157], v25 offset:0
  v_mfma_f32_16x16x32_bf16 v[128:131], a[184:187], a[232:235], v[128:131]
  ds_read_b64_tr_b16 a[160:161], v26 offset:0
  ds_read_b64_tr_b16 a[164:165], v27 offset:0
  v_mfma_f32_16x16x32_bf16 v[132:135], a[184:187], a[236:239], v[132:135]
  buffer_load_dwordx4 v11, s[8:11], s31 offen offset:3072 lds
  v_mfma_f32_16x16x32_bf16 v[136:139], a[184:187], a[240:243], v[136:139]
  ds_read_b64_tr_b16 a[168:169], v28 offset:0
  ds_read_b64_tr_b16 a[172:173], v29 offset:0
  v_mfma_f32_16x16x32_bf16 v[140:143], a[184:187], a[244:247], v[140:143]
  s_waitcnt vmcnt(9)
  ds_read_b64_tr_b16 a[146:147], v22 offset:1024
  ds_read_b64_tr_b16 a[150:151], v23 offset:1024
  v_mfma_f32_16x16x32_bf16 v[144:147], a[188:191], a[232:235], v[144:147]
  ds_read_b64_tr_b16 a[154:155], v24 offset:1024
  ds_read_b64_tr_b16 a[158:159], v25 offset:1024
  s_waitcnt lgkmcnt(4)
  s_add_u32 s27, s29, 4718592
  s_add_u32 m0, s28, 8192
  v_mfma_f32_16x16x32_bf16 v[148:151], a[188:191], a[236:239], v[148:151]
  buffer_load_dwordx4 v12, s[8:11], s27 offen lds
  v_mfma_f32_16x16x32_bf16 v[152:155], a[188:191], a[240:243], v[152:155]
  ds_read_b64_tr_b16 a[162:163], v26 offset:1024
  ds_read_b64_tr_b16 a[166:167], v27 offset:1024
  v_mfma_f32_16x16x32_bf16 v[156:159], a[188:191], a[244:247], v[156:159]
  ds_read_b64_tr_b16 a[170:171], v28 offset:1024
  ds_read_b64_tr_b16 a[174:175], v29 offset:1024
  v_mfma_f32_16x16x32_bf16 v[160:163], a[192:195], a[232:235], v[160:163]
  ds_read_b128 a[216:219], v80 offset:14336
  s_add_u32 m0, s28, 0
  v_mfma_f32_16x16x32_bf16 v[164:167], a[192:195], a[236:239], v[164:167]
  buffer_load_dwordx4 v4, s[8:11], s27 offen lds
  v_mfma_f32_16x16x32_bf16 v[168:171], a[192:195], a[240:243], v[168:171]
  ds_read_b128 a[220:223], v80 offset:32768
  v_mfma_f32_16x16x32_bf16 v[172:175], a[192:195], a[244:247], v[172:175]
  ds_read_b128 a[224:227], v82 offset:14336
  v_mfma_f32_16x16x32_bf16 v[176:179], a[196:199], a[232:235], v[176:179]
  s_waitcnt lgkmcnt(3)
  ds_read_b128 a[228:231], v82 offset:32768
  v_mfma_f32_16x16x32_bf16 v[180:183], a[196:199], a[236:239], v[180:183]
  buffer_load_dwordx4 v6, s[8:11], s27 offen offset:2048 lds
  v_mfma_f32_16x16x32_bf16 v[184:187], a[196:199], a[240:243], v[184:187]
  v_mfma_f32_16x16x32_bf16 v[188:191], a[196:199], a[244:247], v[188:191]
  v_mfma_f32_16x16x32_bf16 v[192:195], a[200:203], a[232:235], v[192:195]
  s_add_u32 m0, s28, 4096
  v_mfma_f32_16x16x32_bf16 v[196:199], a[200:203], a[236:239], v[196:199]
  buffer_load_dwordx4 v8, s[8:11], s27 offen lds
  v_mfma_f32_16x16x32_bf16 v[200:203], a[200:203], a[240:243], v[200:203]
  v_mfma_f32_16x16x32_bf16 v[204:207], a[200:203], a[244:247], v[204:207]
  v_mfma_f32_16x16x32_bf16 v[208:211], a[204:207], a[232:235], v[208:211]
  v_mfma_f32_16x16x32_bf16 v[212:215], a[204:207], a[236:239], v[212:215]
  buffer_load_dwordx4 v10, s[8:11], s27 offen offset:2048 lds
  v_mfma_f32_16x16x32_bf16 v[216:219], a[204:207], a[240:243], v[216:219]
  v_mfma_f32_16x16x32_bf16 v[220:223], a[204:207], a[244:247], v[220:223]
  v_mfma_f32_16x16x32_bf16 v[224:227], a[208:211], a[232:235], v[224:227]
  s_add_u32 m0, s28, 0
  v_mfma_f32_16x16x32_bf16 v[228:231], a[208:211], a[236:239], v[228:231]
  buffer_load_dwordx4 v5, s[8:11], s27 offen offset:1024 lds
  v_mfma_f32_16x16x32_bf16 v[232:235], a[208:211], a[240:243], v[232:235]
  v_mfma_f32_16x16x32_bf16 v[236:239], a[208:211], a[244:247], v[236:239]
  v_mfma_f32_16x16x32_bf16 v[240:243], a[212:215], a[232:235], v[240:243]
  v_mfma_f32_16x16x32_bf16 v[244:247], a[212:215], a[236:239], v[244:247]
  buffer_load_dwordx4 v7, s[8:11], s27 offen offset:3072 lds
  v_mfma_f32_16x16x32_bf16 v[248:251], a[212:215], a[240:243], v[248:251]
  v_mfma_f32_16x16x32_bf16 v[252:255], a[212:215], a[244:247], v[252:255]
  s_waitcnt lgkmcnt(0)
  s_waitcnt vmcnt(11)
  v_mfma_f32_16x16x32_bf16 v[112:115], a[144:147], a[216:219], v[112:115]
  s_add_u32 m0, s28, 4096
  ds_read_b64_tr_b16 a[212:213], v30 offset:9216
  ds_read_b64_tr_b16 a[214:215], v30 offset:9472
  v_mfma_f32_16x16x32_bf16 v[116:119], a[144:147], a[220:223], v[116:119]
  buffer_load_dwordx4 v9, s[8:11], s27 offen offset:1024 lds
  v_mfma_f32_16x16x32_bf16 v[120:123], a[144:147], a[224:227], v[120:123]
  ds_read_b64_tr_b16 a[180:181], v22 offset:9216
  ds_read_b64_tr_b16 a[184:185], v23 offset:9216
  v_mfma_f32_16x16x32_bf16 v[124:127], a[144:147], a[228:231], v[124:127]
  ds_read_b64_tr_b16 a[188:189], v24 offset:9216
  ds_read_b64_tr_b16 a[192:193], v25 offset:9216
  v_mfma_f32_16x16x32_bf16 v[128:131], a[148:151], a[216:219], v[128:131]
  ds_read_b64_tr_b16 a[196:197], v26 offset:9216
  ds_read_b64_tr_b16 a[200:201], v27 offset:9216
  v_mfma_f32_16x16x32_bf16 v[132:135], a[148:151], a[220:223], v[132:135]
  buffer_load_dwordx4 v11, s[8:11], s27 offen offset:3072 lds
  v_mfma_f32_16x16x32_bf16 v[136:139], a[148:151], a[224:227], v[136:139]
  ds_read_b64_tr_b16 a[204:205], v28 offset:9216
  ds_read_b64_tr_b16 a[208:209], v29 offset:9216
  v_mfma_f32_16x16x32_bf16 v[140:143], a[148:151], a[228:231], v[140:143]
  s_waitcnt vmcnt(9)
  ds_read_b64_tr_b16 a[182:183], v22 offset:10240
  ds_read_b64_tr_b16 a[186:187], v23 offset:10240
  v_mfma_f32_16x16x32_bf16 v[144:147], a[152:155], a[216:219], v[144:147]
  ds_read_b64_tr_b16 a[190:191], v24 offset:10240
  ds_read_b64_tr_b16 a[194:195], v25 offset:10240
  s_waitcnt lgkmcnt(4)
  s_add_u32 s31, s29, 5013504
  s_add_u32 m0, s28, 17408
  v_mfma_f32_16x16x32_bf16 v[148:151], a[152:155], a[220:223], v[148:151]
  buffer_load_dwordx4 v12, s[8:11], s31 offen lds
  v_mfma_f32_16x16x32_bf16 v[152:155], a[152:155], a[224:227], v[152:155]
  ds_read_b64_tr_b16 a[198:199], v26 offset:10240
  ds_read_b64_tr_b16 a[202:203], v27 offset:10240
  v_mfma_f32_16x16x32_bf16 v[156:159], a[152:155], a[228:231], v[156:159]
  ds_read_b64_tr_b16 a[206:207], v28 offset:10240
  ds_read_b64_tr_b16 a[210:211], v29 offset:10240
  v_mfma_f32_16x16x32_bf16 v[160:163], a[156:159], a[216:219], v[160:163]
  ds_read_b128 a[232:235], v81 offset:15360
  s_add_u32 m0, s28, 9216
  v_mfma_f32_16x16x32_bf16 v[164:167], a[156:159], a[220:223], v[164:167]
  buffer_load_dwordx4 v4, s[8:11], s31 offen lds
  v_mfma_f32_16x16x32_bf16 v[168:171], a[156:159], a[224:227], v[168:171]
  ds_read_b128 a[236:239], v81 offset:33792
  v_mfma_f32_16x16x32_bf16 v[172:175], a[156:159], a[228:231], v[172:175]
  ds_read_b128 a[240:243], v83 offset:15360
  v_mfma_f32_16x16x32_bf16 v[176:179], a[160:163], a[216:219], v[176:179]
  s_waitcnt lgkmcnt(3)
  ds_read_b128 a[244:247], v83 offset:33792
  v_mfma_f32_16x16x32_bf16 v[180:183], a[160:163], a[220:223], v[180:183]
  buffer_load_dwordx4 v6, s[8:11], s31 offen offset:2048 lds
  v_mfma_f32_16x16x32_bf16 v[184:187], a[160:163], a[224:227], v[184:187]
  v_mfma_f32_16x16x32_bf16 v[188:191], a[160:163], a[228:231], v[188:191]
  v_mfma_f32_16x16x32_bf16 v[192:195], a[164:167], a[216:219], v[192:195]
  s_add_u32 m0, s28, 13312
  v_mfma_f32_16x16x32_bf16 v[196:199], a[164:167], a[220:223], v[196:199]
  buffer_load_dwordx4 v8, s[8:11], s31 offen lds
  v_mfma_f32_16x16x32_bf16 v[200:203], a[164:167], a[224:227], v[200:203]
  v_mfma_f32_16x16x32_bf16 v[204:207], a[164:167], a[228:231], v[204:207]
  v_mfma_f32_16x16x32_bf16 v[208:211], a[168:171], a[216:219], v[208:211]
  v_mfma_f32_16x16x32_bf16 v[212:215], a[168:171], a[220:223], v[212:215]
  buffer_load_dwordx4 v10, s[8:11], s31 offen offset:2048 lds
  v_mfma_f32_16x16x32_bf16 v[216:219], a[168:171], a[224:227], v[216:219]
  v_mfma_f32_16x16x32_bf16 v[220:223], a[168:171], a[228:231], v[220:223]
  v_mfma_f32_16x16x32_bf16 v[224:227], a[172:175], a[216:219], v[224:227]
  s_add_u32 m0, s28, 9216
  v_mfma_f32_16x16x32_bf16 v[228:231], a[172:175], a[220:223], v[228:231]
  buffer_load_dwordx4 v5, s[8:11], s31 offen offset:1024 lds
  v_mfma_f32_16x16x32_bf16 v[232:235], a[172:175], a[224:227], v[232:235]
  v_mfma_f32_16x16x32_bf16 v[236:239], a[172:175], a[228:231], v[236:239]
  v_mfma_f32_16x16x32_bf16 v[240:243], a[176:179], a[216:219], v[240:243]
  v_mfma_f32_16x16x32_bf16 v[244:247], a[176:179], a[220:223], v[244:247]
  buffer_load_dwordx4 v7, s[8:11], s31 offen offset:3072 lds
  v_mfma_f32_16x16x32_bf16 v[248:251], a[176:179], a[224:227], v[248:251]
  v_mfma_f32_16x16x32_bf16 v[252:255], a[176:179], a[228:231], v[252:255]
  s_waitcnt lgkmcnt(0)
  s_waitcnt vmcnt(11)
  v_mfma_f32_16x16x32_bf16 v[112:115], a[180:183], a[232:235], v[112:115]
  s_add_u32 m0, s28, 13312
  ds_read_b64_tr_b16 a[176:177], v30 offset:0
  ds_read_b64_tr_b16 a[178:179], v30 offset:256
  v_mfma_f32_16x16x32_bf16 v[116:119], a[180:183], a[236:239], v[116:119]
  buffer_load_dwordx4 v9, s[8:11], s31 offen offset:1024 lds
  v_mfma_f32_16x16x32_bf16 v[120:123], a[180:183], a[240:243], v[120:123]
  ds_read_b64_tr_b16 a[144:145], v22 offset:0
  ds_read_b64_tr_b16 a[148:149], v23 offset:0
  v_mfma_f32_16x16x32_bf16 v[124:127], a[180:183], a[244:247], v[124:127]
  ds_read_b64_tr_b16 a[152:153], v24 offset:0
  ds_read_b64_tr_b16 a[156:157], v25 offset:0
  v_mfma_f32_16x16x32_bf16 v[128:131], a[184:187], a[232:235], v[128:131]
  ds_read_b64_tr_b16 a[160:161], v26 offset:0
  ds_read_b64_tr_b16 a[164:165], v27 offset:0
  v_mfma_f32_16x16x32_bf16 v[132:135], a[184:187], a[236:239], v[132:135]
  buffer_load_dwordx4 v11, s[8:11], s31 offen offset:3072 lds
  v_mfma_f32_16x16x32_bf16 v[136:139], a[184:187], a[240:243], v[136:139]
  ds_read_b64_tr_b16 a[168:169], v28 offset:0
  ds_read_b64_tr_b16 a[172:173], v29 offset:0
  v_mfma_f32_16x16x32_bf16 v[140:143], a[184:187], a[244:247], v[140:143]
  s_waitcnt vmcnt(9)
  ds_read_b64_tr_b16 a[146:147], v22 offset:1024
  ds_read_b64_tr_b16 a[150:151], v23 offset:1024
  v_mfma_f32_16x16x32_bf16 v[144:147], a[188:191], a[232:235], v[144:147]
  ds_read_b64_tr_b16 a[154:155], v24 offset:1024
  ds_read_b64_tr_b16 a[158:159], v25 offset:1024
  s_waitcnt lgkmcnt(4)
  s_add_u32 s27, s30, 0
  s_add_u32 m0, s28, 8192
  v_mfma_f32_16x16x32_bf16 v[148:151], a[188:191], a[236:239], v[148:151]
  buffer_load_dwordx4 v21, s[12:15], s27 offen lds
  v_mfma_f32_16x16x32_bf16 v[152:155], a[188:191], a[240:243], v[152:155]
  ds_read_b64_tr_b16 a[162:163], v26 offset:1024
  ds_read_b64_tr_b16 a[166:167], v27 offset:1024
  v_mfma_f32_16x16x32_bf16 v[156:159], a[188:191], a[244:247], v[156:159]
  ds_read_b64_tr_b16 a[170:171], v28 offset:1024
  ds_read_b64_tr_b16 a[174:175], v29 offset:1024
  v_mfma_f32_16x16x32_bf16 v[160:163], a[192:195], a[232:235], v[160:163]
  ds_read_b128 a[216:219], v80 offset:16384
  s_add_u32 m0, s28, 0
  v_mfma_f32_16x16x32_bf16 v[164:167], a[192:195], a[236:239], v[164:167]
  buffer_load_dwordx4 v13, s[12:15], s27 offen lds
  v_mfma_f32_16x16x32_bf16 v[168:171], a[192:195], a[240:243], v[168:171]
  ds_read_b128 a[220:223], v80 offset:34816
  v_mfma_f32_16x16x32_bf16 v[172:175], a[192:195], a[244:247], v[172:175]
  ds_read_b128 a[224:227], v82 offset:16384
  v_mfma_f32_16x16x32_bf16 v[176:179], a[196:199], a[232:235], v[176:179]
  s_waitcnt lgkmcnt(3)
  ds_read_b128 a[228:231], v82 offset:34816
  v_mfma_f32_16x16x32_bf16 v[180:183], a[196:199], a[236:239], v[180:183]
  buffer_load_dwordx4 v15, s[12:15], s27 offen offset:2048 lds
  v_mfma_f32_16x16x32_bf16 v[184:187], a[196:199], a[240:243], v[184:187]
  v_mfma_f32_16x16x32_bf16 v[188:191], a[196:199], a[244:247], v[188:191]
  v_mfma_f32_16x16x32_bf16 v[192:195], a[200:203], a[232:235], v[192:195]
  s_add_u32 m0, s28, 4096
  v_mfma_f32_16x16x32_bf16 v[196:199], a[200:203], a[236:239], v[196:199]
  buffer_load_dwordx4 v17, s[12:15], s27 offen lds
  v_mfma_f32_16x16x32_bf16 v[200:203], a[200:203], a[240:243], v[200:203]
  v_mfma_f32_16x16x32_bf16 v[204:207], a[200:203], a[244:247], v[204:207]
  v_mfma_f32_16x16x32_bf16 v[208:211], a[204:207], a[232:235], v[208:211]
  v_mfma_f32_16x16x32_bf16 v[212:215], a[204:207], a[236:239], v[212:215]
  buffer_load_dwordx4 v19, s[12:15], s27 offen offset:2048 lds
  v_mfma_f32_16x16x32_bf16 v[216:219], a[204:207], a[240:243], v[216:219]
  v_mfma_f32_16x16x32_bf16 v[220:223], a[204:207], a[244:247], v[220:223]
  v_mfma_f32_16x16x32_bf16 v[224:227], a[208:211], a[232:235], v[224:227]
  s_add_u32 m0, s28, 0
  v_mfma_f32_16x16x32_bf16 v[228:231], a[208:211], a[236:239], v[228:231]
  buffer_load_dwordx4 v14, s[12:15], s27 offen offset:1024 lds
  v_mfma_f32_16x16x32_bf16 v[232:235], a[208:211], a[240:243], v[232:235]
  v_mfma_f32_16x16x32_bf16 v[236:239], a[208:211], a[244:247], v[236:239]
  v_mfma_f32_16x16x32_bf16 v[240:243], a[212:215], a[232:235], v[240:243]
  v_mfma_f32_16x16x32_bf16 v[244:247], a[212:215], a[236:239], v[244:247]
  buffer_load_dwordx4 v16, s[12:15], s27 offen offset:3072 lds
  v_mfma_f32_16x16x32_bf16 v[248:251], a[212:215], a[240:243], v[248:251]
  v_mfma_f32_16x16x32_bf16 v[252:255], a[212:215], a[244:247], v[252:255]
  s_waitcnt lgkmcnt(0)
  s_waitcnt vmcnt(11)
  v_mfma_f32_16x16x32_bf16 v[112:115], a[144:147], a[216:219], v[112:115]
  s_add_u32 m0, s28, 4096
  ds_read_b64_tr_b16 a[212:213], v30 offset:9216
  ds_read_b64_tr_b16 a[214:215], v30 offset:9472
  v_mfma_f32_16x16x32_bf16 v[116:119], a[144:147], a[220:223], v[116:119]
  buffer_load_dwordx4 v18, s[12:15], s27 offen offset:1024 lds
  v_mfma_f32_16x16x32_bf16 v[120:123], a[144:147], a[224:227], v[120:123]
  ds_read_b64_tr_b16 a[180:181], v22 offset:9216
  ds_read_b64_tr_b16 a[184:185], v23 offset:9216
  v_mfma_f32_16x16x32_bf16 v[124:127], a[144:147], a[228:231], v[124:127]
  ds_read_b64_tr_b16 a[188:189], v24 offset:9216
  ds_read_b64_tr_b16 a[192:193], v25 offset:9216
  v_mfma_f32_16x16x32_bf16 v[128:131], a[148:151], a[216:219], v[128:131]
  ds_read_b64_tr_b16 a[196:197], v26 offset:9216
  ds_read_b64_tr_b16 a[200:201], v27 offset:9216
  v_mfma_f32_16x16x32_bf16 v[132:135], a[148:151], a[220:223], v[132:135]
  buffer_load_dwordx4 v20, s[12:15], s27 offen offset:3072 lds
  v_mfma_f32_16x16x32_bf16 v[136:139], a[148:151], a[224:227], v[136:139]
  ds_read_b64_tr_b16 a[204:205], v28 offset:9216
  ds_read_b64_tr_b16 a[208:209], v29 offset:9216
  v_mfma_f32_16x16x32_bf16 v[140:143], a[148:151], a[228:231], v[140:143]
  s_waitcnt vmcnt(9)
  ds_read_b64_tr_b16 a[182:183], v22 offset:10240
  ds_read_b64_tr_b16 a[186:187], v23 offset:10240
  v_mfma_f32_16x16x32_bf16 v[144:147], a[152:155], a[216:219], v[144:147]
  ds_read_b64_tr_b16 a[190:191], v24 offset:10240
  ds_read_b64_tr_b16 a[194:195], v25 offset:10240
  s_waitcnt lgkmcnt(4)
  s_add_u32 s31, s30, 147456
  s_add_u32 m0, s28, 17408
  v_mfma_f32_16x16x32_bf16 v[148:151], a[152:155], a[220:223], v[148:151]
  buffer_load_dwordx4 v21, s[12:15], s31 offen lds
  v_mfma_f32_16x16x32_bf16 v[152:155], a[152:155], a[224:227], v[152:155]
  ds_read_b64_tr_b16 a[198:199], v26 offset:10240
  ds_read_b64_tr_b16 a[202:203], v27 offset:10240
  v_mfma_f32_16x16x32_bf16 v[156:159], a[152:155], a[228:231], v[156:159]
  ds_read_b64_tr_b16 a[206:207], v28 offset:10240
  ds_read_b64_tr_b16 a[210:211], v29 offset:10240
  v_mfma_f32_16x16x32_bf16 v[160:163], a[156:159], a[216:219], v[160:163]
  ds_read_b128 a[232:235], v81 offset:17408
  s_add_u32 m0, s28, 9216
  v_mfma_f32_16x16x32_bf16 v[164:167], a[156:159], a[220:223], v[164:167]
  buffer_load_dwordx4 v13, s[12:15], s31 offen lds
  v_mfma_f32_16x16x32_bf16 v[168:171], a[156:159], a[224:227], v[168:171]
  ds_read_b128 a[236:239], v81 offset:35840
  v_mfma_f32_16x16x32_bf16 v[172:175], a[156:159], a[228:231], v[172:175]
  ds_read_b128 a[240:243], v83 offset:17408
  v_mfma_f32_16x16x32_bf16 v[176:179], a[160:163], a[216:219], v[176:179]
  s_waitcnt lgkmcnt(3)
  ds_read_b128 a[244:247], v83 offset:35840
  v_mfma_f32_16x16x32_bf16 v[180:183], a[160:163], a[220:223], v[180:183]
  buffer_load_dwordx4 v15, s[12:15], s31 offen offset:2048 lds
  v_mfma_f32_16x16x32_bf16 v[184:187], a[160:163], a[224:227], v[184:187]
  v_mfma_f32_16x16x32_bf16 v[188:191], a[160:163], a[228:231], v[188:191]
  v_mfma_f32_16x16x32_bf16 v[192:195], a[164:167], a[216:219], v[192:195]
  s_add_u32 m0, s28, 13312
  v_mfma_f32_16x16x32_bf16 v[196:199], a[164:167], a[220:223], v[196:199]
  buffer_load_dwordx4 v17, s[12:15], s31 offen lds
  v_mfma_f32_16x16x32_bf16 v[200:203], a[164:167], a[224:227], v[200:203]
  v_mfma_f32_16x16x32_bf16 v[204:207], a[164:167], a[228:231], v[204:207]
  v_mfma_f32_16x16x32_bf16 v[208:211], a[168:171], a[216:219], v[208:211]
  v_mfma_f32_16x16x32_bf16 v[212:215], a[168:171], a[220:223], v[212:215]
  buffer_load_dwordx4 v19, s[12:15], s31 offen offset:2048 lds
  v_mfma_f32_16x16x32_bf16 v[216:219], a[168:171], a[224:227], v[216:219]
  v_mfma_f32_16x16x32_bf16 v[220:223], a[168:171], a[228:231], v[220:223]
  v_mfma_f32_16x16x32_bf16 v[224:227], a[172:175], a[216:219], v[224:227]
  s_add_u32 m0, s28, 9216
  v_mfma_f32_16x16x32_bf16 v[228:231], a[172:175], a[220:223], v[228:231]
  buffer_load_dwordx4 v14, s[12:15], s31 offen offset:1024 lds
  v_mfma_f32_16x16x32_bf16 v[232:235], a[172:175], a[224:227], v[232:235]
  v_mfma_f32_16x16x32_bf16 v[236:239], a[172:175], a[228:231], v[236:239]
  v_mfma_f32_16x16x32_bf16 v[240:243], a[176:179], a[216:219], v[240:243]
  v_mfma_f32_16x16x32_bf16 v[244:247], a[176:179], a[220:223], v[244:247]
  buffer_load_dwordx4 v16, s[12:15], s31 offen offset:3072 lds
  v_mfma_f32_16x16x32_bf16 v[248:251], a[176:179], a[224:227], v[248:251]
  v_mfma_f32_16x16x32_bf16 v[252:255], a[176:179], a[228:231], v[252:255]
  s_waitcnt lgkmcnt(0)
  s_waitcnt vmcnt(11)
  v_mfma_f32_16x16x32_bf16 v[112:115], a[180:183], a[232:235], v[112:115]
  s_add_u32 m0, s28, 13312
  ds_read_b64_tr_b16 a[176:177], v30 offset:0
  ds_read_b64_tr_b16 a[178:179], v30 offset:256
  v_mfma_f32_16x16x32_bf16 v[116:119], a[180:183], a[236:239], v[116:119]
  buffer_load_dwordx4 v18, s[12:15], s31 offen offset:1024 lds
  v_mfma_f32_16x16x32_bf16 v[120:123], a[180:183], a[240:243], v[120:123]
  ds_read_b64_tr_b16 a[144:145], v22 offset:0
  ds_read_b64_tr_b16 a[148:149], v23 offset:0
  v_mfma_f32_16x16x32_bf16 v[124:127], a[180:183], a[244:247], v[124:127]
  ds_read_b64_tr_b16 a[152:153], v24 offset:0
  ds_read_b64_tr_b16 a[156:157], v25 offset:0
  v_mfma_f32_16x16x32_bf16 v[128:131], a[184:187], a[232:235], v[128:131]
  ds_read_b64_tr_b16 a[160:161], v26 offset:0
  ds_read_b64_tr_b16 a[164:165], v27 offset:0
  v_mfma_f32_16x16x32_bf16 v[132:135], a[184:187], a[236:239], v[132:135]
  buffer_load_dwordx4 v20, s[12:15], s31 offen offset:3072 lds
  v_mfma_f32_16x16x32_bf16 v[136:139], a[184:187], a[240:243], v[136:139]
  ds_read_b64_tr_b16 a[168:169], v28 offset:0
  ds_read_b64_tr_b16 a[172:173], v29 offset:0
  v_mfma_f32_16x16x32_bf16 v[140:143], a[184:187], a[244:247], v[140:143]
  s_waitcnt vmcnt(9)
  ds_read_b64_tr_b16 a[146:147], v22 offset:1024
  ds_read_b64_tr_b16 a[150:151], v23 offset:1024
  v_mfma_f32_16x16x32_bf16 v[144:147], a[188:191], a[232:235], v[144:147]
  ds_read_b64_tr_b16 a[154:155], v24 offset:1024
  ds_read_b64_tr_b16 a[158:159], v25 offset:1024
  s_waitcnt lgkmcnt(4)
  s_add_u32 s27, s30, 294912
  s_add_u32 m0, s28, 8192
  v_mfma_f32_16x16x32_bf16 v[148:151], a[188:191], a[236:239], v[148:151]
  buffer_load_dwordx4 v21, s[12:15], s27 offen lds
  v_mfma_f32_16x16x32_bf16 v[152:155], a[188:191], a[240:243], v[152:155]
  ds_read_b64_tr_b16 a[162:163], v26 offset:1024
  ds_read_b64_tr_b16 a[166:167], v27 offset:1024
  v_mfma_f32_16x16x32_bf16 v[156:159], a[188:191], a[244:247], v[156:159]
  ds_read_b64_tr_b16 a[170:171], v28 offset:1024
  ds_read_b64_tr_b16 a[174:175], v29 offset:1024
  v_mfma_f32_16x16x32_bf16 v[160:163], a[192:195], a[232:235], v[160:163]
  s_add_u32 m0, s28, 0
  s_barrier
  v_mfma_f32_16x16x32_bf16 v[164:167], a[192:195], a[236:239], v[164:167]
  buffer_load_dwordx4 v13, s[12:15], s27 offen lds
  s_lshl_b32 s40, s2, 2
  s_add_u32 s40, s40, s24
  s_min_u32 s40, s40, 575
  s_lshl_b32 s41, s40, 12
  v_mfma_f32_16x16x32_bf16 v[168:171], a[192:195], a[240:243], v[168:171]
  v_and_b32 v79, 31, v2
  v_lshlrev_b32 v79, 7, v79
  v_exp_f32 v40, v112
  v_exp_f32 v41, v113
  v_exp_f32 v42, v114
  v_mfma_f32_16x16x32_bf16 v[172:175], a[192:195], a[244:247], v[172:175]
  v_exp_f32 v43, v115
  v_add_f32 v40, 1.0, v40
  v_add_f32 v41, 1.0, v41
  v_add_f32 v42, 1.0, v42
  v_add_f32 v43, 1.0, v43
  v_rcp_f32 v40, v40
  v_mfma_f32_16x16x32_bf16 v[176:179], a[196:199], a[232:235], v[176:179]
  s_waitcnt lgkmcnt(0)
  v_rcp_f32 v41, v41
  v_rcp_f32 v42, v42
  v_rcp_f32 v43, v43
  v_mfma_f32_16x16x32_bf16 v[180:183], a[196:199], a[236:239], v[180:183]
  buffer_load_dwordx4 v15, s[12:15], s27 offen offset:2048 lds
  v_mul_f32 v40, v112, v40
  v_mul_f32 v41, v113, v41
  v_mul_f32 v42, v114, v42
  v_mul_f32 v43, v115, v43
  v_mfma_f32_16x16x32_bf16 v[184:187], a[196:199], a[240:243], v[184:187]
  v_cvt_pk_bf16_f32 v44, v40, v41
  v_cvt_pk_bf16_f32 v45, v42, v43
  v_exp_f32 v48, v116
  v_exp_f32 v49, v117
  v_exp_f32 v50, v118
  v_mfma_f32_16x16x32_bf16 v[188:191], a[196:199], a[244:247], v[188:191]
  ds_write_b64 v33, v[44:45] offset:0
  v_exp_f32 v51, v119
  v_add_f32 v48, 1.0, v48
  v_add_f32 v49, 1.0, v49
  v_mfma_f32_16x16x32_bf16 v[192:195], a[200:203], a[232:235], v[192:195]
  s_add_u32 m0, s28, 4096
  v_add_f32 v50, 1.0, v50
  v_add_f32 v51, 1.0, v51
  v_rcp_f32 v48, v48
  v_rcp_f32 v49, v49
  v_mfma_f32_16x16x32_bf16 v[196:199], a[200:203], a[236:239], v[196:199]
  buffer_load_dwordx4 v17, s[12:15], s27 offen lds
  v_rcp_f32 v50, v50
  v_rcp_f32 v51, v51
  v_mul_f32 v48, v116, v48
  v_mfma_f32_16x16x32_bf16 v[200:203], a[200:203], a[240:243], v[200:203]
  v_mul_f32 v49, v117, v49
  v_mul_f32 v50, v118, v50
  v_mul_f32 v51, v119, v51
  v_cvt_pk_bf16_f32 v52, v48, v49
  v_cvt_pk_bf16_f32 v53, v50, v51
  v_exp_f32 v56, v120
  v_mfma_f32_16x16x32_bf16 v[204:207], a[200:203], a[244:247], v[204:207]
  ds_write_b64 v33, v[52:53] offset:18432
  v_exp_f32 v57, v121
  v_exp_f32 v58, v122
  v_mfma_f32_16x16x32_bf16 v[208:211], a[204:207], a[232:235], v[208:211]
  v_exp_f32 v59, v123
  v_add_f32 v56, 1.0, v56
  v_add_f32 v57, 1.0, v57
  v_add_f32 v58, 1.0, v58
  v_add_f32 v59, 1.0, v59
  v_rcp_f32 v56, v56
  v_mfma_f32_16x16x32_bf16 v[212:215], a[204:207], a[236:239], v[212:215]
  buffer_load_dwordx4 v19, s[12:15], s27 offen offset:2048 lds
  v_rcp_f32 v57, v57
  v_rcp_f32 v58, v58
  v_mfma_f32_16x16x32_bf16 v[216:219], a[204:207], a[240:243], v[216:219]
  v_rcp_f32 v59, v59
  v_mul_f32 v56, v120, v56
  v_mul_f32 v57, v121, v57
  v_mul_f32 v58, v122, v58
  v_mul_f32 v59, v123, v59
  v_cvt_pk_bf16_f32 v60, v56, v57
  v_cvt_pk_bf16_f32 v61, v58, v59
  v_mfma_f32_16x16x32_bf16 v[220:223], a[204:207], a[244:247], v[220:223]
  ds_write_b64 v33, v[60:61] offset:36864
  v_exp_f32 v64, v124
  v_exp_f32 v65, v125
  v_mfma_f32_16x16x32_bf16 v[224:227], a[208:211], a[232:235], v[224:227]
  s_add_u32 m0, s28, 0
  v_exp_f32 v66, v126
  v_exp_f32 v67, v127
  v_add_f32 v64, 1.0, v64
  v_add_f32 v65, 1.0, v65
  v_add_f32 v66, 1.0, v66
  v_mfma_f32_16x16x32_bf16 v[228:231], a[208:211], a[236:239], v[228:231]
  buffer_load_dwordx4 v14, s[12:15], s27 offen offset:1024 lds
  v_add_f32 v67, 1.0, v67
  v_rcp_f32 v64, v64
  v_mfma_f32_16x16x32_bf16 v[232:235], a[208:211], a[240:243], v[232:235]
  v_rcp_f32 v65, v65
  v_rcp_f32 v66, v66
  v_rcp_f32 v67, v67
  v_mul_f32 v64, v124, v64
  v_mul_f32 v65, v125, v65
  v_mul_f32 v66, v126, v66
  v_mfma_f32_16x16x32_bf16 v[236:239], a[208:211], a[244:247], v[236:239]
  v_mul_f32 v67, v127, v67
  v_cvt_pk_bf16_f32 v68, v64, v65
  v_cvt_pk_bf16_f32 v69, v66, v67
  v_exp_f32 v40, v128
  v_exp_f32 v41, v129
  v_mfma_f32_16x16x32_bf16 v[240:243], a[212:215], a[232:235], v[240:243]
  ds_write_b64 v33, v[68:69] offset:55296
  v_exp_f32 v42, v130
  v_exp_f32 v43, v131
  v_mfma_f32_16x16x32_bf16 v[244:247], a[212:215], a[236:239], v[244:247]
  buffer_load_dwordx4 v16, s[12:15], s27 offen offset:3072 lds
  v_add_f32 v40, 1.0, v40
  v_add_f32 v41, 1.0, v41
  v_add_f32 v42, 1.0, v42
  v_add_f32 v43, 1.0, v43
  v_mfma_f32_16x16x32_bf16 v[248:251], a[212:215], a[240:243], v[248:251]
  buffer_load_dword v98, v79, s[20:23], s41 offen
  v_rcp_f32 v40, v40
  v_rcp_f32 v41, v41
  v_mfma_f32_16x16x32_bf16 v[252:255], a[212:215], a[244:247], v[252:255]
  v_rcp_f32 v42, v42
  v_rcp_f32 v43, v43
  v_mul_f32 v40, v128, v40
  v_mul_f32 v41, v129, v41
  v_mul_f32 v42, v130, v42
  v_mul_f32 v43, v131, v43
  v_cvt_pk_bf16_f32 v44, v40, v41
  v_cvt_pk_bf16_f32 v45, v42, v43
  ds_write_b64 v33, v[44:45] offset:512
  v_exp_f32 v48, v132
  v_exp_f32 v49, v133
  v_exp_f32 v50, v134
  v_exp_f32 v51, v135
  v_add_f32 v48, 1.0, v48
  v_add_f32 v49, 1.0, v49
  v_add_f32 v50, 1.0, v50
  v_add_f32 v51, 1.0, v51
  v_rcp_f32 v48, v48
  v_rcp_f32 v49, v49
  v_rcp_f32 v50, v50
  v_rcp_f32 v51, v51
  v_mul_f32 v48, v132, v48
  v_mul_f32 v49, v133, v49
  v_mul_f32 v50, v134, v50
  v_mul_f32 v51, v135, v51
  v_cvt_pk_bf16_f32 v52, v48, v49
  v_cvt_pk_bf16_f32 v53, v50, v51
  ds_write_b64 v33, v[52:53] offset:18944
  v_exp_f32 v56, v136
  v_exp_f32 v57, v137
  v_exp_f32 v58, v138
  v_exp_f32 v59, v139
  v_add_f32 v56, 1.0, v56
  v_add_f32 v57, 1.0, v57
  v_add_f32 v58, 1.0, v58
  v_add_f32 v59, 1.0, v59
  v_rcp_f32 v56, v56
  v_rcp_f32 v57, v57
  v_rcp_f32 v58, v58
  v_rcp_f32 v59, v59
  v_mul_f32 v56, v136, v56
  v_mul_f32 v57, v137, v57
  v_mul_f32 v58, v138, v58
  v_mul_f32 v59, v139, v59
  v_cvt_pk_bf16_f32 v60, v56, v57
  v_cvt_pk_bf16_f32 v61, v58, v59
  ds_write_b64 v33, v[60:61] offset:37376
  v_exp_f32 v64, v140
  v_exp_f32 v65, v141
  v_exp_f32 v66, v142
  v_exp_f32 v67, v143
  v_add_f32 v64, 1.0, v64
  v_add_f32 v65, 1.0, v65
  v_add_f32 v66, 1.0, v66
  v_add_f32 v67, 1.0, v67
  v_rcp_f32 v64, v64
  v_rcp_f32 v65, v65
  v_rcp_f32 v66, v66
  v_rcp_f32 v67, v67
  v_mul_f32 v64, v140, v64
  v_mul_f32 v65, v141, v65
  v_mul_f32 v66, v142, v66
  v_mul_f32 v67, v143, v67
  v_cvt_pk_bf16_f32 v68, v64, v65
  v_cvt_pk_bf16_f32 v69, v66, v67
  ds_write_b64 v33, v[68:69] offset:55808
  s_waitcnt vmcnt(9)
  s_waitcnt lgkmcnt(0)
  s_barrier
  s_cmp_lt_u32 s2, 144
  s_cbranch_scc1 KV_DONE
  s_cmp_lg_u32 s24, 0
  s_cbranch_scc1 KV_DONE
  v_mul_u32_u24 v38, 112, v2
  v_add_u32 v38, s100, v38
  v_cmp_lt_u32 vcc, 255, v38
  v_mov_b32 v39, s100
  s_nop 0
  v_cndmask_b32 v38, v38, v39, vcc
  v_and_b32 v39, 7, v38
  v_lshlrev_b32 v39, 7, v39
  v_lshrrev_b32 v38, 3, v38
  v_lshl_add_u32 v38, v38, 2, v39
  v_mov_b32 v39, s94
  s_mov_b32 s34, 4718592
  s_mov_b64 exec, 7
  buffer_store_dword v39, v38, s[16:19], s34 offen sc1
  s_mov_b64 exec, -1
KV_DONE:
  ds_read_b128 a[216:219], v31 offset:0
  ds_read_b128 a[220:223], v31 offset:18432
  ds_read_b128 a[224:227], v32 offset:0
  ds_read_b128 a[228:231], v32 offset:18432
  s_waitcnt lgkmcnt(0)
  v_mfma_f32_16x16x32_bf16 a[0:3], a[144:147], a[216:219], 0
  s_add_u32 m0, s28, 4096
  ds_read_b64_tr_b16 a[212:213], v30 offset:9216
  ds_read_b64_tr_b16 a[214:215], v30 offset:9472
  v_mfma_f32_16x16x32_bf16 a[4:7], a[144:147], a[220:223], 0
  buffer_load_dwordx4 v18, s[12:15], s27 offen offset:1024 lds
  v_exp_f32 v40, v144
  v_mfma_f32_16x16x32_bf16 a[8:11], a[144:147], a[224:227], 0
  ds_read_b64_tr_b16 a[180:181], v22 offset:9216
  ds_read_b64_tr_b16 a[184:185], v23 offset:9216
  v_mfma_f32_16x16x32_bf16 a[12:15], a[144:147], a[228:231], 0
  ds_read_b64_tr_b16 a[188:189], v24 offset:9216
  ds_read_b64_tr_b16 a[192:193], v25 offset:9216
  v_exp_f32 v41, v145
  v_mfma_f32_16x16x32_bf16 a[16:19], a[148:151], a[216:219], 0
  ds_read_b64_tr_b16 a[196:197], v26 offset:9216
  ds_read_b64_tr_b16 a[200:201], v27 offset:9216
  v_mfma_f32_16x16x32_bf16 a[20:23], a[148:151], a[220:223], 0
  buffer_load_dwordx4 v20, s[12:15], s27 offen offset:3072 lds
  v_exp_f32 v42, v146
  v_mfma_f32_16x16x32_bf16 a[24:27], a[148:151], a[224:227], 0
  ds_read_b64_tr_b16 a[204:205], v28 offset:9216
  ds_read_b64_tr_b16 a[208:209], v29 offset:9216
  v_mfma_f32_16x16x32_bf16 a[28:31], a[148:151], a[228:231], 0
  s_waitcnt vmcnt(10)
  ds_read_b64_tr_b16 a[182:183], v22 offset:10240
  ds_read_b64_tr_b16 a[186:187], v23 offset:10240
  v_mfma_f32_16x16x32_bf16 a[32:35], a[152:155], a[216:219], 0
  ds_read_b64_tr_b16 a[190:191], v24 offset:10240
  ds_read_b64_tr_b16 a[194:195], v25 offset:10240
  s_waitcnt lgkmcnt(4)
  s_add_u32 s31, s30, 442368
  s_add_u32 m0, s28, 17408
  v_mfma_f32_16x16x32_bf16 a[36:39], a[152:155], a[220:223], 0
  buffer_load_dwordx4 v21, s[12:15], s31 offen lds
  v_mfma_f32_16x16x32_bf16 a[40:43], a[152:155], a[224:227], 0
  ds_read_b64_tr_b16 a[198:199], v26 offset:10240
  ds_read_b64_tr_b16 a[202:203], v27 offset:10240
  v_mfma_f32_16x16x32_bf16 a[44:47], a[152:155], a[228:231], 0
  ds_read_b64_tr_b16 a[206:207], v28 offset:10240
  ds_read_b64_tr_b16 a[210:211], v29 offset:10240
  v_exp_f32 v43, v147
  v_mfma_f32_16x16x32_bf16 a[48:51], a[156:159], a[216:219], 0
  ds_read_b128 a[232:235], v31 offset:4096
  s_add_u32 m0, s28, 9216
  v_add_f32 v40, 1.0, v40
  v_mfma_f32_16x16x32_bf16 a[52:55], a[156:159], a[220:223], 0
  buffer_load_dwordx4 v13, s[12:15], s31 offen lds
  v_add_f32 v41, 1.0, v41
  v_mfma_f32_16x16x32_bf16 a[56:59], a[156:159], a[224:227], 0
  ds_read_b128 a[236:239], v31 offset:22528
  v_add_f32 v42, 1.0, v42
  v_add_f32 v43, 1.0, v43
  v_rcp_f32 v40, v40
  v_mfma_f32_16x16x32_bf16 a[60:63], a[156:159], a[228:231], 0
  ds_read_b128 a[240:243], v32 offset:4096
  v_rcp_f32 v41, v41
  v_mfma_f32_16x16x32_bf16 a[64:67], a[160:163], a[216:219], 0
  s_waitcnt lgkmcnt(3)
  ds_read_b128 a[244:247], v32 offset:22528
  v_rcp_f32 v42, v42
  v_mfma_f32_16x16x32_bf16 a[68:71], a[160:163], a[220:223], 0
  buffer_load_dwordx4 v15, s[12:15], s31 offen offset:2048 lds
  v_rcp_f32 v43, v43
  v_mfma_f32_16x16x32_bf16 a[72:75], a[160:163], a[224:227], 0
  v_mul_f32 v40, v144, v40
  v_mul_f32 v41, v145, v41
  v_mul_f32 v42, v146, v42
  v_mul_f32 v43, v147, v43
  v_mfma_f32_16x16x32_bf16 a[76:79], a[160:163], a[228:231], 0
  v_cvt_pk_bf16_f32 v44, v40, v41
  v_cvt_pk_bf16_f32 v45, v42, v43
  v_exp_f32 v48, v148
  v_exp_f32 v49, v149
  v_mfma_f32_16x16x32_bf16 a[80:83], a[164:167], a[216:219], 0
  s_add_u32 m0, s28, 13312
  ds_write_b64 v33, v[44:45] offset:1024
  v_mfma_f32_16x16x32_bf16 a[84:87], a[164:167], a[220:223], 0
  buffer_load_dwordx4 v17, s[12:15], s31 offen lds
  v_mfma_f32_16x16x32_bf16 a[88:91], a[164:167], a[224:227], 0
  v_exp_f32 v50, v150
  v_exp_f32 v51, v151
  v_add_f32 v48, 1.0, v48
  v_mfma_f32_16x16x32_bf16 a[92:95], a[164:167], a[228:231], 0
  v_add_f32 v49, 1.0, v49
  v_add_f32 v50, 1.0, v50
  v_add_f32 v51, 1.0, v51
  v_rcp_f32 v48, v48
  v_mfma_f32_16x16x32_bf16 a[96:99], a[168:171], a[216:219], 0
  v_rcp_f32 v49, v49
  v_rcp_f32 v50, v50
  v_mfma_f32_16x16x32_bf16 a[100:103], a[168:171], a[220:223], 0
  buffer_load_dwordx4 v19, s[12:15], s31 offen offset:2048 lds
  v_rcp_f32 v51, v51
  v_mfma_f32_16x16x32_bf16 a[104:107], a[168:171], a[224:227], 0
  v_mul_f32 v48, v148, v48
  v_mul_f32 v49, v149, v49
  v_mul_f32 v50, v150, v50
  v_mul_f32 v51, v151, v51
  v_cvt_pk_bf16_f32 v52, v48, v49
  v_mfma_f32_16x16x32_bf16 a[108:111], a[168:171], a[228:231], 0
  v_cvt_pk_bf16_f32 v53, v50, v51
  v_exp_f32 v56, v152
  v_exp_f32 v57, v153
  v_mfma_f32_16x16x32_bf16 a[112:115], a[172:175], a[216:219], 0
  s_add_u32 m0, s28, 9216
  ds_write_b64 v33, v[52:53] offset:19456
  v_mfma_f32_16x16x32_bf16 a[116:119], a[172:175], a[220:223], 0
  buffer_load_dwordx4 v14, s[12:15], s31 offen offset:1024 lds
  v_exp_f32 v58, v154
  v_mfma_f32_16x16x32_bf16 a[120:123], a[172:175], a[224:227], 0
  v_exp_f32 v59, v155
  v_add_f32 v56, 1.0, v56
  v_add_f32 v57, 1.0, v57
  v_mfma_f32_16x16x32_bf16 a[124:127], a[172:175], a[228:231], 0
  v_add_f32 v58, 1.0, v58
  v_add_f32 v59, 1.0, v59
  v_rcp_f32 v56, v56
  v_rcp_f32 v57, v57
  v_mfma_f32_16x16x32_bf16 a[128:131], a[176:179], a[216:219], 0
  v_rcp_f32 v58, v58
  v_rcp_f32 v59, v59
  v_mfma_f32_16x16x32_bf16 a[132:135], a[176:179], a[220:223], 0
  buffer_load_dwordx4 v16, s[12:15], s31 offen offset:3072 lds
  v_mul_f32 v56, v152, v56
  v_mfma_f32_16x16x32_bf16 a[136:139], a[176:179], a[224:227], 0
  v_mul_f32 v57, v153, v57
  v_mul_f32 v58, v154, v58
  v_mul_f32 v59, v155, v59
  v_cvt_pk_bf16_f32 v60, v56, v57
  v_cvt_pk_bf16_f32 v61, v58, v59
  v_mfma_f32_16x16x32_bf16 a[140:143], a[176:179], a[228:231], 0
  s_waitcnt lgkmcnt(2)
  ds_write_b64 v33, v[60:61] offset:37888
  s_waitcnt vmcnt(12)
  v_mfma_f32_16x16x32_bf16 a[0:3], a[180:183], a[232:235], a[0:3]
  s_add_u32 m0, s28, 13312
  ds_read_b64_tr_b16 a[176:177], v30 offset:0
  ds_read_b64_tr_b16 a[178:179], v30 offset:256
  v_mfma_f32_16x16x32_bf16 a[4:7], a[180:183], a[236:239], a[4:7]
  buffer_load_dwordx4 v18, s[12:15], s31 offen offset:1024 lds
  v_exp_f32 v64, v156
  v_mfma_f32_16x16x32_bf16 a[8:11], a[180:183], a[240:243], a[8:11]
  ds_read_b64_tr_b16 a[144:145], v22 offset:0
  ds_read_b64_tr_b16 a[148:149], v23 offset:0
  v_mfma_f32_16x16x32_bf16 a[12:15], a[180:183], a[244:247], a[12:15]
  ds_read_b64_tr_b16 a[152:153], v24 offset:0
  ds_read_b64_tr_b16 a[156:157], v25 offset:0
  v_exp_f32 v65, v157
  v_mfma_f32_16x16x32_bf16 a[16:19], a[184:187], a[232:235], a[16:19]
  ds_read_b64_tr_b16 a[160:161], v26 offset:0
  ds_read_b64_tr_b16 a[164:165], v27 offset:0
  v_mfma_f32_16x16x32_bf16 a[20:23], a[184:187], a[236:239], a[20:23]
  buffer_load_dwordx4 v20, s[12:15], s31 offen offset:3072 lds
  v_exp_f32 v66, v158
  v_mfma_f32_16x16x32_bf16 a[24:27], a[184:187], a[240:243], a[24:27]
  ds_read_b64_tr_b16 a[168:169], v28 offset:0
  ds_read_b64_tr_b16 a[172:173], v29 offset:0
  v_mfma_f32_16x16x32_bf16 a[28:31], a[184:187], a[244:247], a[28:31]
  s_waitcnt vmcnt(9)
  ds_read_b64_tr_b16 a[146:147], v22 offset:1024
  ds_read_b64_tr_b16 a[150:151], v23 offset:1024
  v_mfma_f32_16x16x32_bf16 a[32:35], a[188:191], a[232:235], a[32:35]
  ds_read_b64_tr_b16 a[154:155], v24 offset:1024
  ds_read_b64_tr_b16 a[158:159], v25 offset:1024
  s_waitcnt lgkmcnt(4)
  s_add_u32 s27, s30, 36864
  s_add_u32 m0, s28, 8192
  v_mfma_f32_16x16x32_bf16 a[36:39], a[188:191], a[236:239], a[36:39]
  buffer_load_dwordx4 v21, s[12:15], s27 offen lds
  v_mfma_f32_16x16x32_bf16 a[40:43], a[188:191], a[240:243], a[40:43]
  ds_read_b64_tr_b16 a[162:163], v26 offset:1024
  ds_read_b64_tr_b16 a[166:167], v27 offset:1024
  v_mfma_f32_16x16x32_bf16 a[44:47], a[188:191], a[244:247], a[44:47]
  ds_read_b64_tr_b16 a[170:171], v28 offset:1024
  ds_read_b64_tr_b16 a[174:175], v29 offset:1024
  v_exp_f32 v67, v159
  v_mfma_f32_16x16x32_bf16 a[48:51], a[192:195], a[232:235], a[48:51]
  ds_read_b128 a[216:219], v31 offset:8192
  s_add_u32 m0, s28, 0
  v_add_f32 v64, 1.0, v64
  v_mfma_f32_16x16x32_bf16 a[52:55], a[192:195], a[236:239], a[52:55]
  buffer_load_dwordx4 v13, s[12:15], s27 offen lds
  v_add_f32 v65, 1.0, v65
  v_mfma_f32_16x16x32_bf16 a[56:59], a[192:195], a[240:243], a[56:59]
  ds_read_b128 a[220:223], v31 offset:26624
  v_add_f32 v66, 1.0, v66
  v_add_f32 v67, 1.0, v67
  v_rcp_f32 v64, v64
  v_mfma_f32_16x16x32_bf16 a[60:63], a[192:195], a[244:247], a[60:63]
  ds_read_b128 a[224:227], v32 offset:8192
  v_rcp_f32 v65, v65
  v_mfma_f32_16x16x32_bf16 a[64:67], a[196:199], a[232:235], a[64:67]
  s_waitcnt lgkmcnt(3)
  ds_read_b128 a[228:231], v32 offset:26624
  v_rcp_f32 v66, v66
  v_mfma_f32_16x16x32_bf16 a[68:71], a[196:199], a[236:239], a[68:71]
  buffer_load_dwordx4 v15, s[12:15], s27 offen offset:2048 lds
  v_rcp_f32 v67, v67
  v_mfma_f32_16x16x32_bf16 a[72:75], a[196:199], a[240:243], a[72:75]
  v_mul_f32 v64, v156, v64
  v_mul_f32 v65, v157, v65
  v_mul_f32 v66, v158, v66
  v_mul_f32 v67, v159, v67
  v_mfma_f32_16x16x32_bf16 a[76:79], a[196:199], a[244:247], a[76:79]
  v_cvt_pk_bf16_f32 v68, v64, v65
  v_cvt_pk_bf16_f32 v69, v66, v67
  v_exp_f32 v40, v160
  v_exp_f32 v41, v161
  v_mfma_f32_16x16x32_bf16 a[80:83], a[200:203], a[232:235], a[80:83]
  s_add_u32 m0, s28, 4096
  ds_write_b64 v33, v[68:69] offset:56320
  v_mfma_f32_16x16x32_bf16 a[84:87], a[200:203], a[236:239], a[84:87]
  buffer_load_dwordx4 v17, s[12:15], s27 offen lds
  v_mfma_f32_16x16x32_bf16 a[88:91], a[200:203], a[240:243], a[88:91]
  v_exp_f32 v42, v162
  v_exp_f32 v43, v163
  v_add_f32 v40, 1.0, v40
  v_mfma_f32_16x16x32_bf16 a[92:95], a[200:203], a[244:247], a[92:95]
  v_add_f32 v41, 1.0, v41
  v_add_f32 v42, 1.0, v42
  v_add_f32 v43, 1.0, v43
  v_rcp_f32 v40, v40
  v_mfma_f32_16x16x32_bf16 a[96:99], a[204:207], a[232:235], a[96:99]
  v_rcp_f32 v41, v41
  v_rcp_f32 v42, v42
  v_mfma_f32_16x16x32_bf16 a[100:103], a[204:207], a[236:239], a[100:103]
  buffer_load_dwordx4 v19, s[12:15], s27 offen offset:2048 lds
  v_rcp_f32 v43, v43
  v_mfma_f32_16x16x32_bf16 a[104:107], a[204:207], a[240:243], a[104:107]
  v_mul_f32 v40, v160, v40
  v_mul_f32 v41, v161, v41
  v_mul_f32 v42, v162, v42
  v_mul_f32 v43, v163, v43
  v_cvt_pk_bf16_f32 v44, v40, v41
  v_mfma_f32_16x16x32_bf16 a[108:111], a[204:207], a[244:247], a[108:111]
  v_cvt_pk_bf16_f32 v45, v42, v43
  v_exp_f32 v48, v164
  v_exp_f32 v49, v165
  v_mfma_f32_16x16x32_bf16 a[112:115], a[208:211], a[232:235], a[112:115]
  s_add_u32 m0, s28, 0
  ds_write_b64 v33, v[44:45] offset:1536
  v_mfma_f32_16x16x32_bf16 a[116:119], a[208:211], a[236:239], a[116:119]
  buffer_load_dwordx4 v14, s[12:15], s27 offen offset:1024 lds
  v_exp_f32 v50, v166
  v_mfma_f32_16x16x32_bf16 a[120:123], a[208:211], a[240:243], a[120:123]
  v_exp_f32 v51, v167
  v_add_f32 v48, 1.0, v48
  v_add_f32 v49, 1.0, v49
  v_mfma_f32_16x16x32_bf16 a[124:127], a[208:211], a[244:247], a[124:127]
  v_add_f32 v50, 1.0, v50
  v_add_f32 v51, 1.0, v51
  v_rcp_f32 v48, v48
  v_rcp_f32 v49, v49
  v_mfma_f32_16x16x32_bf16 a[128:131], a[212:215], a[232:235], a[128:131]
  v_rcp_f32 v50, v50
  v_rcp_f32 v51, v51
  v_mfma_f32_16x16x32_bf16 a[132:135], a[212:215], a[236:239], a[132:135]
  buffer_load_dwordx4 v16, s[12:15], s27 offen offset:3072 lds
  v_mul_f32 v48, v164, v48
  v_mfma_f32_16x16x32_bf16 a[136:139], a[212:215], a[240:243], a[136:139]
  v_mul_f32 v49, v165, v49
  v_mul_f32 v50, v166, v50
  v_mul_f32 v51, v167, v51
  v_cvt_pk_bf16_f32 v52, v48, v49
  v_cvt_pk_bf16_f32 v53, v50, v51
  v_mfma_f32_16x16x32_bf16 a[140:143], a[212:215], a[244:247], a[140:143]
  s_waitcnt lgkmcnt(2)
  ds_write_b64 v33, v[52:53] offset:19968
  s_waitcnt vmcnt(11)
  v_mfma_f32_16x16x32_bf16 a[0:3], a[144:147], a[216:219], a[0:3]
  s_add_u32 m0, s28, 4096
  ds_read_b64_tr_b16 a[212:213], v30 offset:9216
  ds_read_b64_tr_b16 a[214:215], v30 offset:9472
  v_mfma_f32_16x16x32_bf16 a[4:7], a[144:147], a[220:223], a[4:7]
  buffer_load_dwordx4 v18, s[12:15], s27 offen offset:1024 lds
  v_mfma_f32_16x16x32_bf16 a[8:11], a[144:147], a[224:227], a[8:11]
  ds_read_b64_tr_b16 a[180:181], v22 offset:9216
  ds_read_b64_tr_b16 a[184:185], v23 offset:9216
  v_mfma_f32_16x16x32_bf16 a[12:15], a[144:147], a[228:231], a[12:15]
  ds_read_b64_tr_b16 a[188:189], v24 offset:9216
  ds_read_b64_tr_b16 a[192:193], v25 offset:9216
  v_mfma_f32_16x16x32_bf16 a[16:19], a[148:151], a[216:219], a[16:19]
  ds_read_b64_tr_b16 a[196:197], v26 offset:9216
  ds_read_b64_tr_b16 a[200:201], v27 offset:9216
  v_mfma_f32_16x16x32_bf16 a[20:23], a[148:151], a[220:223], a[20:23]
  buffer_load_dwordx4 v20, s[12:15], s27 offen offset:3072 lds
  v_mfma_f32_16x16x32_bf16 a[24:27], a[148:151], a[224:227], a[24:27]
  ds_read_b64_tr_b16 a[204:205], v28 offset:9216
  ds_read_b64_tr_b16 a[208:209], v29 offset:9216
  v_exp_f32 v56, v168
  v_mfma_f32_16x16x32_bf16 a[28:31], a[148:151], a[228:231], a[28:31]
  s_waitcnt vmcnt(9)
  ds_read_b64_tr_b16 a[182:183], v22 offset:10240
  ds_read_b64_tr_b16 a[186:187], v23 offset:10240
  v_mfma_f32_16x16x32_bf16 a[32:35], a[152:155], a[216:219], a[32:35]
  ds_read_b64_tr_b16 a[190:191], v24 offset:10240
  ds_read_b64_tr_b16 a[194:195], v25 offset:10240
  s_waitcnt lgkmcnt(4)
  s_add_u32 s31, s30, 184320
  s_add_u32 m0, s28, 17408
  v_mfma_f32_16x16x32_bf16 a[36:39], a[152:155], a[220:223], a[36:39]
  buffer_load_dwordx4 v21, s[12:15], s31 offen lds
  v_mfma_f32_16x16x32_bf16 a[40:43], a[152:155], a[224:227], a[40:43]
  ds_read_b64_tr_b16 a[198:199], v26 offset:10240
  ds_read_b64_tr_b16 a[202:203], v27 offset:10240
  v_mfma_f32_16x16x32_bf16 a[44:47], a[152:155], a[228:231], a[44:47]
  ds_read_b64_tr_b16 a[206:207], v28 offset:10240
  ds_read_b64_tr_b16 a[210:211], v29 offset:10240
  v_mfma_f32_16x16x32_bf16 a[48:51], a[156:159], a[216:219], a[48:51]
  ds_read_b128 a[232:235], v31 offset:12288
  s_add_u32 m0, s28, 9216
  v_mfma_f32_16x16x32_bf16 a[52:55], a[156:159], a[220:223], a[52:55]
  buffer_load_dwordx4 v13, s[12:15], s31 offen lds
  v_mfma_f32_16x16x32_bf16 a[56:59], a[156:159], a[224:227], a[56:59]
  ds_read_b128 a[236:239], v31 offset:30720
  v_mfma_f32_16x16x32_bf16 a[60:63], a[156:159], a[228:231], a[60:63]
  ds_read_b128 a[240:243], v32 offset:12288
  v_exp_f32 v57, v169
  v_mfma_f32_16x16x32_bf16 a[64:67], a[160:163], a[216:219], a[64:67]
  s_waitcnt lgkmcnt(3)
  ds_read_b128 a[244:247], v32 offset:30720
  v_exp_f32 v58, v170
  v_mfma_f32_16x16x32_bf16 a[68:71], a[160:163], a[220:223], a[68:71]
  buffer_load_dwordx4 v15, s[12:15], s31 offen offset:2048 lds
  v_mfma_f32_16x16x32_bf16 a[72:75], a[160:163], a[224:227], a[72:75]
  v_exp_f32 v59, v171
  v_add_f32 v56, 1.0, v56
  v_add_f32 v57, 1.0, v57
  v_add_f32 v58, 1.0, v58
  v_mfma_f32_16x16x32_bf16 a[76:79], a[160:163], a[228:231], a[76:79]
  v_add_f32 v59, 1.0, v59
  v_rcp_f32 v56, v56
  v_rcp_f32 v57, v57
  v_mfma_f32_16x16x32_bf16 a[80:83], a[164:167], a[216:219], a[80:83]
  s_add_u32 m0, s28, 13312
  v_rcp_f32 v58, v58
  v_mfma_f32_16x16x32_bf16 a[84:87], a[164:167], a[220:223], a[84:87]
  buffer_load_dwordx4 v17, s[12:15], s31 offen lds
  v_mfma_f32_16x16x32_bf16 a[88:91], a[164:167], a[224:227], a[88:91]
  v_rcp_f32 v59, v59
  v_mul_f32 v56, v168, v56
  v_mul_f32 v57, v169, v57
  v_mul_f32 v58, v170, v58
  v_mfma_f32_16x16x32_bf16 a[92:95], a[164:167], a[228:231], a[92:95]
  v_mul_f32 v59, v171, v59
  v_cvt_pk_bf16_f32 v60, v56, v57
  v_cvt_pk_bf16_f32 v61, v58, v59
  v_mfma_f32_16x16x32_bf16 a[96:99], a[168:171], a[216:219], a[96:99]
  ds_write_b64 v33, v[60:61] offset:38400
  v_exp_f32 v64, v172
  v_mfma_f32_16x16x32_bf16 a[100:103], a[168:171], a[220:223], a[100:103]
  buffer_load_dwordx4 v19, s[12:15], s31 offen offset:2048 lds
  v_mfma_f32_16x16x32_bf16 a[104:107], a[168:171], a[224:227], a[104:107]
  v_exp_f32 v65, v173
  v_exp_f32 v66, v174
  v_mfma_f32_16x16x32_bf16 a[108:111], a[168:171], a[228:231], a[108:111]
  v_exp_f32 v67, v175
  v_add_f32 v64, 1.0, v64
  v_add_f32 v65, 1.0, v65
  v_add_f32 v66, 1.0, v66
  v_mfma_f32_16x16x32_bf16 a[112:115], a[172:175], a[216:219], a[112:115]
  s_add_u32 m0, s28, 9216
  v_add_f32 v67, 1.0, v67
  v_rcp_f32 v64, v64
  v_mfma_f32_16x16x32_bf16 a[116:119], a[172:175], a[220:223], a[116:119]
  buffer_load_dwordx4 v14, s[12:15], s31 offen offset:1024 lds
  v_mfma_f32_16x16x32_bf16 a[120:123], a[172:175], a[224:227], a[120:123]
  v_rcp_f32 v65, v65
  v_rcp_f32 v66, v66
  v_mfma_f32_16x16x32_bf16 a[124:127], a[172:175], a[228:231], a[124:127]
  v_rcp_f32 v67, v67
  v_mul_f32 v64, v172, v64
  v_mul_f32 v65, v173, v65
  v_mul_f32 v66, v174, v66
  v_mfma_f32_16x16x32_bf16 a[128:131], a[176:179], a[216:219], a[128:131]
  v_mul_f32 v67, v175, v67
  v_cvt_pk_bf16_f32 v68, v64, v65
  v_cvt_pk_bf16_f32 v69, v66, v67
  v_mfma_f32_16x16x32_bf16 a[132:135], a[176:179], a[220:223], a[132:135]
  buffer_load_dwordx4 v16, s[12:15], s31 offen offset:3072 lds
  v_mfma_f32_16x16x32_bf16 a[136:139], a[176:179], a[224:227], a[136:139]
  ds_write_b64 v33, v[68:69] offset:56832
  v_mov_b32 v78, 1
  v_mfma_f32_16x16x32_bf16 a[140:143], a[176:179], a[228:231], a[140:143]
  s_waitcnt lgkmcnt(2)
  ds_write_b32 v110, v78
  s_waitcnt vmcnt(11)
  v_mfma_f32_16x16x32_bf16 a[0:3], a[180:183], a[232:235], a[0:3]
  s_add_u32 m0, s28, 13312
  ds_read_b64_tr_b16 a[176:177], v30 offset:0
  ds_read_b64_tr_b16 a[178:179], v30 offset:256
  v_mfma_f32_16x16x32_bf16 a[4:7], a[180:183], a[236:239], a[4:7]
  buffer_load_dwordx4 v18, s[12:15], s31 offen offset:1024 lds
  v_mfma_f32_16x16x32_bf16 a[8:11], a[180:183], a[240:243], a[8:11]
  ds_read_b64_tr_b16 a[144:145], v22 offset:0
  ds_read_b64_tr_b16 a[148:149], v23 offset:0
  v_mfma_f32_16x16x32_bf16 a[12:15], a[180:183], a[244:247], a[12:15]
  ds_read_b64_tr_b16 a[152:153], v24 offset:0
  ds_read_b64_tr_b16 a[156:157], v25 offset:0
  v_mfma_f32_16x16x32_bf16 a[16:19], a[184:187], a[232:235], a[16:19]
  ds_read_b64_tr_b16 a[160:161], v26 offset:0
  ds_read_b64_tr_b16 a[164:165], v27 offset:0
  v_mfma_f32_16x16x32_bf16 a[20:23], a[184:187], a[236:239], a[20:23]
  buffer_load_dwordx4 v20, s[12:15], s31 offen offset:3072 lds
  v_mfma_f32_16x16x32_bf16 a[24:27], a[184:187], a[240:243], a[24:27]
  ds_read_b64_tr_b16 a[168:169], v28 offset:0
  ds_read_b64_tr_b16 a[172:173], v29 offset:0
  v_mfma_f32_16x16x32_bf16 a[28:31], a[184:187], a[244:247], a[28:31]
  s_waitcnt vmcnt(9)
  ds_read_b64_tr_b16 a[146:147], v22 offset:1024
  ds_read_b64_tr_b16 a[150:151], v23 offset:1024
  v_mfma_f32_16x16x32_bf16 a[32:35], a[188:191], a[232:235], a[32:35]
  ds_read_b64_tr_b16 a[154:155], v24 offset:1024
  ds_read_b64_tr_b16 a[158:159], v25 offset:1024
  s_waitcnt lgkmcnt(4)
  s_add_u32 s27, s30, 331776
  s_add_u32 m0, s28, 8192
  v_mfma_f32_16x16x32_bf16 a[36:39], a[188:191], a[236:239], a[36:39]
  buffer_load_dwordx4 v21, s[12:15], s27 offen lds
  v_mfma_f32_16x16x32_bf16 a[40:43], a[188:191], a[240:243], a[40:43]
  ds_read_b64_tr_b16 a[162:163], v26 offset:1024
  ds_read_b64_tr_b16 a[166:167], v27 offset:1024
  v_mfma_f32_16x16x32_bf16 a[44:47], a[188:191], a[244:247], a[44:47]
  ds_read_b64_tr_b16 a[170:171], v28 offset:1024
  ds_read_b64_tr_b16 a[174:175], v29 offset:1024
  v_mfma_f32_16x16x32_bf16 a[48:51], a[192:195], a[232:235], a[48:51]
  s_add_u32 m0, s28, 0
  v_mfma_f32_16x16x32_bf16 a[52:55], a[192:195], a[236:239], a[52:55]
  buffer_load_dwordx4 v13, s[12:15], s27 offen lds
  v_mfma_f32_16x16x32_bf16 a[56:59], a[192:195], a[240:243], a[56:59]
  v_mfma_f32_16x16x32_bf16 a[60:63], a[192:195], a[244:247], a[60:63]
  v_mfma_f32_16x16x32_bf16 a[64:67], a[196:199], a[232:235], a[64:67]
  s_waitcnt lgkmcnt(0)
  v_mfma_f32_16x16x32_bf16 a[68:71], a[196:199], a[236:239], a[68:71]
  buffer_load_dwordx4 v15, s[12:15], s27 offen offset:2048 lds
  v_mfma_f32_16x16x32_bf16 a[72:75], a[196:199], a[240:243], a[72:75]
  ds_read_b128 v[72:75], v111
  v_mfma_f32_16x16x32_bf16 a[76:79], a[196:199], a[244:247], a[76:79]
  v_mfma_f32_16x16x32_bf16 a[80:83], a[200:203], a[232:235], a[80:83]
  s_add_u32 m0, s28, 4096
  v_mfma_f32_16x16x32_bf16 a[84:87], a[200:203], a[236:239], a[84:87]
  buffer_load_dwordx4 v17, s[12:15], s27 offen lds
  v_mfma_f32_16x16x32_bf16 a[88:91], a[200:203], a[240:243], a[88:91]
  v_mfma_f32_16x16x32_bf16 a[92:95], a[200:203], a[244:247], a[92:95]
  v_mfma_f32_16x16x32_bf16 a[96:99], a[204:207], a[232:235], a[96:99]
  s_waitcnt lgkmcnt(0)
  v_min3_u32 v72, v72, v73, v74
  v_min_u32 v72, v72, v75
  s_nop 0
  v_readfirstlane_b32 s34, v72
  s_nop 1
  s_cmp_ge_u32 s34, 1
  s_cbranch_scc1 FG21_OK
  FG21_SPIN:
  ds_read_b128 v[72:75], v111
  s_waitcnt lgkmcnt(0)
  v_min3_u32 v72, v72, v73, v74
  v_min_u32 v72, v72, v75
  s_nop 0
  v_readfirstlane_b32 s34, v72
  s_nop 1
  s_cmp_lt_u32 s34, 1
  s_cbranch_scc1 FG21_SPIN
  FG21_OK:
  v_mfma_f32_16x16x32_bf16 a[100:103], a[204:207], a[236:239], a[100:103]
  buffer_load_dwordx4 v19, s[12:15], s27 offen offset:2048 lds
  v_mfma_f32_16x16x32_bf16 a[104:107], a[204:207], a[240:243], a[104:107]
  ds_read_b128 a[216:219], v31 offset:1024
  v_mfma_f32_16x16x32_bf16 a[108:111], a[204:207], a[244:247], a[108:111]
  ds_read_b128 a[220:223], v31 offset:19456
  v_mfma_f32_16x16x32_bf16 a[112:115], a[208:211], a[232:235], a[112:115]
  s_add_u32 m0, s28, 0
  ds_read_b128 a[224:227], v32 offset:1024
  v_mfma_f32_16x16x32_bf16 a[116:119], a[208:211], a[236:239], a[116:119]
  buffer_load_dwordx4 v14, s[12:15], s27 offen offset:1024 lds
  v_mfma_f32_16x16x32_bf16 a[120:123], a[208:211], a[240:243], a[120:123]
  ds_read_b128 a[228:231], v32 offset:19456
  v_mfma_f32_16x16x32_bf16 a[124:127], a[208:211], a[244:247], a[124:127]
  v_mfma_f32_16x16x32_bf16 a[128:131], a[212:215], a[232:235], a[128:131]
  v_mfma_f32_16x16x32_bf16 a[132:135], a[212:215], a[236:239], a[132:135]
  buffer_load_dwordx4 v16, s[12:15], s27 offen offset:3072 lds
  v_mfma_f32_16x16x32_bf16 a[136:139], a[212:215], a[240:243], a[136:139]
  v_mfma_f32_16x16x32_bf16 a[140:143], a[212:215], a[244:247], a[140:143]
  s_waitcnt lgkmcnt(0)
  s_waitcnt vmcnt(11)
  v_mfma_f32_16x16x32_bf16 a[0:3], a[144:147], a[216:219], a[0:3]
  s_add_u32 m0, s28, 4096
  ds_read_b64_tr_b16 a[212:213], v30 offset:9216
  ds_read_b64_tr_b16 a[214:215], v30 offset:9472
  v_mfma_f32_16x16x32_bf16 a[4:7], a[144:147], a[220:223], a[4:7]
  buffer_load_dwordx4 v18, s[12:15], s27 offen offset:1024 lds
  v_exp_f32 v40, v176
  v_mfma_f32_16x16x32_bf16 a[8:11], a[144:147], a[224:227], a[8:11]
  ds_read_b64_tr_b16 a[180:181], v22 offset:9216
  ds_read_b64_tr_b16 a[184:185], v23 offset:9216
  v_mfma_f32_16x16x32_bf16 a[12:15], a[144:147], a[228:231], a[12:15]
  ds_read_b64_tr_b16 a[188:189], v24 offset:9216
  ds_read_b64_tr_b16 a[192:193], v25 offset:9216
  v_exp_f32 v41, v177
  v_mfma_f32_16x16x32_bf16 a[16:19], a[148:151], a[216:219], a[16:19]
  ds_read_b64_tr_b16 a[196:197], v26 offset:9216
  ds_read_b64_tr_b16 a[200:201], v27 offset:9216
  v_mfma_f32_16x16x32_bf16 a[20:23], a[148:151], a[220:223], a[20:23]
  buffer_load_dwordx4 v20, s[12:15], s27 offen offset:3072 lds
  v_exp_f32 v42, v178
  v_mfma_f32_16x16x32_bf16 a[24:27], a[148:151], a[224:227], a[24:27]
  ds_read_b64_tr_b16 a[204:205], v28 offset:9216
  ds_read_b64_tr_b16 a[208:209], v29 offset:9216
  v_mfma_f32_16x16x32_bf16 a[28:31], a[148:151], a[228:231], a[28:31]
  s_waitcnt vmcnt(9)
  ds_read_b64_tr_b16 a[182:183], v22 offset:10240
  ds_read_b64_tr_b16 a[186:187], v23 offset:10240
  v_mfma_f32_16x16x32_bf16 a[32:35], a[152:155], a[216:219], a[32:35]
  ds_read_b64_tr_b16 a[190:191], v24 offset:10240
  ds_read_b64_tr_b16 a[194:195], v25 offset:10240
  s_waitcnt lgkmcnt(4)
  s_add_u32 s31, s30, 479232
  s_add_u32 m0, s28, 17408
  v_mfma_f32_16x16x32_bf16 a[36:39], a[152:155], a[220:223], a[36:39]
  buffer_load_dwordx4 v21, s[12:15], s31 offen lds
  v_mfma_f32_16x16x32_bf16 a[40:43], a[152:155], a[224:227], a[40:43]
  ds_read_b64_tr_b16 a[198:199], v26 offset:10240
  ds_read_b64_tr_b16 a[202:203], v27 offset:10240
  v_mfma_f32_16x16x32_bf16 a[44:47], a[152:155], a[228:231], a[44:47]
  ds_read_b64_tr_b16 a[206:207], v28 offset:10240
  ds_read_b64_tr_b16 a[210:211], v29 offset:10240
  v_exp_f32 v43, v179
  v_mfma_f32_16x16x32_bf16 a[48:51], a[156:159], a[216:219], a[48:51]
  ds_read_b128 a[232:235], v31 offset:5120
  s_add_u32 m0, s28, 9216
  v_add_f32 v40, 1.0, v40
  v_mfma_f32_16x16x32_bf16 a[52:55], a[156:159], a[220:223], a[52:55]
  buffer_load_dwordx4 v13, s[12:15], s31 offen lds
  v_add_f32 v41, 1.0, v41
  v_mfma_f32_16x16x32_bf16 a[56:59], a[156:159], a[224:227], a[56:59]
  ds_read_b128 a[236:239], v31 offset:23552
  v_add_f32 v42, 1.0, v42
  v_add_f32 v43, 1.0, v43
  v_rcp_f32 v40, v40
  v_mfma_f32_16x16x32_bf16 a[60:63], a[156:159], a[228:231], a[60:63]
  ds_read_b128 a[240:243], v32 offset:5120
  v_rcp_f32 v41, v41
  v_mfma_f32_16x16x32_bf16 a[64:67], a[160:163], a[216:219], a[64:67]
  s_waitcnt lgkmcnt(3)
  ds_read_b128 a[244:247], v32 offset:23552
  v_rcp_f32 v42, v42
  v_mfma_f32_16x16x32_bf16 a[68:71], a[160:163], a[220:223], a[68:71]
  buffer_load_dwordx4 v15, s[12:15], s31 offen offset:2048 lds
  v_rcp_f32 v43, v43
  v_mfma_f32_16x16x32_bf16 a[72:75], a[160:163], a[224:227], a[72:75]
  v_mul_f32 v40, v176, v40
  v_mul_f32 v41, v177, v41
  v_mul_f32 v42, v178, v42
  v_mul_f32 v43, v179, v43
  v_mfma_f32_16x16x32_bf16 a[76:79], a[160:163], a[228:231], a[76:79]
  v_cvt_pk_bf16_f32 v44, v40, v41
  v_cvt_pk_bf16_f32 v45, v42, v43
  v_exp_f32 v48, v180
  v_exp_f32 v49, v181
  v_mfma_f32_16x16x32_bf16 a[80:83], a[164:167], a[216:219], a[80:83]
  s_add_u32 m0, s28, 13312
  ds_write_b64 v33, v[44:45] offset:2048
  v_mfma_f32_16x16x32_bf16 a[84:87], a[164:167], a[220:223], a[84:87]
  buffer_load_dwordx4 v17, s[12:15], s31 offen lds
  v_mfma_f32_16x16x32_bf16 a[88:91], a[164:167], a[224:227], a[88:91]
  v_exp_f32 v50, v182
  v_exp_f32 v51, v183
  v_add_f32 v48, 1.0, v48
  v_mfma_f32_16x16x32_bf16 a[92:95], a[164:167], a[228:231], a[92:95]
  v_add_f32 v49, 1.0, v49
  v_add_f32 v50, 1.0, v50
  v_add_f32 v51, 1.0, v51
  v_rcp_f32 v48, v48
  v_mfma_f32_16x16x32_bf16 a[96:99], a[168:171], a[216:219], a[96:99]
  v_rcp_f32 v49, v49
  v_rcp_f32 v50, v50
  v_mfma_f32_16x16x32_bf16 a[100:103], a[168:171], a[220:223], a[100:103]
  buffer_load_dwordx4 v19, s[12:15], s31 offen offset:2048 lds
  v_rcp_f32 v51, v51
  v_mfma_f32_16x16x32_bf16 a[104:107], a[168:171], a[224:227], a[104:107]
  v_mul_f32 v48, v180, v48
  v_mul_f32 v49, v181, v49
  v_mul_f32 v50, v182, v50
  v_mul_f32 v51, v183, v51
  v_cvt_pk_bf16_f32 v52, v48, v49
  v_mfma_f32_16x16x32_bf16 a[108:111], a[168:171], a[228:231], a[108:111]
  v_cvt_pk_bf16_f32 v53, v50, v51
  v_exp_f32 v56, v184
  v_exp_f32 v57, v185
  v_mfma_f32_16x16x32_bf16 a[112:115], a[172:175], a[216:219], a[112:115]
  s_add_u32 m0, s28, 9216
  ds_write_b64 v33, v[52:53] offset:20480
  v_mfma_f32_16x16x32_bf16 a[116:119], a[172:175], a[220:223], a[116:119]
  buffer_load_dwordx4 v14, s[12:15], s31 offen offset:1024 lds
  v_exp_f32 v58, v186
  v_mfma_f32_16x16x32_bf16 a[120:123], a[172:175], a[224:227], a[120:123]
  v_exp_f32 v59, v187
  v_add_f32 v56, 1.0, v56
  v_add_f32 v57, 1.0, v57
  v_mfma_f32_16x16x32_bf16 a[124:127], a[172:175], a[228:231], a[124:127]
  v_add_f32 v58, 1.0, v58
  v_add_f32 v59, 1.0, v59
  v_rcp_f32 v56, v56
  v_rcp_f32 v57, v57
  v_mfma_f32_16x16x32_bf16 a[128:131], a[176:179], a[216:219], a[128:131]
  v_rcp_f32 v58, v58
  v_rcp_f32 v59, v59
  v_mfma_f32_16x16x32_bf16 a[132:135], a[176:179], a[220:223], a[132:135]
  buffer_load_dwordx4 v16, s[12:15], s31 offen offset:3072 lds
  v_mul_f32 v56, v184, v56
  v_mfma_f32_16x16x32_bf16 a[136:139], a[176:179], a[224:227], a[136:139]
  v_mul_f32 v57, v185, v57
  v_mul_f32 v58, v186, v58
  v_mul_f32 v59, v187, v59
  v_cvt_pk_bf16_f32 v60, v56, v57
  v_cvt_pk_bf16_f32 v61, v58, v59
  v_mfma_f32_16x16x32_bf16 a[140:143], a[176:179], a[228:231], a[140:143]
  s_waitcnt lgkmcnt(2)
  ds_write_b64 v33, v[60:61] offset:38912
  s_waitcnt vmcnt(11)
  v_mfma_f32_16x16x32_bf16 a[0:3], a[180:183], a[232:235], a[0:3]
  s_add_u32 m0, s28, 13312
  ds_read_b64_tr_b16 a[176:177], v30 offset:0
  ds_read_b64_tr_b16 a[178:179], v30 offset:256
  v_mfma_f32_16x16x32_bf16 a[4:7], a[180:183], a[236:239], a[4:7]
  buffer_load_dwordx4 v18, s[12:15], s31 offen offset:1024 lds
  v_exp_f32 v64, v188
  v_mfma_f32_16x16x32_bf16 a[8:11], a[180:183], a[240:243], a[8:11]
  ds_read_b64_tr_b16 a[144:145], v22 offset:0
  ds_read_b64_tr_b16 a[148:149], v23 offset:0
  v_mfma_f32_16x16x32_bf16 a[12:15], a[180:183], a[244:247], a[12:15]
  ds_read_b64_tr_b16 a[152:153], v24 offset:0
  ds_read_b64_tr_b16 a[156:157], v25 offset:0
  v_exp_f32 v65, v189
  v_mfma_f32_16x16x32_bf16 a[16:19], a[184:187], a[232:235], a[16:19]
  ds_read_b64_tr_b16 a[160:161], v26 offset:0
  ds_read_b64_tr_b16 a[164:165], v27 offset:0
  v_mfma_f32_16x16x32_bf16 a[20:23], a[184:187], a[236:239], a[20:23]
  buffer_load_dwordx4 v20, s[12:15], s31 offen offset:3072 lds
  v_exp_f32 v66, v190
  v_mfma_f32_16x16x32_bf16 a[24:27], a[184:187], a[240:243], a[24:27]
  ds_read_b64_tr_b16 a[168:169], v28 offset:0
  ds_read_b64_tr_b16 a[172:173], v29 offset:0
  v_mfma_f32_16x16x32_bf16 a[28:31], a[184:187], a[244:247], a[28:31]
  s_waitcnt vmcnt(9)
  ds_read_b64_tr_b16 a[146:147], v22 offset:1024
  ds_read_b64_tr_b16 a[150:151], v23 offset:1024
  v_mfma_f32_16x16x32_bf16 a[32:35], a[188:191], a[232:235], a[32:35]
  ds_read_b64_tr_b16 a[154:155], v24 offset:1024
  ds_read_b64_tr_b16 a[158:159], v25 offset:1024
  s_waitcnt lgkmcnt(4)
  s_add_u32 s27, s30, 73728
  s_add_u32 m0, s28, 8192
  v_mfma_f32_16x16x32_bf16 a[36:39], a[188:191], a[236:239], a[36:39]
  buffer_load_dwordx4 v21, s[12:15], s27 offen lds
  v_mfma_f32_16x16x32_bf16 a[40:43], a[188:191], a[240:243], a[40:43]
  ds_read_b64_tr_b16 a[162:163], v26 offset:1024
  ds_read_b64_tr_b16 a[166:167], v27 offset:1024
  v_mfma_f32_16x16x32_bf16 a[44:47], a[188:191], a[244:247], a[44:47]
  ds_read_b64_tr_b16 a[170:171], v28 offset:1024
  ds_read_b64_tr_b16 a[174:175], v29 offset:1024
  v_exp_f32 v67, v191
  v_mfma_f32_16x16x32_bf16 a[48:51], a[192:195], a[232:235], a[48:51]
  ds_read_b128 a[216:219], v31 offset:9216
  s_add_u32 m0, s28, 0
  v_add_f32 v64, 1.0, v64
  v_mfma_f32_16x16x32_bf16 a[52:55], a[192:195], a[236:239], a[52:55]
  buffer_load_dwordx4 v13, s[12:15], s27 offen lds
  v_add_f32 v65, 1.0, v65
  v_mfma_f32_16x16x32_bf16 a[56:59], a[192:195], a[240:243], a[56:59]
  ds_read_b128 a[220:223], v31 offset:27648
  v_add_f32 v66, 1.0, v66
  v_add_f32 v67, 1.0, v67
  v_rcp_f32 v64, v64
  v_mfma_f32_16x16x32_bf16 a[60:63], a[192:195], a[244:247], a[60:63]
  ds_read_b128 a[224:227], v32 offset:9216
  v_rcp_f32 v65, v65
  v_mfma_f32_16x16x32_bf16 a[64:67], a[196:199], a[232:235], a[64:67]
  s_waitcnt lgkmcnt(3)
  ds_read_b128 a[228:231], v32 offset:27648
  v_rcp_f32 v66, v66
  v_mfma_f32_16x16x32_bf16 a[68:71], a[196:199], a[236:239], a[68:71]
  buffer_load_dwordx4 v15, s[12:15], s27 offen offset:2048 lds
  v_rcp_f32 v67, v67
  v_mfma_f32_16x16x32_bf16 a[72:75], a[196:199], a[240:243], a[72:75]
  v_mul_f32 v64, v188, v64
  v_mul_f32 v65, v189, v65
  v_mul_f32 v66, v190, v66
  v_mul_f32 v67, v191, v67
  v_mfma_f32_16x16x32_bf16 a[76:79], a[196:199], a[244:247], a[76:79]
  v_cvt_pk_bf16_f32 v68, v64, v65
  v_cvt_pk_bf16_f32 v69, v66, v67
  v_exp_f32 v40, v192
  v_exp_f32 v41, v193
  v_mfma_f32_16x16x32_bf16 a[80:83], a[200:203], a[232:235], a[80:83]
  s_add_u32 m0, s28, 4096
  ds_write_b64 v33, v[68:69] offset:57344
  v_mfma_f32_16x16x32_bf16 a[84:87], a[200:203], a[236:239], a[84:87]
  buffer_load_dwordx4 v17, s[12:15], s27 offen lds
  v_mfma_f32_16x16x32_bf16 a[88:91], a[200:203], a[240:243], a[88:91]
  v_exp_f32 v42, v194
  v_exp_f32 v43, v195
  v_add_f32 v40, 1.0, v40
  v_mfma_f32_16x16x32_bf16 a[92:95], a[200:203], a[244:247], a[92:95]
  v_add_f32 v41, 1.0, v41
  v_add_f32 v42, 1.0, v42
  v_add_f32 v43, 1.0, v43
  v_rcp_f32 v40, v40
  v_mfma_f32_16x16x32_bf16 a[96:99], a[204:207], a[232:235], a[96:99]
  v_rcp_f32 v41, v41
  v_rcp_f32 v42, v42
  v_mfma_f32_16x16x32_bf16 a[100:103], a[204:207], a[236:239], a[100:103]
  buffer_load_dwordx4 v19, s[12:15], s27 offen offset:2048 lds
  v_rcp_f32 v43, v43
  v_mfma_f32_16x16x32_bf16 a[104:107], a[204:207], a[240:243], a[104:107]
  v_mul_f32 v40, v192, v40
  v_mul_f32 v41, v193, v41
  v_mul_f32 v42, v194, v42
  v_mul_f32 v43, v195, v43
  v_cvt_pk_bf16_f32 v44, v40, v41
  v_mfma_f32_16x16x32_bf16 a[108:111], a[204:207], a[244:247], a[108:111]
  v_cvt_pk_bf16_f32 v45, v42, v43
  v_exp_f32 v48, v196
  v_exp_f32 v49, v197
  v_mfma_f32_16x16x32_bf16 a[112:115], a[208:211], a[232:235], a[112:115]
  s_add_u32 m0, s28, 0
  ds_write_b64 v33, v[44:45] offset:2560
  v_mfma_f32_16x16x32_bf16 a[116:119], a[208:211], a[236:239], a[116:119]
  buffer_load_dwordx4 v14, s[12:15], s27 offen offset:1024 lds
  v_exp_f32 v50, v198
  v_mfma_f32_16x16x32_bf16 a[120:123], a[208:211], a[240:243], a[120:123]
  v_exp_f32 v51, v199
  v_add_f32 v48, 1.0, v48
  v_add_f32 v49, 1.0, v49
  v_mfma_f32_16x16x32_bf16 a[124:127], a[208:211], a[244:247], a[124:127]
  v_add_f32 v50, 1.0, v50
  v_add_f32 v51, 1.0, v51
  v_rcp_f32 v48, v48
  v_rcp_f32 v49, v49
  v_mfma_f32_16x16x32_bf16 a[128:131], a[212:215], a[232:235], a[128:131]
  v_rcp_f32 v50, v50
  v_rcp_f32 v51, v51
  v_mfma_f32_16x16x32_bf16 a[132:135], a[212:215], a[236:239], a[132:135]
  buffer_load_dwordx4 v16, s[12:15], s27 offen offset:3072 lds
  v_mul_f32 v48, v196, v48
  v_mfma_f32_16x16x32_bf16 a[136:139], a[212:215], a[240:243], a[136:139]
  v_mul_f32 v49, v197, v49
  v_mul_f32 v50, v198, v50
  v_mul_f32 v51, v199, v51
  v_cvt_pk_bf16_f32 v52, v48, v49
  v_cvt_pk_bf16_f32 v53, v50, v51
  v_mfma_f32_16x16x32_bf16 a[140:143], a[212:215], a[244:247], a[140:143]
  s_waitcnt lgkmcnt(2)
  ds_write_b64 v33, v[52:53] offset:20992
  s_waitcnt vmcnt(11)
  v_mfma_f32_16x16x32_bf16 a[0:3], a[144:147], a[216:219], a[0:3]
  s_add_u32 m0, s28, 4096
  ds_read_b64_tr_b16 a[212:213], v30 offset:9216
  ds_read_b64_tr_b16 a[214:215], v30 offset:9472
  v_mfma_f32_16x16x32_bf16 a[4:7], a[144:147], a[220:223], a[4:7]
  buffer_load_dwordx4 v18, s[12:15], s27 offen offset:1024 lds
  v_mfma_f32_16x16x32_bf16 a[8:11], a[144:147], a[224:227], a[8:11]
  ds_read_b64_tr_b16 a[180:181], v22 offset:9216
  ds_read_b64_tr_b16 a[184:185], v23 offset:9216
  v_mfma_f32_16x16x32_bf16 a[12:15], a[144:147], a[228:231], a[12:15]
  ds_read_b64_tr_b16 a[188:189], v24 offset:9216
  ds_read_b64_tr_b16 a[192:193], v25 offset:9216
  v_mfma_f32_16x16x32_bf16 a[16:19], a[148:151], a[216:219], a[16:19]
  ds_read_b64_tr_b16 a[196:197], v26 offset:9216
  ds_read_b64_tr_b16 a[200:201], v27 offset:9216
  v_mfma_f32_16x16x32_bf16 a[20:23], a[148:151], a[220:223], a[20:23]
  buffer_load_dwordx4 v20, s[12:15], s27 offen offset:3072 lds
  v_mfma_f32_16x16x32_bf16 a[24:27], a[148:151], a[224:227], a[24:27]
  ds_read_b64_tr_b16 a[204:205], v28 offset:9216
  ds_read_b64_tr_b16 a[208:209], v29 offset:9216
  v_exp_f32 v56, v200
  v_mfma_f32_16x16x32_bf16 a[28:31], a[148:151], a[228:231], a[28:31]
  s_waitcnt vmcnt(9)
  ds_read_b64_tr_b16 a[182:183], v22 offset:10240
  ds_read_b64_tr_b16 a[186:187], v23 offset:10240
  v_mfma_f32_16x16x32_bf16 a[32:35], a[152:155], a[216:219], a[32:35]
  ds_read_b64_tr_b16 a[190:191], v24 offset:10240
  ds_read_b64_tr_b16 a[194:195], v25 offset:10240
  s_waitcnt lgkmcnt(4)
  s_add_u32 s31, s30, 221184
  s_add_u32 m0, s28, 17408
  v_mfma_f32_16x16x32_bf16 a[36:39], a[152:155], a[220:223], a[36:39]
  buffer_load_dwordx4 v21, s[12:15], s31 offen lds
  v_mfma_f32_16x16x32_bf16 a[40:43], a[152:155], a[224:227], a[40:43]
  ds_read_b64_tr_b16 a[198:199], v26 offset:10240
  ds_read_b64_tr_b16 a[202:203], v27 offset:10240
  v_mfma_f32_16x16x32_bf16 a[44:47], a[152:155], a[228:231], a[44:47]
  ds_read_b64_tr_b16 a[206:207], v28 offset:10240
  ds_read_b64_tr_b16 a[210:211], v29 offset:10240
  v_mfma_f32_16x16x32_bf16 a[48:51], a[156:159], a[216:219], a[48:51]
  ds_read_b128 a[232:235], v31 offset:13312
  s_add_u32 m0, s28, 9216
  v_mfma_f32_16x16x32_bf16 a[52:55], a[156:159], a[220:223], a[52:55]
  buffer_load_dwordx4 v13, s[12:15], s31 offen lds
  v_mfma_f32_16x16x32_bf16 a[56:59], a[156:159], a[224:227], a[56:59]
  ds_read_b128 a[236:239], v31 offset:31744
  v_mfma_f32_16x16x32_bf16 a[60:63], a[156:159], a[228:231], a[60:63]
  ds_read_b128 a[240:243], v32 offset:13312
  v_exp_f32 v57, v201
  v_mfma_f32_16x16x32_bf16 a[64:67], a[160:163], a[216:219], a[64:67]
  s_waitcnt lgkmcnt(3)
  ds_read_b128 a[244:247], v32 offset:31744
  v_exp_f32 v58, v202
  v_mfma_f32_16x16x32_bf16 a[68:71], a[160:163], a[220:223], a[68:71]
  buffer_load_dwordx4 v15, s[12:15], s31 offen offset:2048 lds
  v_mfma_f32_16x16x32_bf16 a[72:75], a[160:163], a[224:227], a[72:75]
  v_exp_f32 v59, v203
  v_add_f32 v56, 1.0, v56
  v_add_f32 v57, 1.0, v57
  v_add_f32 v58, 1.0, v58
  v_mfma_f32_16x16x32_bf16 a[76:79], a[160:163], a[228:231], a[76:79]
  v_add_f32 v59, 1.0, v59
  v_rcp_f32 v56, v56
  v_rcp_f32 v57, v57
  v_mfma_f32_16x16x32_bf16 a[80:83], a[164:167], a[216:219], a[80:83]
  s_add_u32 m0, s28, 13312
  v_rcp_f32 v58, v58
  v_mfma_f32_16x16x32_bf16 a[84:87], a[164:167], a[220:223], a[84:87]
  buffer_load_dwordx4 v17, s[12:15], s31 offen lds
  v_mfma_f32_16x16x32_bf16 a[88:91], a[164:167], a[224:227], a[88:91]
  v_rcp_f32 v59, v59
  v_mul_f32 v56, v200, v56
  v_mul_f32 v57, v201, v57
  v_mul_f32 v58, v202, v58
  v_mfma_f32_16x16x32_bf16 a[92:95], a[164:167], a[228:231], a[92:95]
  v_mul_f32 v59, v203, v59
  v_cvt_pk_bf16_f32 v60, v56, v57
  v_cvt_pk_bf16_f32 v61, v58, v59
  v_mfma_f32_16x16x32_bf16 a[96:99], a[168:171], a[216:219], a[96:99]
  ds_write_b64 v33, v[60:61] offset:39424
  v_exp_f32 v64, v204
  v_mfma_f32_16x16x32_bf16 a[100:103], a[168:171], a[220:223], a[100:103]
  buffer_load_dwordx4 v19, s[12:15], s31 offen offset:2048 lds
  v_mfma_f32_16x16x32_bf16 a[104:107], a[168:171], a[224:227], a[104:107]
  v_exp_f32 v65, v205
  v_exp_f32 v66, v206
  v_mfma_f32_16x16x32_bf16 a[108:111], a[168:171], a[228:231], a[108:111]
  v_exp_f32 v67, v207
  v_add_f32 v64, 1.0, v64
  v_add_f32 v65, 1.0, v65
  v_add_f32 v66, 1.0, v66
  v_mfma_f32_16x16x32_bf16 a[112:115], a[172:175], a[216:219], a[112:115]
  s_add_u32 m0, s28, 9216
  v_add_f32 v67, 1.0, v67
  v_rcp_f32 v64, v64
  v_mfma_f32_16x16x32_bf16 a[116:119], a[172:175], a[220:223], a[116:119]
  buffer_load_dwordx4 v14, s[12:15], s31 offen offset:1024 lds
  v_mfma_f32_16x16x32_bf16 a[120:123], a[172:175], a[224:227], a[120:123]
  v_rcp_f32 v65, v65
  v_rcp_f32 v66, v66
  v_mfma_f32_16x16x32_bf16 a[124:127], a[172:175], a[228:231], a[124:127]
  v_rcp_f32 v67, v67
  v_mul_f32 v64, v204, v64
  v_mul_f32 v65, v205, v65
  v_mul_f32 v66, v206, v66
  v_mfma_f32_16x16x32_bf16 a[128:131], a[176:179], a[216:219], a[128:131]
  v_mul_f32 v67, v207, v67
  v_cvt_pk_bf16_f32 v68, v64, v65
  v_cvt_pk_bf16_f32 v69, v66, v67
  v_mfma_f32_16x16x32_bf16 a[132:135], a[176:179], a[220:223], a[132:135]
  buffer_load_dwordx4 v16, s[12:15], s31 offen offset:3072 lds
  v_mfma_f32_16x16x32_bf16 a[136:139], a[176:179], a[224:227], a[136:139]
  ds_write_b64 v33, v[68:69] offset:57856
  v_mov_b32 v78, 2
  v_mfma_f32_16x16x32_bf16 a[140:143], a[176:179], a[228:231], a[140:143]
  s_waitcnt lgkmcnt(2)
  ds_write_b32 v110, v78
  s_waitcnt vmcnt(11)
  v_mfma_f32_16x16x32_bf16 a[0:3], a[180:183], a[232:235], a[0:3]
  s_add_u32 m0, s28, 13312
  ds_read_b64_tr_b16 a[176:177], v30 offset:0
  ds_read_b64_tr_b16 a[178:179], v30 offset:256
  v_mfma_f32_16x16x32_bf16 a[4:7], a[180:183], a[236:239], a[4:7]
  buffer_load_dwordx4 v18, s[12:15], s31 offen offset:1024 lds
  v_mfma_f32_16x16x32_bf16 a[8:11], a[180:183], a[240:243], a[8:11]
  ds_read_b64_tr_b16 a[144:145], v22 offset:0
  ds_read_b64_tr_b16 a[148:149], v23 offset:0
  v_mfma_f32_16x16x32_bf16 a[12:15], a[180:183], a[244:247], a[12:15]
  ds_read_b64_tr_b16 a[152:153], v24 offset:0
  ds_read_b64_tr_b16 a[156:157], v25 offset:0
  v_mfma_f32_16x16x32_bf16 a[16:19], a[184:187], a[232:235], a[16:19]
  ds_read_b64_tr_b16 a[160:161], v26 offset:0
  ds_read_b64_tr_b16 a[164:165], v27 offset:0
  v_mfma_f32_16x16x32_bf16 a[20:23], a[184:187], a[236:239], a[20:23]
  buffer_load_dwordx4 v20, s[12:15], s31 offen offset:3072 lds
  v_mfma_f32_16x16x32_bf16 a[24:27], a[184:187], a[240:243], a[24:27]
  ds_read_b64_tr_b16 a[168:169], v28 offset:0
  ds_read_b64_tr_b16 a[172:173], v29 offset:0
  v_mfma_f32_16x16x32_bf16 a[28:31], a[184:187], a[244:247], a[28:31]
  s_waitcnt vmcnt(9)
  ds_read_b64_tr_b16 a[146:147], v22 offset:1024
  ds_read_b64_tr_b16 a[150:151], v23 offset:1024
  v_mfma_f32_16x16x32_bf16 a[32:35], a[188:191], a[232:235], a[32:35]
  ds_read_b64_tr_b16 a[154:155], v24 offset:1024
  ds_read_b64_tr_b16 a[158:159], v25 offset:1024
  s_waitcnt lgkmcnt(4)
  s_add_u32 s27, s30, 368640
  s_add_u32 m0, s28, 8192
  v_mfma_f32_16x16x32_bf16 a[36:39], a[188:191], a[236:239], a[36:39]
  buffer_load_dwordx4 v21, s[12:15], s27 offen lds
  v_mfma_f32_16x16x32_bf16 a[40:43], a[188:191], a[240:243], a[40:43]
  ds_read_b64_tr_b16 a[162:163], v26 offset:1024
  ds_read_b64_tr_b16 a[166:167], v27 offset:1024
  v_mfma_f32_16x16x32_bf16 a[44:47], a[188:191], a[244:247], a[44:47]
  ds_read_b64_tr_b16 a[170:171], v28 offset:1024
  ds_read_b64_tr_b16 a[174:175], v29 offset:1024
  v_mfma_f32_16x16x32_bf16 a[48:51], a[192:195], a[232:235], a[48:51]
  s_add_u32 m0, s28, 0
  v_mfma_f32_16x16x32_bf16 a[52:55], a[192:195], a[236:239], a[52:55]
  buffer_load_dwordx4 v13, s[12:15], s27 offen lds
  v_mfma_f32_16x16x32_bf16 a[56:59], a[192:195], a[240:243], a[56:59]
  v_mfma_f32_16x16x32_bf16 a[60:63], a[192:195], a[244:247], a[60:63]
  v_mfma_f32_16x16x32_bf16 a[64:67], a[196:199], a[232:235], a[64:67]
  s_waitcnt lgkmcnt(0)
  v_mfma_f32_16x16x32_bf16 a[68:71], a[196:199], a[236:239], a[68:71]
  buffer_load_dwordx4 v15, s[12:15], s27 offen offset:2048 lds
  v_mfma_f32_16x16x32_bf16 a[72:75], a[196:199], a[240:243], a[72:75]
  ds_read_b128 v[72:75], v111
  v_mfma_f32_16x16x32_bf16 a[76:79], a[196:199], a[244:247], a[76:79]
  v_mfma_f32_16x16x32_bf16 a[80:83], a[200:203], a[232:235], a[80:83]
  s_add_u32 m0, s28, 4096
  v_mfma_f32_16x16x32_bf16 a[84:87], a[200:203], a[236:239], a[84:87]
  buffer_load_dwordx4 v17, s[12:15], s27 offen lds
  v_mfma_f32_16x16x32_bf16 a[88:91], a[200:203], a[240:243], a[88:91]
  v_mfma_f32_16x16x32_bf16 a[92:95], a[200:203], a[244:247], a[92:95]
  v_mfma_f32_16x16x32_bf16 a[96:99], a[204:207], a[232:235], a[96:99]
  s_waitcnt lgkmcnt(0)
  v_min3_u32 v72, v72, v73, v74
  v_min_u32 v72, v72, v75
  s_nop 0
  v_readfirstlane_b32 s34, v72
  s_nop 1
  s_cmp_ge_u32 s34, 2
  s_cbranch_scc1 FG25_OK
  FG25_SPIN:
  ds_read_b128 v[72:75], v111
  s_waitcnt lgkmcnt(0)
  v_min3_u32 v72, v72, v73, v74
  v_min_u32 v72, v72, v75
  s_nop 0
  v_readfirstlane_b32 s34, v72
  s_nop 1
  s_cmp_lt_u32 s34, 2
  s_cbranch_scc1 FG25_SPIN
  FG25_OK:
  v_mfma_f32_16x16x32_bf16 a[100:103], a[204:207], a[236:239], a[100:103]
  buffer_load_dwordx4 v19, s[12:15], s27 offen offset:2048 lds
  v_mfma_f32_16x16x32_bf16 a[104:107], a[204:207], a[240:243], a[104:107]
  ds_read_b128 a[216:219], v31 offset:2048
  v_mfma_f32_16x16x32_bf16 a[108:111], a[204:207], a[244:247], a[108:111]
  ds_read_b128 a[220:223], v31 offset:20480
  v_mfma_f32_16x16x32_bf16 a[112:115], a[208:211], a[232:235], a[112:115]
  s_add_u32 m0, s28, 0
  ds_read_b128 a[224:227], v32 offset:2048
  v_mfma_f32_16x16x32_bf16 a[116:119], a[208:211], a[236:239], a[116:119]
  buffer_load_dwordx4 v14, s[12:15], s27 offen offset:1024 lds
  v_mfma_f32_16x16x32_bf16 a[120:123], a[208:211], a[240:243], a[120:123]
  ds_read_b128 a[228:231], v32 offset:20480
  v_mfma_f32_16x16x32_bf16 a[124:127], a[208:211], a[244:247], a[124:127]
  v_mfma_f32_16x16x32_bf16 a[128:131], a[212:215], a[232:235], a[128:131]
  v_mfma_f32_16x16x32_bf16 a[132:135], a[212:215], a[236:239], a[132:135]
  buffer_load_dwordx4 v16, s[12:15], s27 offen offset:3072 lds
  v_mfma_f32_16x16x32_bf16 a[136:139], a[212:215], a[240:243], a[136:139]
  v_mfma_f32_16x16x32_bf16 a[140:143], a[212:215], a[244:247], a[140:143]
  s_waitcnt lgkmcnt(0)
  s_waitcnt vmcnt(11)
  v_mfma_f32_16x16x32_bf16 a[0:3], a[144:147], a[216:219], a[0:3]
  s_add_u32 m0, s28, 4096
  ds_read_b64_tr_b16 a[212:213], v30 offset:9216
  ds_read_b64_tr_b16 a[214:215], v30 offset:9472
  v_mfma_f32_16x16x32_bf16 a[4:7], a[144:147], a[220:223], a[4:7]
  buffer_load_dwordx4 v18, s[12:15], s27 offen offset:1024 lds
  v_exp_f32 v40, v208
  v_mfma_f32_16x16x32_bf16 a[8:11], a[144:147], a[224:227], a[8:11]
  ds_read_b64_tr_b16 a[180:181], v22 offset:9216
  ds_read_b64_tr_b16 a[184:185], v23 offset:9216
  v_mfma_f32_16x16x32_bf16 a[12:15], a[144:147], a[228:231], a[12:15]
  ds_read_b64_tr_b16 a[188:189], v24 offset:9216
  ds_read_b64_tr_b16 a[192:193], v25 offset:9216
  v_exp_f32 v41, v209
  v_mfma_f32_16x16x32_bf16 a[16:19], a[148:151], a[216:219], a[16:19]
  ds_read_b64_tr_b16 a[196:197], v26 offset:9216
  ds_read_b64_tr_b16 a[200:201], v27 offset:9216
  v_mfma_f32_16x16x32_bf16 a[20:23], a[148:151], a[220:223], a[20:23]
  buffer_load_dwordx4 v20, s[12:15], s27 offen offset:3072 lds
  v_exp_f32 v42, v210
  v_mfma_f32_16x16x32_bf16 a[24:27], a[148:151], a[224:227], a[24:27]
  ds_read_b64_tr_b16 a[204:205], v28 offset:9216
  ds_read_b64_tr_b16 a[208:209], v29 offset:9216
  v_mfma_f32_16x16x32_bf16 a[28:31], a[148:151], a[228:231], a[28:31]
  s_waitcnt vmcnt(9)
  ds_read_b64_tr_b16 a[182:183], v22 offset:10240
  ds_read_b64_tr_b16 a[186:187], v23 offset:10240
  v_mfma_f32_16x16x32_bf16 a[32:35], a[152:155], a[216:219], a[32:35]
  ds_read_b64_tr_b16 a[190:191], v24 offset:10240
  ds_read_b64_tr_b16 a[194:195], v25 offset:10240
  s_waitcnt lgkmcnt(4)
  s_add_u32 s31, s30, 516096
  s_add_u32 m0, s28, 17408
  v_mfma_f32_16x16x32_bf16 a[36:39], a[152:155], a[220:223], a[36:39]
  buffer_load_dwordx4 v21, s[12:15], s31 offen lds
  v_mfma_f32_16x16x32_bf16 a[40:43], a[152:155], a[224:227], a[40:43]
  ds_read_b64_tr_b16 a[198:199], v26 offset:10240
  ds_read_b64_tr_b16 a[202:203], v27 offset:10240
  v_mfma_f32_16x16x32_bf16 a[44:47], a[152:155], a[228:231], a[44:47]
  ds_read_b64_tr_b16 a[206:207], v28 offset:10240
  ds_read_b64_tr_b16 a[210:211], v29 offset:10240
  v_exp_f32 v43, v211
  v_mfma_f32_16x16x32_bf16 a[48:51], a[156:159], a[216:219], a[48:51]
  ds_read_b128 a[232:235], v31 offset:6144
  s_add_u32 m0, s28, 9216
  v_add_f32 v40, 1.0, v40
  v_mfma_f32_16x16x32_bf16 a[52:55], a[156:159], a[220:223], a[52:55]
  buffer_load_dwordx4 v13, s[12:15], s31 offen lds
  v_add_f32 v41, 1.0, v41
  v_mfma_f32_16x16x32_bf16 a[56:59], a[156:159], a[224:227], a[56:59]
  ds_read_b128 a[236:239], v31 offset:24576
  v_add_f32 v42, 1.0, v42
  v_add_f32 v43, 1.0, v43
  v_rcp_f32 v40, v40
  v_mfma_f32_16x16x32_bf16 a[60:63], a[156:159], a[228:231], a[60:63]
  ds_read_b128 a[240:243], v32 offset:6144
  v_rcp_f32 v41, v41
  v_mfma_f32_16x16x32_bf16 a[64:67], a[160:163], a[216:219], a[64:67]
  s_waitcnt lgkmcnt(3)
  ds_read_b128 a[244:247], v32 offset:24576
  v_rcp_f32 v42, v42
  v_mfma_f32_16x16x32_bf16 a[68:71], a[160:163], a[220:223], a[68:71]
  buffer_load_dwordx4 v15, s[12:15], s31 offen offset:2048 lds
  v_rcp_f32 v43, v43
  v_mfma_f32_16x16x32_bf16 a[72:75], a[160:163], a[224:227], a[72:75]
  v_mul_f32 v40, v208, v40
  v_mul_f32 v41, v209, v41
  v_mul_f32 v42, v210, v42
  v_mul_f32 v43, v211, v43
  v_mfma_f32_16x16x32_bf16 a[76:79], a[160:163], a[228:231], a[76:79]
  v_cvt_pk_bf16_f32 v44, v40, v41
  v_cvt_pk_bf16_f32 v45, v42, v43
  v_exp_f32 v48, v212
  v_exp_f32 v49, v213
  v_mfma_f32_16x16x32_bf16 a[80:83], a[164:167], a[216:219], a[80:83]
  s_add_u32 m0, s28, 13312
  ds_write_b64 v33, v[44:45] offset:3072
  v_mfma_f32_16x16x32_bf16 a[84:87], a[164:167], a[220:223], a[84:87]
  buffer_load_dwordx4 v17, s[12:15], s31 offen lds
  v_mfma_f32_16x16x32_bf16 a[88:91], a[164:167], a[224:227], a[88:91]
  v_exp_f32 v50, v214
  v_exp_f32 v51, v215
  v_add_f32 v48, 1.0, v48
  v_mfma_f32_16x16x32_bf16 a[92:95], a[164:167], a[228:231], a[92:95]
  v_add_f32 v49, 1.0, v49
  v_add_f32 v50, 1.0, v50
  v_add_f32 v51, 1.0, v51
  v_rcp_f32 v48, v48
  v_mfma_f32_16x16x32_bf16 a[96:99], a[168:171], a[216:219], a[96:99]
  v_rcp_f32 v49, v49
  v_rcp_f32 v50, v50
  v_mfma_f32_16x16x32_bf16 a[100:103], a[168:171], a[220:223], a[100:103]
  buffer_load_dwordx4 v19, s[12:15], s31 offen offset:2048 lds
  v_rcp_f32 v51, v51
  v_mfma_f32_16x16x32_bf16 a[104:107], a[168:171], a[224:227], a[104:107]
  v_mul_f32 v48, v212, v48
  v_mul_f32 v49, v213, v49
  v_mul_f32 v50, v214, v50
  v_mul_f32 v51, v215, v51
  v_cvt_pk_bf16_f32 v52, v48, v49
  v_mfma_f32_16x16x32_bf16 a[108:111], a[168:171], a[228:231], a[108:111]
  v_cvt_pk_bf16_f32 v53, v50, v51
  v_exp_f32 v56, v216
  v_exp_f32 v57, v217
  v_mfma_f32_16x16x32_bf16 a[112:115], a[172:175], a[216:219], a[112:115]
  s_add_u32 m0, s28, 9216
  ds_write_b64 v33, v[52:53] offset:21504
  v_mfma_f32_16x16x32_bf16 a[116:119], a[172:175], a[220:223], a[116:119]
  buffer_load_dwordx4 v14, s[12:15], s31 offen offset:1024 lds
  v_exp_f32 v58, v218
  v_mfma_f32_16x16x32_bf16 a[120:123], a[172:175], a[224:227], a[120:123]
  v_exp_f32 v59, v219
  v_add_f32 v56, 1.0, v56
  v_add_f32 v57, 1.0, v57
  v_mfma_f32_16x16x32_bf16 a[124:127], a[172:175], a[228:231], a[124:127]
  v_add_f32 v58, 1.0, v58
  v_add_f32 v59, 1.0, v59
  v_rcp_f32 v56, v56
  v_rcp_f32 v57, v57
  v_mfma_f32_16x16x32_bf16 a[128:131], a[176:179], a[216:219], a[128:131]
  v_rcp_f32 v58, v58
  v_rcp_f32 v59, v59
  v_mfma_f32_16x16x32_bf16 a[132:135], a[176:179], a[220:223], a[132:135]
  buffer_load_dwordx4 v16, s[12:15], s31 offen offset:3072 lds
  v_mul_f32 v56, v216, v56
  v_mfma_f32_16x16x32_bf16 a[136:139], a[176:179], a[224:227], a[136:139]
  v_mul_f32 v57, v217, v57
  v_mul_f32 v58, v218, v58
  v_mul_f32 v59, v219, v59
  v_cvt_pk_bf16_f32 v60, v56, v57
  v_cvt_pk_bf16_f32 v61, v58, v59
  v_mfma_f32_16x16x32_bf16 a[140:143], a[176:179], a[228:231], a[140:143]
  s_waitcnt lgkmcnt(2)
  ds_write_b64 v33, v[60:61] offset:39936
  s_waitcnt vmcnt(11)
  v_mfma_f32_16x16x32_bf16 a[0:3], a[180:183], a[232:235], a[0:3]
  s_add_u32 m0, s28, 13312
  ds_read_b64_tr_b16 a[176:177], v30 offset:0
  ds_read_b64_tr_b16 a[178:179], v30 offset:256
  v_mfma_f32_16x16x32_bf16 a[4:7], a[180:183], a[236:239], a[4:7]
  buffer_load_dwordx4 v18, s[12:15], s31 offen offset:1024 lds
  v_exp_f32 v64, v220
  v_mfma_f32_16x16x32_bf16 a[8:11], a[180:183], a[240:243], a[8:11]
  ds_read_b64_tr_b16 a[144:145], v22 offset:0
  ds_read_b64_tr_b16 a[148:149], v23 offset:0
  v_mfma_f32_16x16x32_bf16 a[12:15], a[180:183], a[244:247], a[12:15]
  ds_read_b64_tr_b16 a[152:153], v24 offset:0
  ds_read_b64_tr_b16 a[156:157], v25 offset:0
  v_exp_f32 v65, v221
  v_mfma_f32_16x16x32_bf16 a[16:19], a[184:187], a[232:235], a[16:19]
  ds_read_b64_tr_b16 a[160:161], v26 offset:0
  ds_read_b64_tr_b16 a[164:165], v27 offset:0
  v_mfma_f32_16x16x32_bf16 a[20:23], a[184:187], a[236:239], a[20:23]
  buffer_load_dwordx4 v20, s[12:15], s31 offen offset:3072 lds
  v_exp_f32 v66, v222
  v_mfma_f32_16x16x32_bf16 a[24:27], a[184:187], a[240:243], a[24:27]
  ds_read_b64_tr_b16 a[168:169], v28 offset:0
  ds_read_b64_tr_b16 a[172:173], v29 offset:0
  v_mfma_f32_16x16x32_bf16 a[28:31], a[184:187], a[244:247], a[28:31]
  s_waitcnt vmcnt(9)
  ds_read_b64_tr_b16 a[146:147], v22 offset:1024
  ds_read_b64_tr_b16 a[150:151], v23 offset:1024
  v_mfma_f32_16x16x32_bf16 a[32:35], a[188:191], a[232:235], a[32:35]
  ds_read_b64_tr_b16 a[154:155], v24 offset:1024
  ds_read_b64_tr_b16 a[158:159], v25 offset:1024
  s_waitcnt lgkmcnt(4)
  s_add_u32 s27, s30, 110592
  s_add_u32 m0, s28, 8192
  v_mfma_f32_16x16x32_bf16 a[36:39], a[188:191], a[236:239], a[36:39]
  buffer_load_dwordx4 v21, s[12:15], s27 offen lds
  v_mfma_f32_16x16x32_bf16 a[40:43], a[188:191], a[240:243], a[40:43]
  ds_read_b64_tr_b16 a[162:163], v26 offset:1024
  ds_read_b64_tr_b16 a[166:167], v27 offset:1024
  v_mfma_f32_16x16x32_bf16 a[44:47], a[188:191], a[244:247], a[44:47]
  ds_read_b64_tr_b16 a[170:171], v28 offset:1024
  ds_read_b64_tr_b16 a[174:175], v29 offset:1024
  v_exp_f32 v67, v223
  v_mfma_f32_16x16x32_bf16 a[48:51], a[192:195], a[232:235], a[48:51]
  ds_read_b128 a[216:219], v31 offset:10240
  s_add_u32 m0, s28, 0
  v_add_f32 v64, 1.0, v64
  v_mfma_f32_16x16x32_bf16 a[52:55], a[192:195], a[236:239], a[52:55]
  buffer_load_dwordx4 v13, s[12:15], s27 offen lds
  v_add_f32 v65, 1.0, v65
  v_mfma_f32_16x16x32_bf16 a[56:59], a[192:195], a[240:243], a[56:59]
  ds_read_b128 a[220:223], v31 offset:28672
  v_add_f32 v66, 1.0, v66
  v_add_f32 v67, 1.0, v67
  v_rcp_f32 v64, v64
  v_mfma_f32_16x16x32_bf16 a[60:63], a[192:195], a[244:247], a[60:63]
  ds_read_b128 a[224:227], v32 offset:10240
  v_rcp_f32 v65, v65
  v_mfma_f32_16x16x32_bf16 a[64:67], a[196:199], a[232:235], a[64:67]
  s_waitcnt lgkmcnt(3)
  ds_read_b128 a[228:231], v32 offset:28672
  v_rcp_f32 v66, v66
  v_mfma_f32_16x16x32_bf16 a[68:71], a[196:199], a[236:239], a[68:71]
  buffer_load_dwordx4 v15, s[12:15], s27 offen offset:2048 lds
  v_rcp_f32 v67, v67
  v_mfma_f32_16x16x32_bf16 a[72:75], a[196:199], a[240:243], a[72:75]
  v_mul_f32 v64, v220, v64
  v_mul_f32 v65, v221, v65
  v_mul_f32 v66, v222, v66
  v_mul_f32 v67, v223, v67
  v_mfma_f32_16x16x32_bf16 a[76:79], a[196:199], a[244:247], a[76:79]
  v_cvt_pk_bf16_f32 v68, v64, v65
  v_cvt_pk_bf16_f32 v69, v66, v67
  v_exp_f32 v40, v224
  v_exp_f32 v41, v225
  v_mfma_f32_16x16x32_bf16 a[80:83], a[200:203], a[232:235], a[80:83]
  s_add_u32 m0, s28, 4096
  ds_write_b64 v33, v[68:69] offset:58368
  v_mfma_f32_16x16x32_bf16 a[84:87], a[200:203], a[236:239], a[84:87]
  buffer_load_dwordx4 v17, s[12:15], s27 offen lds
  v_mfma_f32_16x16x32_bf16 a[88:91], a[200:203], a[240:243], a[88:91]
  v_exp_f32 v42, v226
  v_exp_f32 v43, v227
  v_add_f32 v40, 1.0, v40
  v_mfma_f32_16x16x32_bf16 a[92:95], a[200:203], a[244:247], a[92:95]
  v_add_f32 v41, 1.0, v41
  v_add_f32 v42, 1.0, v42
  v_add_f32 v43, 1.0, v43
  v_rcp_f32 v40, v40
  v_mfma_f32_16x16x32_bf16 a[96:99], a[204:207], a[232:235], a[96:99]
  v_rcp_f32 v41, v41
  v_rcp_f32 v42, v42
  v_mfma_f32_16x16x32_bf16 a[100:103], a[204:207], a[236:239], a[100:103]
  buffer_load_dwordx4 v19, s[12:15], s27 offen offset:2048 lds
  v_rcp_f32 v43, v43
  v_mfma_f32_16x16x32_bf16 a[104:107], a[204:207], a[240:243], a[104:107]
  v_mul_f32 v40, v224, v40
  v_mul_f32 v41, v225, v41
  v_mul_f32 v42, v226, v42
  v_mul_f32 v43, v227, v43
  v_cvt_pk_bf16_f32 v44, v40, v41
  v_mfma_f32_16x16x32_bf16 a[108:111], a[204:207], a[244:247], a[108:111]
  v_cvt_pk_bf16_f32 v45, v42, v43
  v_exp_f32 v48, v228
  v_exp_f32 v49, v229
  v_mfma_f32_16x16x32_bf16 a[112:115], a[208:211], a[232:235], a[112:115]
  s_add_u32 m0, s28, 0
  ds_write_b64 v33, v[44:45] offset:3584
  v_mfma_f32_16x16x32_bf16 a[116:119], a[208:211], a[236:239], a[116:119]
  buffer_load_dwordx4 v14, s[12:15], s27 offen offset:1024 lds
  v_exp_f32 v50, v230
  v_mfma_f32_16x16x32_bf16 a[120:123], a[208:211], a[240:243], a[120:123]
  v_exp_f32 v51, v231
  v_add_f32 v48, 1.0, v48
  v_add_f32 v49, 1.0, v49
  v_mfma_f32_16x16x32_bf16 a[124:127], a[208:211], a[244:247], a[124:127]
  v_add_f32 v50, 1.0, v50
  v_add_f32 v51, 1.0, v51
  v_rcp_f32 v48, v48
  v_rcp_f32 v49, v49
  v_mfma_f32_16x16x32_bf16 a[128:131], a[212:215], a[232:235], a[128:131]
  v_rcp_f32 v50, v50
  v_rcp_f32 v51, v51
  v_mfma_f32_16x16x32_bf16 a[132:135], a[212:215], a[236:239], a[132:135]
  buffer_load_dwordx4 v16, s[12:15], s27 offen offset:3072 lds
  v_mul_f32 v48, v228, v48
  v_mfma_f32_16x16x32_bf16 a[136:139], a[212:215], a[240:243], a[136:139]
  v_mul_f32 v49, v229, v49
  v_mul_f32 v50, v230, v50
  v_mul_f32 v51, v231, v51
  v_cvt_pk_bf16_f32 v52, v48, v49
  v_cvt_pk_bf16_f32 v53, v50, v51
  v_mfma_f32_16x16x32_bf16 a[140:143], a[212:215], a[244:247], a[140:143]
  s_waitcnt lgkmcnt(2)
  ds_write_b64 v33, v[52:53] offset:22016
  s_waitcnt vmcnt(11)
  v_mfma_f32_16x16x32_bf16 a[0:3], a[144:147], a[216:219], a[0:3]
  s_add_u32 m0, s28, 4096
  ds_read_b64_tr_b16 a[212:213], v30 offset:9216
  ds_read_b64_tr_b16 a[214:215], v30 offset:9472
  v_mfma_f32_16x16x32_bf16 a[4:7], a[144:147], a[220:223], a[4:7]
  buffer_load_dwordx4 v18, s[12:15], s27 offen offset:1024 lds
  v_mfma_f32_16x16x32_bf16 a[8:11], a[144:147], a[224:227], a[8:11]
  ds_read_b64_tr_b16 a[180:181], v22 offset:9216
  ds_read_b64_tr_b16 a[184:185], v23 offset:9216
  v_mfma_f32_16x16x32_bf16 a[12:15], a[144:147], a[228:231], a[12:15]
  ds_read_b64_tr_b16 a[188:189], v24 offset:9216
  ds_read_b64_tr_b16 a[192:193], v25 offset:9216
  v_mfma_f32_16x16x32_bf16 a[16:19], a[148:151], a[216:219], a[16:19]
  ds_read_b64_tr_b16 a[196:197], v26 offset:9216
  ds_read_b64_tr_b16 a[200:201], v27 offset:9216
  v_mfma_f32_16x16x32_bf16 a[20:23], a[148:151], a[220:223], a[20:23]
  buffer_load_dwordx4 v20, s[12:15], s27 offen offset:3072 lds
  v_mfma_f32_16x16x32_bf16 a[24:27], a[148:151], a[224:227], a[24:27]
  ds_read_b64_tr_b16 a[204:205], v28 offset:9216
  ds_read_b64_tr_b16 a[208:209], v29 offset:9216
  v_exp_f32 v56, v232
  v_mfma_f32_16x16x32_bf16 a[28:31], a[148:151], a[228:231], a[28:31]
  s_waitcnt vmcnt(9)
  ds_read_b64_tr_b16 a[182:183], v22 offset:10240
  ds_read_b64_tr_b16 a[186:187], v23 offset:10240
  v_mfma_f32_16x16x32_bf16 a[32:35], a[152:155], a[216:219], a[32:35]
  ds_read_b64_tr_b16 a[190:191], v24 offset:10240
  ds_read_b64_tr_b16 a[194:195], v25 offset:10240
  s_waitcnt lgkmcnt(4)
  s_add_u32 s31, s30, 258048
  s_add_u32 m0, s28, 17408
  v_mfma_f32_16x16x32_bf16 a[36:39], a[152:155], a[220:223], a[36:39]
  buffer_load_dwordx4 v21, s[12:15], s31 offen lds
  v_mfma_f32_16x16x32_bf16 a[40:43], a[152:155], a[224:227], a[40:43]
  ds_read_b64_tr_b16 a[198:199], v26 offset:10240
  ds_read_b64_tr_b16 a[202:203], v27 offset:10240
  v_mfma_f32_16x16x32_bf16 a[44:47], a[152:155], a[228:231], a[44:47]
  ds_read_b64_tr_b16 a[206:207], v28 offset:10240
  ds_read_b64_tr_b16 a[210:211], v29 offset:10240
  v_mfma_f32_16x16x32_bf16 a[48:51], a[156:159], a[216:219], a[48:51]
  ds_read_b128 a[232:235], v31 offset:14336
  s_add_u32 m0, s28, 9216
  v_mfma_f32_16x16x32_bf16 a[52:55], a[156:159], a[220:223], a[52:55]
  buffer_load_dwordx4 v13, s[12:15], s31 offen lds
  v_mfma_f32_16x16x32_bf16 a[56:59], a[156:159], a[224:227], a[56:59]
  ds_read_b128 a[236:239], v31 offset:32768
  v_mfma_f32_16x16x32_bf16 a[60:63], a[156:159], a[228:231], a[60:63]
  ds_read_b128 a[240:243], v32 offset:14336
  v_exp_f32 v57, v233
  v_mfma_f32_16x16x32_bf16 a[64:67], a[160:163], a[216:219], a[64:67]
  s_waitcnt lgkmcnt(3)
  ds_read_b128 a[244:247], v32 offset:32768
  v_exp_f32 v58, v234
  v_mfma_f32_16x16x32_bf16 a[68:71], a[160:163], a[220:223], a[68:71]
  buffer_load_dwordx4 v15, s[12:15], s31 offen offset:2048 lds
  v_mfma_f32_16x16x32_bf16 a[72:75], a[160:163], a[224:227], a[72:75]
  v_exp_f32 v59, v235
  v_add_f32 v56, 1.0, v56
  v_add_f32 v57, 1.0, v57
  v_add_f32 v58, 1.0, v58
  v_mfma_f32_16x16x32_bf16 a[76:79], a[160:163], a[228:231], a[76:79]
  v_add_f32 v59, 1.0, v59
  v_rcp_f32 v56, v56
  v_rcp_f32 v57, v57
  v_mfma_f32_16x16x32_bf16 a[80:83], a[164:167], a[216:219], a[80:83]
  s_add_u32 m0, s28, 13312
  v_rcp_f32 v58, v58
  v_mfma_f32_16x16x32_bf16 a[84:87], a[164:167], a[220:223], a[84:87]
  buffer_load_dwordx4 v17, s[12:15], s31 offen lds
  v_mfma_f32_16x16x32_bf16 a[88:91], a[164:167], a[224:227], a[88:91]
  v_rcp_f32 v59, v59
  v_mul_f32 v56, v232, v56
  v_mul_f32 v57, v233, v57
  v_mul_f32 v58, v234, v58
  v_mfma_f32_16x16x32_bf16 a[92:95], a[164:167], a[228:231], a[92:95]
  v_mul_f32 v59, v235, v59
  v_cvt_pk_bf16_f32 v60, v56, v57
  v_cvt_pk_bf16_f32 v61, v58, v59
  v_mfma_f32_16x16x32_bf16 a[96:99], a[168:171], a[216:219], a[96:99]
  ds_write_b64 v33, v[60:61] offset:40448
  v_exp_f32 v64, v236
  v_mfma_f32_16x16x32_bf16 a[100:103], a[168:171], a[220:223], a[100:103]
  buffer_load_dwordx4 v19, s[12:15], s31 offen offset:2048 lds
  v_mfma_f32_16x16x32_bf16 a[104:107], a[168:171], a[224:227], a[104:107]
  v_exp_f32 v65, v237
  v_exp_f32 v66, v238
  v_mfma_f32_16x16x32_bf16 a[108:111], a[168:171], a[228:231], a[108:111]
  v_exp_f32 v67, v239
  v_add_f32 v64, 1.0, v64
  v_add_f32 v65, 1.0, v65
  v_add_f32 v66, 1.0, v66
  v_mfma_f32_16x16x32_bf16 a[112:115], a[172:175], a[216:219], a[112:115]
  s_add_u32 m0, s28, 9216
  v_add_f32 v67, 1.0, v67
  v_rcp_f32 v64, v64
  v_mfma_f32_16x16x32_bf16 a[116:119], a[172:175], a[220:223], a[116:119]
  buffer_load_dwordx4 v14, s[12:15], s31 offen offset:1024 lds
  v_mfma_f32_16x16x32_bf16 a[120:123], a[172:175], a[224:227], a[120:123]
  v_rcp_f32 v65, v65
  v_rcp_f32 v66, v66
  v_mfma_f32_16x16x32_bf16 a[124:127], a[172:175], a[228:231], a[124:127]
  v_rcp_f32 v67, v67
  v_mul_f32 v64, v236, v64
  v_mul_f32 v65, v237, v65
  v_mul_f32 v66, v238, v66
  v_mfma_f32_16x16x32_bf16 a[128:131], a[176:179], a[216:219], a[128:131]
  v_mul_f32 v67, v239, v67
  v_cvt_pk_bf16_f32 v68, v64, v65
  v_cvt_pk_bf16_f32 v69, v66, v67
  v_mfma_f32_16x16x32_bf16 a[132:135], a[176:179], a[220:223], a[132:135]
  buffer_load_dwordx4 v16, s[12:15], s31 offen offset:3072 lds
  v_mfma_f32_16x16x32_bf16 a[136:139], a[176:179], a[224:227], a[136:139]
  ds_write_b64 v33, v[68:69] offset:58880
  v_mov_b32 v78, 3
  v_mfma_f32_16x16x32_bf16 a[140:143], a[176:179], a[228:231], a[140:143]
  s_waitcnt lgkmcnt(2)
  ds_write_b32 v110, v78
  s_waitcnt vmcnt(11)
  v_mfma_f32_16x16x32_bf16 a[0:3], a[180:183], a[232:235], a[0:3]
  s_add_u32 m0, s28, 13312
  ds_read_b64_tr_b16 a[176:177], v30 offset:0
  ds_read_b64_tr_b16 a[178:179], v30 offset:256
  v_mfma_f32_16x16x32_bf16 a[4:7], a[180:183], a[236:239], a[4:7]
  buffer_load_dwordx4 v18, s[12:15], s31 offen offset:1024 lds
  v_mfma_f32_16x16x32_bf16 a[8:11], a[180:183], a[240:243], a[8:11]
  ds_read_b64_tr_b16 a[144:145], v22 offset:0
  ds_read_b64_tr_b16 a[148:149], v23 offset:0
  v_mfma_f32_16x16x32_bf16 a[12:15], a[180:183], a[244:247], a[12:15]
  ds_read_b64_tr_b16 a[152:153], v24 offset:0
  ds_read_b64_tr_b16 a[156:157], v25 offset:0
  v_mfma_f32_16x16x32_bf16 a[16:19], a[184:187], a[232:235], a[16:19]
  ds_read_b64_tr_b16 a[160:161], v26 offset:0
  ds_read_b64_tr_b16 a[164:165], v27 offset:0
  v_mfma_f32_16x16x32_bf16 a[20:23], a[184:187], a[236:239], a[20:23]
  buffer_load_dwordx4 v20, s[12:15], s31 offen offset:3072 lds
  v_mfma_f32_16x16x32_bf16 a[24:27], a[184:187], a[240:243], a[24:27]
  ds_read_b64_tr_b16 a[168:169], v28 offset:0
  ds_read_b64_tr_b16 a[172:173], v29 offset:0
  v_mfma_f32_16x16x32_bf16 a[28:31], a[184:187], a[244:247], a[28:31]
  s_waitcnt vmcnt(9)
  ds_read_b64_tr_b16 a[146:147], v22 offset:1024
  ds_read_b64_tr_b16 a[150:151], v23 offset:1024
  v_mfma_f32_16x16x32_bf16 a[32:35], a[188:191], a[232:235], a[32:35]
  ds_read_b64_tr_b16 a[154:155], v24 offset:1024
  ds_read_b64_tr_b16 a[158:159], v25 offset:1024
  s_waitcnt lgkmcnt(4)
  s_add_u32 s27, s30, 405504
  s_add_u32 m0, s28, 8192
  v_mfma_f32_16x16x32_bf16 a[36:39], a[188:191], a[236:239], a[36:39]
  buffer_load_dwordx4 v21, s[12:15], s27 offen lds
  v_mfma_f32_16x16x32_bf16 a[40:43], a[188:191], a[240:243], a[40:43]
  ds_read_b64_tr_b16 a[162:163], v26 offset:1024
  ds_read_b64_tr_b16 a[166:167], v27 offset:1024
  v_mfma_f32_16x16x32_bf16 a[44:47], a[188:191], a[244:247], a[44:47]
  ds_read_b64_tr_b16 a[170:171], v28 offset:1024
  ds_read_b64_tr_b16 a[174:175], v29 offset:1024
  v_mfma_f32_16x16x32_bf16 a[48:51], a[192:195], a[232:235], a[48:51]
  s_add_u32 m0, s28, 0
  v_mfma_f32_16x16x32_bf16 a[52:55], a[192:195], a[236:239], a[52:55]
  buffer_load_dwordx4 v13, s[12:15], s27 offen lds
  v_mfma_f32_16x16x32_bf16 a[56:59], a[192:195], a[240:243], a[56:59]
  v_mfma_f32_16x16x32_bf16 a[60:63], a[192:195], a[244:247], a[60:63]
  v_mfma_f32_16x16x32_bf16 a[64:67], a[196:199], a[232:235], a[64:67]
  s_waitcnt lgkmcnt(0)
  v_mfma_f32_16x16x32_bf16 a[68:71], a[196:199], a[236:239], a[68:71]
  buffer_load_dwordx4 v15, s[12:15], s27 offen offset:2048 lds
  v_mfma_f32_16x16x32_bf16 a[72:75], a[196:199], a[240:243], a[72:75]
  ds_read_b128 v[72:75], v111
  v_mfma_f32_16x16x32_bf16 a[76:79], a[196:199], a[244:247], a[76:79]
  v_mfma_f32_16x16x32_bf16 a[80:83], a[200:203], a[232:235], a[80:83]
  s_add_u32 m0, s28, 4096
  v_mfma_f32_16x16x32_bf16 a[84:87], a[200:203], a[236:239], a[84:87]
  buffer_load_dwordx4 v17, s[12:15], s27 offen lds
  v_mfma_f32_16x16x32_bf16 a[88:91], a[200:203], a[240:243], a[88:91]
  v_mfma_f32_16x16x32_bf16 a[92:95], a[200:203], a[244:247], a[92:95]
  v_mfma_f32_16x16x32_bf16 a[96:99], a[204:207], a[232:235], a[96:99]
  s_waitcnt lgkmcnt(0)
  v_min3_u32 v72, v72, v73, v74
  v_min_u32 v72, v72, v75
  s_nop 0
  v_readfirstlane_b32 s34, v72
  s_nop 1
  s_cmp_ge_u32 s34, 3
  s_cbranch_scc1 FG29_OK
  FG29_SPIN:
  ds_read_b128 v[72:75], v111
  s_waitcnt lgkmcnt(0)
  v_min3_u32 v72, v72, v73, v74
  v_min_u32 v72, v72, v75
  s_nop 0
  v_readfirstlane_b32 s34, v72
  s_nop 1
  s_cmp_lt_u32 s34, 3
  s_cbranch_scc1 FG29_SPIN
  FG29_OK:
  v_mfma_f32_16x16x32_bf16 a[100:103], a[204:207], a[236:239], a[100:103]
  buffer_load_dwordx4 v19, s[12:15], s27 offen offset:2048 lds
  v_mfma_f32_16x16x32_bf16 a[104:107], a[204:207], a[240:243], a[104:107]
  ds_read_b128 a[216:219], v31 offset:3072
  v_mfma_f32_16x16x32_bf16 a[108:111], a[204:207], a[244:247], a[108:111]
  ds_read_b128 a[220:223], v31 offset:21504
  v_mfma_f32_16x16x32_bf16 a[112:115], a[208:211], a[232:235], a[112:115]
  s_add_u32 m0, s28, 0
  ds_read_b128 a[224:227], v32 offset:3072
  v_mfma_f32_16x16x32_bf16 a[116:119], a[208:211], a[236:239], a[116:119]
  buffer_load_dwordx4 v14, s[12:15], s27 offen offset:1024 lds
  v_mfma_f32_16x16x32_bf16 a[120:123], a[208:211], a[240:243], a[120:123]
  ds_read_b128 a[228:231], v32 offset:21504
  v_mfma_f32_16x16x32_bf16 a[124:127], a[208:211], a[244:247], a[124:127]
  v_mfma_f32_16x16x32_bf16 a[128:131], a[212:215], a[232:235], a[128:131]
  v_mfma_f32_16x16x32_bf16 a[132:135], a[212:215], a[236:239], a[132:135]
  buffer_load_dwordx4 v16, s[12:15], s27 offen offset:3072 lds
  v_mfma_f32_16x16x32_bf16 a[136:139], a[212:215], a[240:243], a[136:139]
  v_mfma_f32_16x16x32_bf16 a[140:143], a[212:215], a[244:247], a[140:143]
  s_waitcnt lgkmcnt(0)
  s_waitcnt vmcnt(11)
  v_mfma_f32_16x16x32_bf16 a[0:3], a[144:147], a[216:219], a[0:3]
  s_add_u32 m0, s28, 4096
  ds_read_b64_tr_b16 a[212:213], v30 offset:9216
  ds_read_b64_tr_b16 a[214:215], v30 offset:9472
  v_mfma_f32_16x16x32_bf16 a[4:7], a[144:147], a[220:223], a[4:7]
  buffer_load_dwordx4 v18, s[12:15], s27 offen offset:1024 lds
  v_mfma_f32_16x16x32_bf16 a[8:11], a[144:147], a[224:227], a[8:11]
  ds_read_b64_tr_b16 a[180:181], v22 offset:9216
  ds_read_b64_tr_b16 a[184:185], v23 offset:9216
  v_mfma_f32_16x16x32_bf16 a[12:15], a[144:147], a[228:231], a[12:15]
  ds_read_b64_tr_b16 a[188:189], v24 offset:9216
  ds_read_b64_tr_b16 a[192:193], v25 offset:9216
  v_mfma_f32_16x16x32_bf16 a[16:19], a[148:151], a[216:219], a[16:19]
  ds_read_b64_tr_b16 a[196:197], v26 offset:9216
  ds_read_b64_tr_b16 a[200:201], v27 offset:9216
  v_mfma_f32_16x16x32_bf16 a[20:23], a[148:151], a[220:223], a[20:23]
  buffer_load_dwordx4 v20, s[12:15], s27 offen offset:3072 lds
  v_mfma_f32_16x16x32_bf16 a[24:27], a[148:151], a[224:227], a[24:27]
  ds_read_b64_tr_b16 a[204:205], v28 offset:9216
  ds_read_b64_tr_b16 a[208:209], v29 offset:9216
  v_mfma_f32_16x16x32_bf16 a[28:31], a[148:151], a[228:231], a[28:31]
  s_waitcnt vmcnt(9)
  ds_read_b64_tr_b16 a[182:183], v22 offset:10240
  ds_read_b64_tr_b16 a[186:187], v23 offset:10240
  v_mfma_f32_16x16x32_bf16 a[32:35], a[152:155], a[216:219], a[32:35]
  ds_read_b64_tr_b16 a[190:191], v24 offset:10240
  ds_read_b64_tr_b16 a[194:195], v25 offset:10240
  s_waitcnt lgkmcnt(4)
  s_add_u32 s31, s30, 552960
  s_add_u32 m0, s28, 17408
  v_mfma_f32_16x16x32_bf16 a[36:39], a[152:155], a[220:223], a[36:39]
  buffer_load_dwordx4 v21, s[12:15], s31 offen lds
  v_mfma_f32_16x16x32_bf16 a[40:43], a[152:155], a[224:227], a[40:43]
  ds_read_b64_tr_b16 a[198:199], v26 offset:10240
  ds_read_b64_tr_b16 a[202:203], v27 offset:10240
  v_mfma_f32_16x16x32_bf16 a[44:47], a[152:155], a[228:231], a[44:47]
  ds_read_b64_tr_b16 a[206:207], v28 offset:10240
  ds_read_b64_tr_b16 a[210:211], v29 offset:10240
  v_mfma_f32_16x16x32_bf16 a[48:51], a[156:159], a[216:219], a[48:51]
  ds_read_b128 a[232:235], v31 offset:7168
  s_add_u32 m0, s28, 9216
  v_mfma_f32_16x16x32_bf16 a[52:55], a[156:159], a[220:223], a[52:55]
  buffer_load_dwordx4 v13, s[12:15], s31 offen lds
  v_mfma_f32_16x16x32_bf16 a[56:59], a[156:159], a[224:227], a[56:59]
  ds_read_b128 a[236:239], v31 offset:25600
  v_mfma_f32_16x16x32_bf16 a[60:63], a[156:159], a[228:231], a[60:63]
  ds_read_b128 a[240:243], v32 offset:7168
  v_exp_f32 v40, v240
  v_mfma_f32_16x16x32_bf16 a[64:67], a[160:163], a[216:219], a[64:67]
  s_waitcnt lgkmcnt(3)
  ds_read_b128 a[244:247], v32 offset:25600
  v_exp_f32 v41, v241
  v_mfma_f32_16x16x32_bf16 a[68:71], a[160:163], a[220:223], a[68:71]
  buffer_load_dwordx4 v15, s[12:15], s31 offen offset:2048 lds
  v_mfma_f32_16x16x32_bf16 a[72:75], a[160:163], a[224:227], a[72:75]
  v_exp_f32 v42, v242
  v_exp_f32 v43, v243
  v_mfma_f32_16x16x32_bf16 a[76:79], a[160:163], a[228:231], a[76:79]
  v_add_f32 v40, 1.0, v40
  v_add_f32 v41, 1.0, v41
  v_add_f32 v42, 1.0, v42
  v_add_f32 v43, 1.0, v43
  v_mfma_f32_16x16x32_bf16 a[80:83], a[164:167], a[216:219], a[80:83]
  s_add_u32 m0, s28, 13312
  v_rcp_f32 v40, v40
  v_rcp_f32 v41, v41
  v_mfma_f32_16x16x32_bf16 a[84:87], a[164:167], a[220:223], a[84:87]
  buffer_load_dwordx4 v17, s[12:15], s31 offen lds
  v_mfma_f32_16x16x32_bf16 a[88:91], a[164:167], a[224:227], a[88:91]
  v_rcp_f32 v42, v42
  v_rcp_f32 v43, v43
  v_mfma_f32_16x16x32_bf16 a[92:95], a[164:167], a[228:231], a[92:95]
  v_mul_f32 v40, v240, v40
  v_mul_f32 v41, v241, v41
  v_mul_f32 v42, v242, v42
  v_mul_f32 v43, v243, v43
  v_mfma_f32_16x16x32_bf16 a[96:99], a[168:171], a[216:219], a[96:99]
  v_cvt_pk_bf16_f32 v44, v40, v41
  v_cvt_pk_bf16_f32 v45, v42, v43
  v_exp_f32 v48, v244
  v_mfma_f32_16x16x32_bf16 a[100:103], a[168:171], a[220:223], a[100:103]
  buffer_load_dwordx4 v19, s[12:15], s31 offen offset:2048 lds
  ds_write_b64 v34, v[44:45] offset:0
  v_mfma_f32_16x16x32_bf16 a[104:107], a[168:171], a[224:227], a[104:107]
  v_mfma_f32_16x16x32_bf16 a[108:111], a[168:171], a[228:231], a[108:111]
  v_exp_f32 v49, v245
  v_exp_f32 v50, v246
  v_mfma_f32_16x16x32_bf16 a[112:115], a[172:175], a[216:219], a[112:115]
  s_add_u32 m0, s28, 9216
  v_exp_f32 v51, v247
  v_add_f32 v48, 1.0, v48
  v_add_f32 v49, 1.0, v49
  v_mfma_f32_16x16x32_bf16 a[116:119], a[172:175], a[220:223], a[116:119]
  buffer_load_dwordx4 v14, s[12:15], s31 offen offset:1024 lds
  v_mfma_f32_16x16x32_bf16 a[120:123], a[172:175], a[224:227], a[120:123]
  v_add_f32 v50, 1.0, v50
  v_add_f32 v51, 1.0, v51
  v_rcp_f32 v48, v48
  v_mfma_f32_16x16x32_bf16 a[124:127], a[172:175], a[228:231], a[124:127]
  v_rcp_f32 v49, v49
  v_rcp_f32 v50, v50
  v_mfma_f32_16x16x32_bf16 a[128:131], a[176:179], a[216:219], a[128:131]
  v_rcp_f32 v51, v51
  v_mul_f32 v48, v244, v48
  v_mul_f32 v49, v245, v49
  v_mfma_f32_16x16x32_bf16 a[132:135], a[176:179], a[220:223], a[132:135]
  buffer_load_dwordx4 v16, s[12:15], s31 offen offset:3072 lds
  v_mul_f32 v50, v246, v50
  v_mfma_f32_16x16x32_bf16 a[136:139], a[176:179], a[224:227], a[136:139]
  v_mul_f32 v51, v247, v51
  v_cvt_pk_bf16_f32 v52, v48, v49
  v_cvt_pk_bf16_f32 v53, v50, v51
  v_mfma_f32_16x16x32_bf16 a[140:143], a[176:179], a[228:231], a[140:143]
  s_waitcnt lgkmcnt(1)
  ds_write_b64 v34, v[52:53] offset:18432
  s_waitcnt vmcnt(11)
  v_mfma_f32_16x16x32_bf16 a[0:3], a[180:183], a[232:235], a[0:3]
  s_add_u32 m0, s28, 13312
  ds_read_b64_tr_b16 a[176:177], v30 offset:0
  ds_read_b64_tr_b16 a[178:179], v30 offset:256
  v_mfma_f32_16x16x32_bf16 a[4:7], a[180:183], a[236:239], a[4:7]
  buffer_load_dwordx4 v18, s[12:15], s31 offen offset:1024 lds
  v_mfma_f32_16x16x32_bf16 a[8:11], a[180:183], a[240:243], a[8:11]
  ds_read_b64_tr_b16 a[144:145], v22 offset:0
  ds_read_b64_tr_b16 a[148:149], v23 offset:0
  v_mfma_f32_16x16x32_bf16 a[12:15], a[180:183], a[244:247], a[12:15]
  ds_read_b64_tr_b16 a[152:153], v24 offset:0
  ds_read_b64_tr_b16 a[156:157], v25 offset:0
  v_mfma_f32_16x16x32_bf16 a[16:19], a[184:187], a[232:235], a[16:19]
  ds_read_b64_tr_b16 a[160:161], v26 offset:0
  ds_read_b64_tr_b16 a[164:165], v27 offset:0
  v_mfma_f32_16x16x32_bf16 a[20:23], a[184:187], a[236:239], a[20:23]
  buffer_load_dwordx4 v20, s[12:15], s31 offen offset:3072 lds
  v_mfma_f32_16x16x32_bf16 a[24:27], a[184:187], a[240:243], a[24:27]
  ds_read_b64_tr_b16 a[168:169], v28 offset:0
  ds_read_b64_tr_b16 a[172:173], v29 offset:0
  v_exp_f32 v56, v248
  v_mfma_f32_16x16x32_bf16 a[28:31], a[184:187], a[244:247], a[28:31]
  s_waitcnt vmcnt(9)
  ds_read_b64_tr_b16 a[146:147], v22 offset:1024
  ds_read_b64_tr_b16 a[150:151], v23 offset:1024
  v_mfma_f32_16x16x32_bf16 a[32:35], a[188:191], a[232:235], a[32:35]
  ds_read_b64_tr_b16 a[154:155], v24 offset:1024
  ds_read_b64_tr_b16 a[158:159], v25 offset:1024
  s_waitcnt lgkmcnt(4)
  s_add_u32 s27, s30, 589824
  s_add_u32 m0, s28, 8192
  v_mfma_f32_16x16x32_bf16 a[36:39], a[188:191], a[236:239], a[36:39]
  buffer_load_dwordx4 v21, s[12:15], s27 offen lds
  v_mfma_f32_16x16x32_bf16 a[40:43], a[188:191], a[240:243], a[40:43]
  ds_read_b64_tr_b16 a[162:163], v26 offset:1024
  ds_read_b64_tr_b16 a[166:167], v27 offset:1024
  v_mfma_f32_16x16x32_bf16 a[44:47], a[188:191], a[244:247], a[44:47]
  ds_read_b64_tr_b16 a[170:171], v28 offset:1024
  ds_read_b64_tr_b16 a[174:175], v29 offset:1024
  v_mfma_f32_16x16x32_bf16 a[48:51], a[192:195], a[232:235], a[48:51]
  ds_read_b128 a[216:219], v31 offset:11264
  s_add_u32 m0, s28, 0
  v_mfma_f32_16x16x32_bf16 a[52:55], a[192:195], a[236:239], a[52:55]
  buffer_load_dwordx4 v13, s[12:15], s27 offen lds
  v_mfma_f32_16x16x32_bf16 a[56:59], a[192:195], a[240:243], a[56:59]
  ds_read_b128 a[220:223], v31 offset:29696
  v_mfma_f32_16x16x32_bf16 a[60:63], a[192:195], a[244:247], a[60:63]
  ds_read_b128 a[224:227], v32 offset:11264
  v_exp_f32 v57, v249
  v_mfma_f32_16x16x32_bf16 a[64:67], a[196:199], a[232:235], a[64:67]
  s_waitcnt lgkmcnt(3)
  ds_read_b128 a[228:231], v32 offset:29696
  v_exp_f32 v58, v250
  v_mfma_f32_16x16x32_bf16 a[68:71], a[196:199], a[236:239], a[68:71]
  buffer_load_dwordx4 v15, s[12:15], s27 offen offset:2048 lds
  v_mfma_f32_16x16x32_bf16 a[72:75], a[196:199], a[240:243], a[72:75]
  v_exp_f32 v59, v251
  v_add_f32 v56, 1.0, v56
  v_add_f32 v57, 1.0, v57
  v_add_f32 v58, 1.0, v58
  v_mfma_f32_16x16x32_bf16 a[76:79], a[196:199], a[244:247], a[76:79]
  v_add_f32 v59, 1.0, v59
  v_rcp_f32 v56, v56
  v_rcp_f32 v57, v57
  v_mfma_f32_16x16x32_bf16 a[80:83], a[200:203], a[232:235], a[80:83]
  s_add_u32 m0, s28, 4096
  v_rcp_f32 v58, v58
  v_mfma_f32_16x16x32_bf16 a[84:87], a[200:203], a[236:239], a[84:87]
  buffer_load_dwordx4 v17, s[12:15], s27 offen lds
  v_mfma_f32_16x16x32_bf16 a[88:91], a[200:203], a[240:243], a[88:91]
  v_rcp_f32 v59, v59
  v_mul_f32 v56, v248, v56
  v_mul_f32 v57, v249, v57
  v_mul_f32 v58, v250, v58
  v_mfma_f32_16x16x32_bf16 a[92:95], a[200:203], a[244:247], a[92:95]
  v_mul_f32 v59, v251, v59
  v_cvt_pk_bf16_f32 v60, v56, v57
  v_cvt_pk_bf16_f32 v61, v58, v59
  v_mfma_f32_16x16x32_bf16 a[96:99], a[204:207], a[232:235], a[96:99]
  ds_write_b64 v34, v[60:61] offset:36864
  v_exp_f32 v64, v252
  v_mfma_f32_16x16x32_bf16 a[100:103], a[204:207], a[236:239], a[100:103]
  buffer_load_dwordx4 v19, s[12:15], s27 offen offset:2048 lds
  v_mfma_f32_16x16x32_bf16 a[104:107], a[204:207], a[240:243], a[104:107]
  v_exp_f32 v65, v253
  v_exp_f32 v66, v254
  v_mfma_f32_16x16x32_bf16 a[108:111], a[204:207], a[244:247], a[108:111]
  v_exp_f32 v67, v255
  v_add_f32 v64, 1.0, v64
  v_add_f32 v65, 1.0, v65
  v_add_f32 v66, 1.0, v66
  v_mfma_f32_16x16x32_bf16 a[112:115], a[208:211], a[232:235], a[112:115]
  s_add_u32 m0, s28, 0
  v_add_f32 v67, 1.0, v67
  v_rcp_f32 v64, v64
  v_mfma_f32_16x16x32_bf16 a[116:119], a[208:211], a[236:239], a[116:119]
  buffer_load_dwordx4 v14, s[12:15], s27 offen offset:1024 lds
  v_mfma_f32_16x16x32_bf16 a[120:123], a[208:211], a[240:243], a[120:123]
  v_rcp_f32 v65, v65
  v_rcp_f32 v66, v66
  v_mfma_f32_16x16x32_bf16 a[124:127], a[208:211], a[244:247], a[124:127]
  v_rcp_f32 v67, v67
  v_mul_f32 v64, v252, v64
  v_mul_f32 v65, v253, v65
  v_mul_f32 v66, v254, v66
  v_mfma_f32_16x16x32_bf16 a[128:131], a[212:215], a[232:235], a[128:131]
  v_mul_f32 v67, v255, v67
  v_cvt_pk_bf16_f32 v68, v64, v65
  v_cvt_pk_bf16_f32 v69, v66, v67
  v_mfma_f32_16x16x32_bf16 a[132:135], a[212:215], a[236:239], a[132:135]
  buffer_load_dwordx4 v16, s[12:15], s27 offen offset:3072 lds
  v_mfma_f32_16x16x32_bf16 a[136:139], a[212:215], a[240:243], a[136:139]
  ds_write_b64 v34, v[68:69] offset:55296
  v_mov_b32 v78, 4
  v_mfma_f32_16x16x32_bf16 a[140:143], a[212:215], a[244:247], a[140:143]
  s_waitcnt lgkmcnt(2)
  ds_write_b32 v110, v78
  s_waitcnt vmcnt(11)
  v_mfma_f32_16x16x32_bf16 a[0:3], a[144:147], a[216:219], a[0:3]
  s_add_u32 m0, s28, 4096
  ds_read_b64_tr_b16 a[212:213], v30 offset:9216
  ds_read_b64_tr_b16 a[214:215], v30 offset:9472
  v_mfma_f32_16x16x32_bf16 a[4:7], a[144:147], a[220:223], a[4:7]
  buffer_load_dwordx4 v18, s[12:15], s27 offen offset:1024 lds
  v_mfma_f32_16x16x32_bf16 a[8:11], a[144:147], a[224:227], a[8:11]
  ds_read_b64_tr_b16 a[180:181], v22 offset:9216
  ds_read_b64_tr_b16 a[184:185], v23 offset:9216
  v_mfma_f32_16x16x32_bf16 a[12:15], a[144:147], a[228:231], a[12:15]
  ds_read_b64_tr_b16 a[188:189], v24 offset:9216
  ds_read_b64_tr_b16 a[192:193], v25 offset:9216
  v_mfma_f32_16x16x32_bf16 a[16:19], a[148:151], a[216:219], a[16:19]
  ds_read_b64_tr_b16 a[196:197], v26 offset:9216
  ds_read_b64_tr_b16 a[200:201], v27 offset:9216
  v_mfma_f32_16x16x32_bf16 a[20:23], a[148:151], a[220:223], a[20:23]
  buffer_load_dwordx4 v20, s[12:15], s27 offen offset:3072 lds
  v_mfma_f32_16x16x32_bf16 a[24:27], a[148:151], a[224:227], a[24:27]
  ds_read_b64_tr_b16 a[204:205], v28 offset:9216
  ds_read_b64_tr_b16 a[208:209], v29 offset:9216
  v_mfma_f32_16x16x32_bf16 a[28:31], a[148:151], a[228:231], a[28:31]
  s_waitcnt vmcnt(9)
  ds_read_b64_tr_b16 a[182:183], v22 offset:10240
  ds_read_b64_tr_b16 a[186:187], v23 offset:10240
  v_mfma_f32_16x16x32_bf16 a[32:35], a[152:155], a[216:219], a[32:35]
  ds_read_b64_tr_b16 a[190:191], v24 offset:10240
  ds_read_b64_tr_b16 a[194:195], v25 offset:10240
  s_waitcnt lgkmcnt(4)
  s_add_u32 s31, s30, 626688
  s_add_u32 m0, s28, 17408
  v_mfma_f32_16x16x32_bf16 a[36:39], a[152:155], a[220:223], a[36:39]
  buffer_load_dwordx4 v21, s[12:15], s31 offen lds
  v_mfma_f32_16x16x32_bf16 a[40:43], a[152:155], a[224:227], a[40:43]
  ds_read_b64_tr_b16 a[198:199], v26 offset:10240
  ds_read_b64_tr_b16 a[202:203], v27 offset:10240
  v_mfma_f32_16x16x32_bf16 a[44:47], a[152:155], a[228:231], a[44:47]
  ds_read_b64_tr_b16 a[206:207], v28 offset:10240
  ds_read_b64_tr_b16 a[210:211], v29 offset:10240
  v_mfma_f32_16x16x32_bf16 a[48:51], a[156:159], a[216:219], a[48:51]
  ds_read_b128 a[232:235], v31 offset:15360
  s_add_u32 m0, s28, 9216
  v_mfma_f32_16x16x32_bf16 a[52:55], a[156:159], a[220:223], a[52:55]
  buffer_load_dwordx4 v13, s[12:15], s31 offen lds
  v_mfma_f32_16x16x32_bf16 a[56:59], a[156:159], a[224:227], a[56:59]
  ds_read_b128 a[236:239], v31 offset:33792
  v_mfma_f32_16x16x32_bf16 a[60:63], a[156:159], a[228:231], a[60:63]
  ds_read_b128 a[240:243], v32 offset:15360
  v_mfma_f32_16x16x32_bf16 a[64:67], a[160:163], a[216:219], a[64:67]
  s_waitcnt lgkmcnt(3)
  ds_read_b128 a[244:247], v32 offset:33792
  v_mfma_f32_16x16x32_bf16 a[68:71], a[160:163], a[220:223], a[68:71]
  buffer_load_dwordx4 v15, s[12:15], s31 offen offset:2048 lds
  v_mfma_f32_16x16x32_bf16 a[72:75], a[160:163], a[224:227], a[72:75]
  v_mfma_f32_16x16x32_bf16 a[76:79], a[160:163], a[228:231], a[76:79]
  v_mfma_f32_16x16x32_bf16 a[80:83], a[164:167], a[216:219], a[80:83]
  s_add_u32 m0, s28, 13312
  v_mfma_f32_16x16x32_bf16 a[84:87], a[164:167], a[220:223], a[84:87]
  buffer_load_dwordx4 v17, s[12:15], s31 offen lds
  v_mfma_f32_16x16x32_bf16 a[88:91], a[164:167], a[224:227], a[88:91]
  v_mfma_f32_16x16x32_bf16 a[92:95], a[164:167], a[228:231], a[92:95]
  v_mfma_f32_16x16x32_bf16 a[96:99], a[168:171], a[216:219], a[96:99]
  v_mfma_f32_16x16x32_bf16 a[100:103], a[168:171], a[220:223], a[100:103]
  buffer_load_dwordx4 v19, s[12:15], s31 offen offset:2048 lds
  v_mfma_f32_16x16x32_bf16 a[104:107], a[168:171], a[224:227], a[104:107]
  v_mfma_f32_16x16x32_bf16 a[108:111], a[168:171], a[228:231], a[108:111]
  s_mul_i32 s42, s2, 3641
  v_mfma_f32_16x16x32_bf16 a[112:115], a[172:175], a[216:219], a[112:115]
  s_add_u32 m0, s28, 9216
  s_lshr_b32 s42, s42, 16
  s_lshl_b32 s42, s42, 7
  v_mfma_f32_16x16x32_bf16 a[116:119], a[172:175], a[220:223], a[116:119]
  buffer_load_dwordx4 v14, s[12:15], s31 offen offset:1024 lds
  v_mfma_f32_16x16x32_bf16 a[120:123], a[172:175], a[224:227], a[120:123]
  s_add_u32 s42, s42, 4718592
  v_mfma_f32_16x16x32_bf16 a[124:127], a[172:175], a[228:231], a[124:127]
  s_lshl_b32 s40, s2, 2
  s_add_u32 s40, s40, s24
  s_min_u32 s40, s40, 575
  v_mfma_f32_16x16x32_bf16 a[128:131], a[176:179], a[216:219], a[128:131]
  s_lshl_b32 s41, s40, 12
  v_and_b32 v86, 31, v2
  v_lshlrev_b32 v86, 2, v86
  v_mfma_f32_16x16x32_bf16 a[132:135], a[176:179], a[220:223], a[132:135]
  buffer_load_dwordx4 v16, s[12:15], s31 offen offset:3072 lds
  v_mfma_f32_16x16x32_bf16 a[136:139], a[176:179], a[224:227], a[136:139]
  buffer_load_dword v87, v86, s[16:19], s42 offen sc1
  v_mfma_f32_16x16x32_bf16 a[140:143], a[176:179], a[228:231], a[140:143]
  s_waitcnt lgkmcnt(0)
  s_waitcnt vmcnt(12)
  v_mfma_f32_16x16x32_bf16 a[0:3], a[180:183], a[232:235], a[0:3]
  s_add_u32 m0, s28, 13312
  ds_read_b64_tr_b16 a[176:177], v30 offset:0
  ds_read_b64_tr_b16 a[178:179], v30 offset:256
  v_mfma_f32_16x16x32_bf16 a[4:7], a[180:183], a[236:239], a[4:7]
  buffer_load_dwordx4 v18, s[12:15], s31 offen offset:1024 lds
  v_mfma_f32_16x16x32_bf16 a[8:11], a[180:183], a[240:243], a[8:11]
  ds_read_b64_tr_b16 a[144:145], v22 offset:0
  ds_read_b64_tr_b16 a[148:149], v23 offset:0
  v_mfma_f32_16x16x32_bf16 a[12:15], a[180:183], a[244:247], a[12:15]
  ds_read_b64_tr_b16 a[152:153], v24 offset:0
  ds_read_b64_tr_b16 a[156:157], v25 offset:0
  v_mfma_f32_16x16x32_bf16 a[16:19], a[184:187], a[232:235], a[16:19]
  ds_read_b64_tr_b16 a[160:161], v26 offset:0
  ds_read_b64_tr_b16 a[164:165], v27 offset:0
  v_mfma_f32_16x16x32_bf16 a[20:23], a[184:187], a[236:239], a[20:23]
  buffer_load_dwordx4 v20, s[12:15], s31 offen offset:3072 lds
  v_mfma_f32_16x16x32_bf16 a[24:27], a[184:187], a[240:243], a[24:27]
  ds_read_b64_tr_b16 a[168:169], v28 offset:0
  ds_read_b64_tr_b16 a[172:173], v29 offset:0
  v_mfma_f32_16x16x32_bf16 a[28:31], a[184:187], a[244:247], a[28:31]
  s_waitcnt vmcnt(10)
  ds_read_b64_tr_b16 a[146:147], v22 offset:1024
  ds_read_b64_tr_b16 a[150:151], v23 offset:1024
  v_mfma_f32_16x16x32_bf16 a[32:35], a[188:191], a[232:235], a[32:35]
  ds_read_b64_tr_b16 a[154:155], v24 offset:1024
  ds_read_b64_tr_b16 a[158:159], v25 offset:1024
  s_waitcnt lgkmcnt(4)
  v_mfma_f32_16x16x32_bf16 a[36:39], a[188:191], a[236:239], a[36:39]
  v_mfma_f32_16x16x32_bf16 a[40:43], a[188:191], a[240:243], a[40:43]
  ds_read_b64_tr_b16 a[162:163], v26 offset:1024
  ds_read_b64_tr_b16 a[166:167], v27 offset:1024
  v_mfma_f32_16x16x32_bf16 a[44:47], a[188:191], a[244:247], a[44:47]
  ds_read_b64_tr_b16 a[170:171], v28 offset:1024
  ds_read_b64_tr_b16 a[174:175], v29 offset:1024
  v_mfma_f32_16x16x32_bf16 a[48:51], a[192:195], a[232:235], a[48:51]
  v_mfma_f32_16x16x32_bf16 a[52:55], a[192:195], a[236:239], a[52:55]
  v_mfma_f32_16x16x32_bf16 a[56:59], a[192:195], a[240:243], a[56:59]
  v_mfma_f32_16x16x32_bf16 a[60:63], a[192:195], a[244:247], a[60:63]
  v_mfma_f32_16x16x32_bf16 a[64:67], a[196:199], a[232:235], a[64:67]
  s_waitcnt lgkmcnt(0)
  v_mfma_f32_16x16x32_bf16 a[68:71], a[196:199], a[236:239], a[68:71]
  v_mfma_f32_16x16x32_bf16 a[72:75], a[196:199], a[240:243], a[72:75]
  ds_read_b128 v[72:75], v111
  v_mfma_f32_16x16x32_bf16 a[76:79], a[196:199], a[244:247], a[76:79]
  v_mfma_f32_16x16x32_bf16 a[80:83], a[200:203], a[232:235], a[80:83]
  v_mfma_f32_16x16x32_bf16 a[84:87], a[200:203], a[236:239], a[84:87]
  v_mfma_f32_16x16x32_bf16 a[88:91], a[200:203], a[240:243], a[88:91]
  v_mfma_f32_16x16x32_bf16 a[92:95], a[200:203], a[244:247], a[92:95]
  v_mfma_f32_16x16x32_bf16 a[96:99], a[204:207], a[232:235], a[96:99]
  s_waitcnt lgkmcnt(0)
  v_min3_u32 v72, v72, v73, v74
  v_min_u32 v72, v72, v75
  s_nop 0
  v_readfirstlane_b32 s34, v72
  s_nop 1
  s_cmp_ge_u32 s34, 4
  s_cbranch_scc1 FG33_OK
  FG33_SPIN:
  ds_read_b128 v[72:75], v111
  s_waitcnt lgkmcnt(0)
  v_min3_u32 v72, v72, v73, v74
  v_min_u32 v72, v72, v75
  s_nop 0
  v_readfirstlane_b32 s34, v72
  s_nop 1
  s_cmp_lt_u32 s34, 4
  s_cbranch_scc1 FG33_SPIN
  FG33_OK:
  v_mfma_f32_16x16x32_bf16 a[100:103], a[204:207], a[236:239], a[100:103]
  v_mfma_f32_16x16x32_bf16 a[104:107], a[204:207], a[240:243], a[104:107]
  ds_read_b128 a[216:219], v31 offset:16384
  v_mfma_f32_16x16x32_bf16 a[108:111], a[204:207], a[244:247], a[108:111]
  ds_read_b128 a[220:223], v31 offset:34816
  v_mfma_f32_16x16x32_bf16 a[112:115], a[208:211], a[232:235], a[112:115]
  ds_read_b128 a[224:227], v32 offset:16384
  v_mfma_f32_16x16x32_bf16 a[116:119], a[208:211], a[236:239], a[116:119]
  v_mfma_f32_16x16x32_bf16 a[120:123], a[208:211], a[240:243], a[120:123]
  ds_read_b128 a[228:231], v32 offset:34816
  v_mfma_f32_16x16x32_bf16 a[124:127], a[208:211], a[244:247], a[124:127]
  v_mfma_f32_16x16x32_bf16 a[128:131], a[212:215], a[232:235], a[128:131]
  v_mfma_f32_16x16x32_bf16 a[132:135], a[212:215], a[236:239], a[132:135]
  v_mfma_f32_16x16x32_bf16 a[136:139], a[212:215], a[240:243], a[136:139]
  v_mfma_f32_16x16x32_bf16 a[140:143], a[212:215], a[244:247], a[140:143]
  s_waitcnt lgkmcnt(0)
  s_waitcnt vmcnt(2)
  s_cmp_ge_u32 s2, 144
  s_cbranch_scc1 K_UR_OK
  v_cmp_ne_u32 vcc, s94, v87
  s_nop 3
  s_cmp_eq_u64 vcc, 0
  s_cbranch_scc1 K_UR_OK
  s_mov_b32 s47, 1048576
POLL1_UR:
  buffer_load_dword v87, v86, s[16:19], s42 offen sc1
  s_waitcnt vmcnt(0)
  v_cmp_ne_u32 vcc, s94, v87
  s_nop 3
  s_cmp_eq_u64 vcc, 0
  s_cbranch_scc1 POLL1_UR_X
  s_sub_u32 s47, s47, 1
  s_cbranch_scc1 POLL1_UR_X
  s_sleep 1
  s_branch POLL1_UR
POLL1_UR_X:
K_UR_OK:
  v_mfma_f32_16x16x32_bf16 a[0:3], a[144:147], a[216:219], a[0:3]
  ds_read_b64_tr_b16 a[212:213], v30 offset:9216
  ds_read_b64_tr_b16 a[214:215], v30 offset:9472
  v_mfma_f32_16x16x32_bf16 a[4:7], a[144:147], a[220:223], a[4:7]
  v_mfma_f32_16x16x32_bf16 a[8:11], a[144:147], a[224:227], a[8:11]
  ds_read_b64_tr_b16 a[180:181], v22 offset:9216
  ds_read_b64_tr_b16 a[184:185], v23 offset:9216
  v_mfma_f32_16x16x32_bf16 a[12:15], a[144:147], a[228:231], a[12:15]
  ds_read_b64_tr_b16 a[188:189], v24 offset:9216
  ds_read_b64_tr_b16 a[192:193], v25 offset:9216
  v_mfma_f32_16x16x32_bf16 a[16:19], a[148:151], a[216:219], a[16:19]
  ds_read_b64_tr_b16 a[196:197], v26 offset:9216
  ds_read_b64_tr_b16 a[200:201], v27 offset:9216
  v_mfma_f32_16x16x32_bf16 a[20:23], a[148:151], a[220:223], a[20:23]
  v_mfma_f32_16x16x32_bf16 a[24:27], a[148:151], a[224:227], a[24:27]
  ds_read_b64_tr_b16 a[204:205], v28 offset:9216
  ds_read_b64_tr_b16 a[208:209], v29 offset:9216
  v_mfma_f32_16x16x32_bf16 a[28:31], a[148:151], a[228:231], a[28:31]
  s_waitcnt vmcnt(0)
  ds_read_b64_tr_b16 a[182:183], v22 offset:10240
  ds_read_b64_tr_b16 a[186:187], v23 offset:10240
  v_mfma_f32_16x16x32_bf16 a[32:35], a[152:155], a[216:219], a[32:35]
  ds_read_b64_tr_b16 a[190:191], v24 offset:10240
  ds_read_b64_tr_b16 a[194:195], v25 offset:10240
  s_waitcnt lgkmcnt(4)
  v_mfma_f32_16x16x32_bf16 a[36:39], a[152:155], a[220:223], a[36:39]
  v_mfma_f32_16x16x32_bf16 a[40:43], a[152:155], a[224:227], a[40:43]
  ds_read_b64_tr_b16 a[198:199], v26 offset:10240
  ds_read_b64_tr_b16 a[202:203], v27 offset:10240
  v_mfma_f32_16x16x32_bf16 a[44:47], a[152:155], a[228:231], a[44:47]
  ds_read_b64_tr_b16 a[206:207], v28 offset:10240
  ds_read_b64_tr_b16 a[210:211], v29 offset:10240
  v_mfma_f32_16x16x32_bf16 a[48:51], a[156:159], a[216:219], a[48:51]
  ds_read_b128 a[232:235], v31 offset:17408
  v_mfma_f32_16x16x32_bf16 a[52:55], a[156:159], a[220:223], a[52:55]
  v_mfma_f32_16x16x32_bf16 a[56:59], a[156:159], a[224:227], a[56:59]
  ds_read_b128 a[236:239], v31 offset:35840
  v_mfma_f32_16x16x32_bf16 a[60:63], a[156:159], a[228:231], a[60:63]
  ds_read_b128 a[240:243], v32 offset:17408
  v_mfma_f32_16x16x32_bf16 a[64:67], a[160:163], a[216:219], a[64:67]
  s_waitcnt lgkmcnt(3)
  ds_read_b128 a[244:247], v32 offset:35840
  v_mfma_f32_16x16x32_bf16 a[68:71], a[160:163], a[220:223], a[68:71]
  v_mfma_f32_16x16x32_bf16 a[72:75], a[160:163], a[224:227], a[72:75]
  v_mfma_f32_16x16x32_bf16 a[76:79], a[160:163], a[228:231], a[76:79]
  s_add_u32 s42, s41, 0
  v_mfma_f32_16x16x32_bf16 a[80:83], a[164:167], a[216:219], a[80:83]
  buffer_load_dwordx4 v[172:175], v35, s[16:19], s42 offen sc1
  v_mfma_f32_16x16x32_bf16 a[84:87], a[164:167], a[220:223], a[84:87]
  v_mfma_f32_16x16x32_bf16 a[88:91], a[164:167], a[224:227], a[88:91]
  buffer_load_dwordx4 v[176:179], v35, s[16:19], s42 offen offset:1024 sc1
  v_mfma_f32_16x16x32_bf16 a[92:95], a[164:167], a[228:231], a[92:95]
  buffer_load_dwordx4 v[180:183], v35, s[16:19], s42 offen offset:2048 sc1
  v_mfma_f32_16x16x32_bf16 a[96:99], a[168:171], a[216:219], a[96:99]
  v_mfma_f32_16x16x32_bf16 a[100:103], a[168:171], a[220:223], a[100:103]
  buffer_load_dwordx4 v[184:187], v35, s[16:19], s42 offen offset:3072 sc1
  v_mfma_f32_16x16x32_bf16 a[104:107], a[168:171], a[224:227], a[104:107]
  v_add_u32 v38, s41, v35
  v_subrev_u32 v39, 32, v38
  v_mfma_f32_16x16x32_bf16 a[108:111], a[168:171], a[228:231], a[108:111]
  v_max_i32 v39, 0, v39
  v_add_u32 v38, 992, v38
  v_mfma_f32_16x16x32_bf16 a[112:115], a[172:175], a[216:219], a[112:115]
  buffer_load_dwordx4 v[112:115], v39, s[20:23], 0 offen offset:0
  v_mfma_f32_16x16x32_bf16 a[116:119], a[172:175], a[220:223], a[116:119]
  v_mfma_f32_16x16x32_bf16 a[120:123], a[172:175], a[224:227], a[120:123]
  buffer_load_dwordx4 v[116:119], v38, s[20:23], 0 offen offset:0
  v_mfma_f32_16x16x32_bf16 a[124:127], a[172:175], a[228:231], a[124:127]
  buffer_load_dwordx4 v[120:123], v38, s[20:23], 0 offen offset:1024
  v_mfma_f32_16x16x32_bf16 a[128:131], a[176:179], a[216:219], a[128:131]
  v_mfma_f32_16x16x32_bf16 a[132:135], a[176:179], a[220:223], a[132:135]
  buffer_load_dwordx4 v[124:127], v38, s[20:23], 0 offen offset:2048
  v_mfma_f32_16x16x32_bf16 a[136:139], a[176:179], a[224:227], a[136:139]
  buffer_load_dwordx4 v[128:131], v38, s[20:23], 0 offen offset:3072
  v_mfma_f32_16x16x32_bf16 a[140:143], a[176:179], a[228:231], a[140:143]
  s_waitcnt lgkmcnt(0)
  v_mfma_f32_16x16x32_bf16 a[0:3], a[180:183], a[232:235], a[0:3]
  v_mfma_f32_16x16x32_bf16 a[4:7], a[180:183], a[236:239], a[4:7]
  v_mfma_f32_16x16x32_bf16 a[8:11], a[180:183], a[240:243], a[8:11]
  v_mfma_f32_16x16x32_bf16 a[12:15], a[180:183], a[244:247], a[12:15]
  buffer_load_dwordx4 v[132:135], v39, s[20:23], 0 offen offset:4
  v_mfma_f32_16x16x32_bf16 a[16:19], a[184:187], a[232:235], a[16:19]
  v_mfma_f32_16x16x32_bf16 a[20:23], a[184:187], a[236:239], a[20:23]
  v_mfma_f32_16x16x32_bf16 a[24:27], a[184:187], a[240:243], a[24:27]
  v_mfma_f32_16x16x32_bf16 a[28:31], a[184:187], a[244:247], a[28:31]
  buffer_load_dwordx4 v[136:139], v38, s[20:23], 0 offen offset:4
  v_mfma_f32_16x16x32_bf16 a[32:35], a[188:191], a[232:235], a[32:35]
  v_mfma_f32_16x16x32_bf16 a[36:39], a[188:191], a[236:239], a[36:39]
  v_mfma_f32_16x16x32_bf16 a[40:43], a[188:191], a[240:243], a[40:43]
  buffer_load_dwordx4 v[140:143], v38, s[20:23], 0 offen offset:1028
  v_mfma_f32_16x16x32_bf16 a[44:47], a[188:191], a[244:247], a[44:47]
  v_mfma_f32_16x16x32_bf16 a[48:51], a[192:195], a[232:235], a[48:51]
  v_mfma_f32_16x16x32_bf16 a[52:55], a[192:195], a[236:239], a[52:55]
  buffer_load_dwordx4 v[144:147], v38, s[20:23], 0 offen offset:2052
  v_mfma_f32_16x16x32_bf16 a[56:59], a[192:195], a[240:243], a[56:59]
  v_mfma_f32_16x16x32_bf16 a[60:63], a[192:195], a[244:247], a[60:63]
  v_mfma_f32_16x16x32_bf16 a[64:67], a[196:199], a[232:235], a[64:67]
  v_mfma_f32_16x16x32_bf16 a[68:71], a[196:199], a[236:239], a[68:71]
  buffer_load_dwordx4 v[148:151], v38, s[20:23], 0 offen offset:3076
  v_mfma_f32_16x16x32_bf16 a[72:75], a[196:199], a[240:243], a[72:75]
  v_mfma_f32_16x16x32_bf16 a[76:79], a[196:199], a[244:247], a[76:79]
  v_mfma_f32_16x16x32_bf16 a[80:83], a[200:203], a[232:235], a[80:83]
  buffer_load_dwordx4 v[152:155], v39, s[20:23], 0 offen offset:8
  v_mfma_f32_16x16x32_bf16 a[84:87], a[200:203], a[236:239], a[84:87]
  v_mfma_f32_16x16x32_bf16 a[88:91], a[200:203], a[240:243], a[88:91]
  v_mfma_f32_16x16x32_bf16 a[92:95], a[200:203], a[244:247], a[92:95]
  v_mfma_f32_16x16x32_bf16 a[96:99], a[204:207], a[232:235], a[96:99]
  buffer_load_dwordx4 v[156:159], v38, s[20:23], 0 offen offset:8
  v_mfma_f32_16x16x32_bf16 a[100:103], a[204:207], a[236:239], a[100:103]
  v_mfma_f32_16x16x32_bf16 a[104:107], a[204:207], a[240:243], a[104:107]
  v_mfma_f32_16x16x32_bf16 a[108:111], a[204:207], a[244:247], a[108:111]
  buffer_load_dwordx4 v[160:163], v38, s[20:23], 0 offen offset:1032
  v_mfma_f32_16x16x32_bf16 a[112:115], a[208:211], a[232:235], a[112:115]
  v_mfma_f32_16x16x32_bf16 a[116:119], a[208:211], a[236:239], a[116:119]
  v_mfma_f32_16x16x32_bf16 a[120:123], a[208:211], a[240:243], a[120:123]
  buffer_load_dwordx4 v[164:167], v38, s[20:23], 0 offen offset:2056
  v_mfma_f32_16x16x32_bf16 a[124:127], a[208:211], a[244:247], a[124:127]
  v_mfma_f32_16x16x32_bf16 a[128:131], a[212:215], a[232:235], a[128:131]
  v_mfma_f32_16x16x32_bf16 a[132:135], a[212:215], a[236:239], a[132:135]
  v_mfma_f32_16x16x32_bf16 a[136:139], a[212:215], a[240:243], a[136:139]
  buffer_load_dwordx4 v[168:171], v38, s[20:23], 0 offen offset:3080
  v_mfma_f32_16x16x32_bf16 a[140:143], a[212:215], a[244:247], a[140:143]
  s_mul_i32 s31, s25, 2359296
  s_lshl_b32 s34, s26, 2
  s_add_u32 s34, s34, s24
  s_mul_i32 s34, s34, 18432
  s_add_u32 s31, s31, s34
  s_add_u32 s31, s31, 4784128
  s_cmp_lt_u32 s2, 144
  s_cbranch_scc1 K_CONV
  s_nop 7
  v_accvgpr_read_b32 v40, a0
  v_accvgpr_read_b32 v41, a1
  v_accvgpr_read_b32 v42, a2
  v_accvgpr_read_b32 v43, a3
  v_accvgpr_read_b32 v44, a4
  v_accvgpr_read_b32 v45, a5
  v_accvgpr_read_b32 v46, a6
  v_accvgpr_read_b32 v47, a7
  v_cvt_pk_bf16_f32 v48, v40, v41
  v_cvt_pk_bf16_f32 v49, v42, v43
  v_cvt_pk_bf16_f32 v50, v44, v45
  v_cvt_pk_bf16_f32 v51, v46, v47
  s_add_u32 s35, s31, 0
  buffer_store_dwordx4 v[48:51], v35, s[16:19], s35 offen sc1
  v_accvgpr_read_b32 v52, a16
  v_accvgpr_read_b32 v53, a17
  v_accvgpr_read_b32 v54, a18
  v_accvgpr_read_b32 v55, a19
  v_accvgpr_read_b32 v56, a20
  v_accvgpr_read_b32 v57, a21
  v_accvgpr_read_b32 v58, a22
  v_accvgpr_read_b32 v59, a23
  v_cvt_pk_bf16_f32 v60, v52, v53
  v_cvt_pk_bf16_f32 v61, v54, v55
  v_cvt_pk_bf16_f32 v62, v56, v57
  v_cvt_pk_bf16_f32 v63, v58, v59
  buffer_store_dwordx4 v[60:63], v35, s[16:19], s35 offen offset:1024 sc1
  v_accvgpr_read_b32 v64, a32
  v_accvgpr_read_b32 v65, a33
  v_accvgpr_read_b32 v66, a34
  v_accvgpr_read_b32 v67, a35
  v_accvgpr_read_b32 v68, a36
  v_accvgpr_read_b32 v69, a37
  v_accvgpr_read_b32 v70, a38
  v_accvgpr_read_b32 v71, a39
  v_cvt_pk_bf16_f32 v72, v64, v65
  v_cvt_pk_bf16_f32 v73, v66, v67
  v_cvt_pk_bf16_f32 v74, v68, v69
  v_cvt_pk_bf16_f32 v75, v70, v71
  buffer_store_dwordx4 v[72:75], v35, s[16:19], s35 offen offset:2048 sc1
  v_accvgpr_read_b32 v40, a48
  v_accvgpr_read_b32 v41, a49
  v_accvgpr_read_b32 v42, a50
  v_accvgpr_read_b32 v43, a51
  v_accvgpr_read_b32 v44, a52
  v_accvgpr_read_b32 v45, a53
  v_accvgpr_read_b32 v46, a54
  v_accvgpr_read_b32 v47, a55
  v_cvt_pk_bf16_f32 v48, v40, v41
  v_cvt_pk_bf16_f32 v49, v42, v43
  v_cvt_pk_bf16_f32 v50, v44, v45
  v_cvt_pk_bf16_f32 v51, v46, v47
  buffer_store_dwordx4 v[48:51], v35, s[16:19], s35 offen offset:3072 sc1
  v_accvgpr_read_b32 v52, a64
  v_accvgpr_read_b32 v53, a65
  v_accvgpr_read_b32 v54, a66
  v_accvgpr_read_b32 v55, a67
  v_accvgpr_read_b32 v56, a68
  v_accvgpr_read_b32 v57, a69
  v_accvgpr_read_b32 v58, a70
  v_accvgpr_read_b32 v59, a71
  v_cvt_pk_bf16_f32 v60, v52, v53
  v_cvt_pk_bf16_f32 v61, v54, v55
  v_cvt_pk_bf16_f32 v62, v56, v57
  v_cvt_pk_bf16_f32 v63, v58, v59
  s_add_u32 s35, s31, 4096
  buffer_store_dwordx4 v[60:63], v35, s[16:19], s35 offen sc1
  v_accvgpr_read_b32 v64, a80
  v_accvgpr_read_b32 v65, a81
  v_accvgpr_read_b32 v66, a82
  v_accvgpr_read_b32 v67, a83
  v_accvgpr_read_b32 v68, a84
  v_accvgpr_read_b32 v69, a85
  v_accvgpr_read_b32 v70, a86
  v_accvgpr_read_b32 v71, a87
  v_cvt_pk_bf16_f32 v72, v64, v65
  v_cvt_pk_bf16_f32 v73, v66, v67
  v_cvt_pk_bf16_f32 v74, v68, v69
  v_cvt_pk_bf16_f32 v75, v70, v71
  buffer_store_dwordx4 v[72:75], v35, s[16:19], s35 offen offset:1024 sc1
  v_accvgpr_read_b32 v40, a96
  v_accvgpr_read_b32 v41, a97
  v_accvgpr_read_b32 v42, a98
  v_accvgpr_read_b32 v43, a99
  v_accvgpr_read_b32 v44, a100
  v_accvgpr_read_b32 v45, a101
  v_accvgpr_read_b32 v46, a102
  v_accvgpr_read_b32 v47, a103
  v_cvt_pk_bf16_f32 v48, v40, v41
  v_cvt_pk_bf16_f32 v49, v42, v43
  v_cvt_pk_bf16_f32 v50, v44, v45
  v_cvt_pk_bf16_f32 v51, v46, v47
  buffer_store_dwordx4 v[48:51], v35, s[16:19], s35 offen offset:2048 sc1
  v_accvgpr_read_b32 v52, a112
  v_accvgpr_read_b32 v53, a113
  v_accvgpr_read_b32 v54, a114
  v_accvgpr_read_b32 v55, a115
  v_accvgpr_read_b32 v56, a116
  v_accvgpr_read_b32 v57, a117
  v_accvgpr_read_b32 v58, a118
  v_accvgpr_read_b32 v59, a119
  v_cvt_pk_bf16_f32 v60, v52, v53
  v_cvt_pk_bf16_f32 v61, v54, v55
  v_cvt_pk_bf16_f32 v62, v56, v57
  v_cvt_pk_bf16_f32 v63, v58, v59
  buffer_store_dwordx4 v[60:63], v35, s[16:19], s35 offen offset:3072 sc1
  v_accvgpr_read_b32 v64, a128
  v_accvgpr_read_b32 v65, a129
  v_accvgpr_read_b32 v66, a130
  v_accvgpr_read_b32 v67, a131
  v_accvgpr_read_b32 v68, a132
  v_accvgpr_read_b32 v69, a133
  v_accvgpr_read_b32 v70, a134
  v_accvgpr_read_b32 v71, a135
  v_cvt_pk_bf16_f32 v72, v64, v65
  v_cvt_pk_bf16_f32 v73, v66, v67
  v_cvt_pk_bf16_f32 v74, v68, v69
  v_cvt_pk_bf16_f32 v75, v70, v71
  s_add_u32 s35, s31, 8192
  buffer_store_dwordx4 v[72:75], v35, s[16:19], s35 offen sc1
  v_accvgpr_read_b32 v40, a8
  v_accvgpr_read_b32 v41, a9
  v_accvgpr_read_b32 v42, a10
  v_accvgpr_read_b32 v43, a11
  v_accvgpr_read_b32 v44, a12
  v_accvgpr_read_b32 v45, a13
  v_accvgpr_read_b32 v46, a14
  v_accvgpr_read_b32 v47, a15
  v_cvt_pk_bf16_f32 v48, v40, v41
  v_cvt_pk_bf16_f32 v49, v42, v43
  v_cvt_pk_bf16_f32 v50, v44, v45
  v_cvt_pk_bf16_f32 v51, v46, v47
  buffer_store_dwordx4 v[48:51], v35, s[16:19], s35 offen offset:1024 sc1
  v_accvgpr_read_b32 v52, a24
  v_accvgpr_read_b32 v53, a25
  v_accvgpr_read_b32 v54, a26
  v_accvgpr_read_b32 v55, a27
  v_accvgpr_read_b32 v56, a28
  v_accvgpr_read_b32 v57, a29
  v_accvgpr_read_b32 v58, a30
  v_accvgpr_read_b32 v59, a31
  v_cvt_pk_bf16_f32 v60, v52, v53
  v_cvt_pk_bf16_f32 v61, v54, v55
  v_cvt_pk_bf16_f32 v62, v56, v57
  v_cvt_pk_bf16_f32 v63, v58, v59
  buffer_store_dwordx4 v[60:63], v35, s[16:19], s35 offen offset:2048 sc1
  v_accvgpr_read_b32 v64, a40
  v_accvgpr_read_b32 v65, a41
  v_accvgpr_read_b32 v66, a42
  v_accvgpr_read_b32 v67, a43
  v_accvgpr_read_b32 v68, a44
  v_accvgpr_read_b32 v69, a45
  v_accvgpr_read_b32 v70, a46
  v_accvgpr_read_b32 v71, a47
  v_cvt_pk_bf16_f32 v72, v64, v65
  v_cvt_pk_bf16_f32 v73, v66, v67
  v_cvt_pk_bf16_f32 v74, v68, v69
  v_cvt_pk_bf16_f32 v75, v70, v71
  buffer_store_dwordx4 v[72:75], v35, s[16:19], s35 offen offset:3072 sc1
  v_accvgpr_read_b32 v40, a56
  v_accvgpr_read_b32 v41, a57
  v_accvgpr_read_b32 v42, a58
  v_accvgpr_read_b32 v43, a59
  v_accvgpr_read_b32 v44, a60
  v_accvgpr_read_b32 v45, a61
  v_accvgpr_read_b32 v46, a62
  v_accvgpr_read_b32 v47, a63
  v_cvt_pk_bf16_f32 v48, v40, v41
  v_cvt_pk_bf16_f32 v49, v42, v43
  v_cvt_pk_bf16_f32 v50, v44, v45
  v_cvt_pk_bf16_f32 v51, v46, v47
  s_add_u32 s35, s31, 12288
  buffer_store_dwordx4 v[48:51], v35, s[16:19], s35 offen sc1
  v_accvgpr_read_b32 v52, a72
  v_accvgpr_read_b32 v53, a73
  v_accvgpr_read_b32 v54, a74
  v_accvgpr_read_b32 v55, a75
  v_accvgpr_read_b32 v56, a76
  v_accvgpr_read_b32 v57, a77
  v_accvgpr_read_b32 v58, a78
  v_accvgpr_read_b32 v59, a79
  v_cvt_pk_bf16_f32 v60, v52, v53
  v_cvt_pk_bf16_f32 v61, v54, v55
  v_cvt_pk_bf16_f32 v62, v56, v57
  v_cvt_pk_bf16_f32 v63, v58, v59
  buffer_store_dwordx4 v[60:63], v35, s[16:19], s35 offen offset:1024 sc1
  v_accvgpr_read_b32 v64, a88
  v_accvgpr_read_b32 v65, a89
  v_accvgpr_read_b32 v66, a90
  v_accvgpr_read_b32 v67, a91
  v_accvgpr_read_b32 v68, a92
  v_accvgpr_read_b32 v69, a93
  v_accvgpr_read_b32 v70, a94
  v_accvgpr_read_b32 v71, a95
  v_cvt_pk_bf16_f32 v72, v64, v65
  v_cvt_pk_bf16_f32 v73, v66, v67
  v_cvt_pk_bf16_f32 v74, v68, v69
  v_cvt_pk_bf16_f32 v75, v70, v71
  buffer_store_dwordx4 v[72:75], v35, s[16:19], s35 offen offset:2048 sc1
  v_accvgpr_read_b32 v40, a104
  v_accvgpr_read_b32 v41, a105
  v_accvgpr_read_b32 v42, a106
  v_accvgpr_read_b32 v43, a107
  v_accvgpr_read_b32 v44, a108
  v_accvgpr_read_b32 v45, a109
  v_accvgpr_read_b32 v46, a110
  v_accvgpr_read_b32 v47, a111
  v_cvt_pk_bf16_f32 v48, v40, v41
  v_cvt_pk_bf16_f32 v49, v42, v43
  v_cvt_pk_bf16_f32 v50, v44, v45
  v_cvt_pk_bf16_f32 v51, v46, v47
  buffer_store_dwordx4 v[48:51], v35, s[16:19], s35 offen offset:3072 sc1
  v_accvgpr_read_b32 v52, a120
  v_accvgpr_read_b32 v53, a121
  v_accvgpr_read_b32 v54, a122
  v_accvgpr_read_b32 v55, a123
  v_accvgpr_read_b32 v56, a124
  v_accvgpr_read_b32 v57, a125
  v_accvgpr_read_b32 v58, a126
  v_accvgpr_read_b32 v59, a127
  v_cvt_pk_bf16_f32 v60, v52, v53
  v_cvt_pk_bf16_f32 v61, v54, v55
  v_cvt_pk_bf16_f32 v62, v56, v57
  v_cvt_pk_bf16_f32 v63, v58, v59
  s_add_u32 s35, s31, 16384
  buffer_store_dwordx4 v[60:63], v35, s[16:19], s35 offen sc1
  v_accvgpr_read_b32 v64, a136
  v_accvgpr_read_b32 v65, a137
  v_accvgpr_read_b32 v66, a138
  v_accvgpr_read_b32 v67, a139
  v_accvgpr_read_b32 v68, a140
  v_accvgpr_read_b32 v69, a141
  v_accvgpr_read_b32 v70, a142
  v_accvgpr_read_b32 v71, a143
  v_cvt_pk_bf16_f32 v72, v64, v65
  v_cvt_pk_bf16_f32 v73, v66, v67
  v_cvt_pk_bf16_f32 v74, v68, v69
  v_cvt_pk_bf16_f32 v75, v70, v71
  buffer_store_dwordx4 v[72:75], v35, s[16:19], s35 offen offset:1024 sc1
  s_branch K_NOCONV
K_CONV:
  s_and_b32 s43, s40, 0xfffe
  s_lshl_b32 s43, s43, 1
  s_load_dword s44, s[38:39], s43
  s_barrier
  s_mul_i32 s45, s24, 25856
  s_waitcnt vmcnt(0)
  v_readlane_b32 s46, v112, 2
  v_readlane_b32 s47, v113, 2
  s_mov_b64 exec, 3
  v_mov_b32 v112, 0
  v_mov_b32 v113, 0
  v_mov_b32 v114, 0
  v_mov_b32 v115, 0
  v_mov_b32 v132, 0
  v_mov_b32 v133, 0
  v_mov_b32 v134, 0
  v_mov_b32 v135, 0
  v_mov_b32 v152, 0
  v_mov_b32 v153, 0
  v_mov_b32 v154, 0
  v_mov_b32 v155, 0
  s_mov_b64 exec, -1
  v_writelane_b32 v135, s46, 1
  v_writelane_b32 v154, s46, 1
  v_writelane_b32 v155, s47, 1
  v_add_u32 v38, s45, v35
  ds_write_b128 v38, v[112:115] offset:0
  v_alignbit_b32 v40, v132, v112, 16
  v_alignbit_b32 v41, v133, v113, 16
  v_alignbit_b32 v42, v134, v114, 16
  v_alignbit_b32 v43, v135, v115, 16
  ds_write_b128 v38, v[132:135] offset:10368
  v_alignbit_b32 v44, v152, v132, 16
  v_alignbit_b32 v45, v153, v133, 16
  v_alignbit_b32 v46, v154, v134, 16
  v_alignbit_b32 v47, v155, v135, 16
  ds_write_b128 v38, v[40:43] offset:5184
  ds_write_b128 v38, v[44:47] offset:15552
  ds_write_b128 v38, v[116:119] offset:1024
  v_alignbit_b32 v48, v136, v116, 16
  v_alignbit_b32 v49, v137, v117, 16
  v_alignbit_b32 v50, v138, v118, 16
  v_alignbit_b32 v51, v139, v119, 16
  ds_write_b128 v38, v[136:139] offset:11392
  v_alignbit_b32 v52, v156, v136, 16
  v_alignbit_b32 v53, v157, v137, 16
  v_alignbit_b32 v54, v158, v138, 16
  v_alignbit_b32 v55, v159, v139, 16
  ds_write_b128 v38, v[48:51] offset:6208
  ds_write_b128 v38, v[52:55] offset:16576
  ds_write_b128 v38, v[120:123] offset:2048
  v_alignbit_b32 v40, v140, v120, 16
  v_alignbit_b32 v41, v141, v121, 16
  v_alignbit_b32 v42, v142, v122, 16
  v_alignbit_b32 v43, v143, v123, 16
  ds_write_b128 v38, v[140:143] offset:12416
  v_alignbit_b32 v44, v160, v140, 16
  v_alignbit_b32 v45, v161, v141, 16
  v_alignbit_b32 v46, v162, v142, 16
  v_alignbit_b32 v47, v163, v143, 16
  ds_write_b128 v38, v[40:43] offset:7232
  ds_write_b128 v38, v[44:47] offset:17600
  ds_write_b128 v38, v[124:127] offset:3072
  v_alignbit_b32 v48, v144, v124, 16
  v_alignbit_b32 v49, v145, v125, 16
  v_alignbit_b32 v50, v146, v126, 16
  v_alignbit_b32 v51, v147, v127, 16
  ds_write_b128 v38, v[144:147] offset:13440
  v_alignbit_b32 v52, v164, v144, 16
  v_alignbit_b32 v53, v165, v145, 16
  v_alignbit_b32 v54, v166, v146, 16
  v_alignbit_b32 v55, v167, v147, 16
  ds_write_b128 v38, v[48:51] offset:8256
  ds_write_b128 v38, v[52:55] offset:18624
  ds_write_b128 v38, v[128:131] offset:4096
  v_alignbit_b32 v40, v148, v128, 16
  v_alignbit_b32 v41, v149, v129, 16
  v_alignbit_b32 v42, v150, v130, 16
  v_alignbit_b32 v43, v151, v131, 16
  ds_write_b128 v38, v[148:151] offset:14464
  v_alignbit_b32 v44, v168, v148, 16
  v_alignbit_b32 v45, v169, v149, 16
  v_alignbit_b32 v46, v170, v150, 16
  v_alignbit_b32 v47, v171, v151, 16
  ds_write_b128 v38, v[40:43] offset:9280
  ds_write_b128 v38, v[44:47] offset:19648
  v_mov_b32 v60, 0
  v_mov_b32 v61, 0
  v_mov_b32 v62, 0
  v_mov_b32 v63, 0
  ds_write_b128 v38, v[60:63] offset:24832
  v_add_u32 v39, 1, v37
  v_and_b32 v76, 3, v39
  v_mul_u32_u24 v76, 5184, v76
  v_and_b32 v57, 0x1c, v39
  v_lshl_add_u32 v76, v57, 1, v76
  v_lshl_add_u32 v76, v36, 4, v76
  v_add_u32 v76, s45, v76
  v_lshlrev_b32 v77, 5, v37
  v_lshlrev_b32 v58, 4, v36
  v_sub_u32 v77, v58, v77
  s_add_u32 s46, s45, 21216
  v_add_u32 v77, s46, v77
  ds_write_b128 v38, v[172:175] offset:20736
  ds_write_b128 v38, v[176:179] offset:21760
  ds_write_b128 v38, v[180:183] offset:22784
  ds_write_b128 v38, v[184:187] offset:23808
  s_waitcnt lgkmcnt(0)
  ds_read_b64 a[144:145], v76 offset:0
  ds_read_b64 a[146:147], v76 offset:8
  ds_read_b128 v[188:191], v77 offset:3584
  ds_read_b64 a[148:149], v76 offset:512
  ds_read_b64 a[150:151], v76 offset:520
  ds_read_b128 v[192:195], v77 offset:3072
  ds_read_b64 a[152:153], v76 offset:1024
  ds_read_b64 a[154:155], v76 offset:1032
  ds_read_b128 v[196:199], v77 offset:2560
  ds_read_b64 a[156:157], v76 offset:1536
  ds_read_b64 a[158:159], v76 offset:1544
  ds_read_b128 v[200:203], v77 offset:2048
  ds_read_b64 a[160:161], v76 offset:2048
  ds_read_b64 a[162:163], v76 offset:2056
  ds_read_b128 v[204:207], v77 offset:1536
  ds_read_b64 a[164:165], v76 offset:2560
  ds_read_b64 a[166:167], v76 offset:2568
  ds_read_b128 v[208:211], v77 offset:1024
  ds_read_b64 a[168:169], v76 offset:3072
  ds_read_b64 a[170:171], v76 offset:3080
  ds_read_b128 v[212:215], v77 offset:512
  ds_read_b64 a[172:173], v76 offset:3584
  ds_read_b64 a[174:175], v76 offset:3592
  ds_read_b128 v[216:219], v77 offset:0
  s_waitcnt lgkmcnt(0)
  v_mfma_f32_16x16x32_bf16 v[80:83], a[144:147], v[188:191], 0
  ds_read_b64 a[176:177], v76 offset:64
  v_accvgpr_read_b32 v40, a0
  v_mfma_f32_16x16x32_bf16 v[84:87], a[144:147], v[192:195], 0
  ds_read_b64 a[178:179], v76 offset:72
  v_mfma_f32_16x16x32_bf16 v[88:91], a[144:147], v[196:199], 0
  ds_read_b128 v[220:223], v77 offset:3648
  v_accvgpr_read_b32 v41, a1
  v_mfma_f32_16x16x32_bf16 v[92:95], a[144:147], v[200:203], 0
  ds_read_b64 a[180:181], v76 offset:576
  v_accvgpr_read_b32 v42, a2
  v_mfma_f32_16x16x32_bf16 v[96:99], a[144:147], v[204:207], 0
  ds_read_b64 a[182:183], v76 offset:584
  v_mfma_f32_16x16x32_bf16 v[100:103], a[144:147], v[208:211], 0
  ds_read_b128 v[224:227], v77 offset:3136
  v_accvgpr_read_b32 v43, a3
  v_mfma_f32_16x16x32_bf16 v[104:107], a[144:147], v[212:215], 0
  ds_read_b64 a[184:185], v76 offset:1088
  v_accvgpr_read_b32 v44, a4
  v_mfma_f32_16x16x32_bf16 v[108:111], a[144:147], v[216:219], 0
  ds_read_b64 a[186:187], v76 offset:1096
  v_mfma_f32_16x16x32_bf16 v[84:87], a[148:151], v[188:191], v[84:87]
  ds_read_b128 v[228:231], v77 offset:2624
  v_accvgpr_read_b32 v45, a5
  v_mfma_f32_16x16x32_bf16 v[88:91], a[148:151], v[192:195], v[88:91]
  ds_read_b64 a[188:189], v76 offset:1600
  v_accvgpr_read_b32 v46, a6
  v_mfma_f32_16x16x32_bf16 v[92:95], a[148:151], v[196:199], v[92:95]
  ds_read_b64 a[190:191], v76 offset:1608
  v_mfma_f32_16x16x32_bf16 v[96:99], a[148:151], v[200:203], v[96:99]
  ds_read_b128 v[232:235], v77 offset:2112
  v_accvgpr_read_b32 v47, a7
  v_mfma_f32_16x16x32_bf16 v[100:103], a[148:151], v[204:207], v[100:103]
  ds_read_b64 a[192:193], v76 offset:2112
  v_cvt_pk_bf16_f32 v48, v40, v41
  v_mfma_f32_16x16x32_bf16 v[104:107], a[148:151], v[208:211], v[104:107]
  ds_read_b64 a[194:195], v76 offset:2120
  v_mfma_f32_16x16x32_bf16 v[108:111], a[148:151], v[212:215], v[108:111]
  ds_read_b128 v[236:239], v77 offset:1600
  v_cvt_pk_bf16_f32 v49, v42, v43
  v_mfma_f32_16x16x32_bf16 v[88:91], a[152:155], v[188:191], v[88:91]
  ds_read_b64 a[196:197], v76 offset:2624
  v_cvt_pk_bf16_f32 v50, v44, v45
  v_mfma_f32_16x16x32_bf16 v[92:95], a[152:155], v[192:195], v[92:95]
  ds_read_b64 a[198:199], v76 offset:2632
  v_mfma_f32_16x16x32_bf16 v[96:99], a[152:155], v[196:199], v[96:99]
  ds_read_b128 v[240:243], v77 offset:1088
  v_cvt_pk_bf16_f32 v51, v46, v47
  v_mfma_f32_16x16x32_bf16 v[100:103], a[152:155], v[200:203], v[100:103]
  ds_read_b64 a[200:201], v76 offset:3136
  s_add_u32 s35, s31, 0
  v_mfma_f32_16x16x32_bf16 v[104:107], a[152:155], v[204:207], v[104:107]
  ds_read_b64 a[202:203], v76 offset:3144
  v_mfma_f32_16x16x32_bf16 v[108:111], a[152:155], v[208:211], v[108:111]
  ds_read_b128 v[244:247], v77 offset:576
  v_mfma_f32_16x16x32_bf16 v[92:95], a[156:159], v[188:191], v[92:95]
  ds_read_b64 a[204:205], v76 offset:3648
  v_mfma_f32_16x16x32_bf16 v[96:99], a[156:159], v[192:195], v[96:99]
  ds_read_b64 a[206:207], v76 offset:3656
  buffer_store_dwordx4 v[48:51], v35, s[16:19], s35 offen sc1
  v_mfma_f32_16x16x32_bf16 v[100:103], a[156:159], v[196:199], v[100:103]
  ds_read_b128 v[248:251], v77 offset:64
  v_mfma_f32_16x16x32_bf16 v[104:107], a[156:159], v[200:203], v[104:107]
  v_accvgpr_read_b32 v52, a16
  v_accvgpr_read_b32 v53, a17
  v_mfma_f32_16x16x32_bf16 v[108:111], a[156:159], v[204:207], v[108:111]
  v_accvgpr_read_b32 v54, a18
  v_accvgpr_read_b32 v55, a19
  v_accvgpr_read_b32 v56, a20
  v_mfma_f32_16x16x32_bf16 v[96:99], a[160:163], v[188:191], v[96:99]
  v_accvgpr_read_b32 v57, a21
  v_accvgpr_read_b32 v58, a22
  v_mfma_f32_16x16x32_bf16 v[100:103], a[160:163], v[192:195], v[100:103]
  v_accvgpr_read_b32 v59, a23
  v_cvt_pk_bf16_f32 v60, v52, v53
  v_cvt_pk_bf16_f32 v61, v54, v55
  v_mfma_f32_16x16x32_bf16 v[104:107], a[160:163], v[196:199], v[104:107]
  v_cvt_pk_bf16_f32 v62, v56, v57
  v_cvt_pk_bf16_f32 v63, v58, v59
  v_mfma_f32_16x16x32_bf16 v[108:111], a[160:163], v[200:203], v[108:111]
  buffer_store_dwordx4 v[60:63], v35, s[16:19], s35 offen offset:1024 sc1
  v_mfma_f32_16x16x32_bf16 v[100:103], a[164:167], v[188:191], v[100:103]
  v_accvgpr_read_b32 v64, a32
  v_accvgpr_read_b32 v65, a33
  v_mfma_f32_16x16x32_bf16 v[104:107], a[164:167], v[192:195], v[104:107]
  v_accvgpr_read_b32 v66, a34
  v_accvgpr_read_b32 v67, a35
  v_accvgpr_read_b32 v68, a36
  v_mfma_f32_16x16x32_bf16 v[108:111], a[164:167], v[196:199], v[108:111]
  v_accvgpr_read_b32 v69, a37
  v_accvgpr_read_b32 v70, a38
  v_accvgpr_read_b32 v71, a39
  v_mfma_f32_16x16x32_bf16 v[104:107], a[168:171], v[188:191], v[104:107]
  v_cvt_pk_bf16_f32 v72, v64, v65
  v_cvt_pk_bf16_f32 v73, v66, v67
  v_mfma_f32_16x16x32_bf16 v[108:111], a[168:171], v[192:195], v[108:111]
  v_cvt_pk_bf16_f32 v74, v68, v69
  v_cvt_pk_bf16_f32 v75, v70, v71
  v_mfma_f32_16x16x32_bf16 v[108:111], a[172:175], v[188:191], v[108:111]
  buffer_store_dwordx4 v[72:75], v35, s[16:19], s35 offen offset:2048 sc1
  s_waitcnt lgkmcnt(0)
  v_mfma_f32_16x16x32_bf16 v[80:83], a[176:179], v[220:223], v[80:83]
  ds_read_b64 a[144:145], v76 offset:128
  v_accvgpr_read_b32 v40, a48
  v_mfma_f32_16x16x32_bf16 v[84:87], a[176:179], v[224:227], v[84:87]
  ds_read_b64 a[146:147], v76 offset:136
  v_mfma_f32_16x16x32_bf16 v[88:91], a[176:179], v[228:231], v[88:91]
  ds_read_b128 v[188:191], v77 offset:3712
  v_accvgpr_read_b32 v41, a49
  v_mfma_f32_16x16x32_bf16 v[92:95], a[176:179], v[232:235], v[92:95]
  ds_read_b64 a[148:149], v76 offset:640
  v_accvgpr_read_b32 v42, a50
  v_mfma_f32_16x16x32_bf16 v[96:99], a[176:179], v[236:239], v[96:99]
  ds_read_b64 a[150:151], v76 offset:648
  v_mfma_f32_16x16x32_bf16 v[100:103], a[176:179], v[240:243], v[100:103]
  ds_read_b128 v[192:195], v77 offset:3200
  v_accvgpr_read_b32 v43, a51
  v_mfma_f32_16x16x32_bf16 v[104:107], a[176:179], v[244:247], v[104:107]
  ds_read_b64 a[152:153], v76 offset:1152
  v_accvgpr_read_b32 v44, a52
  v_mfma_f32_16x16x32_bf16 v[108:111], a[176:179], v[248:251], v[108:111]
  ds_read_b64 a[154:155], v76 offset:1160
  v_mfma_f32_16x16x32_bf16 v[84:87], a[180:183], v[220:223], v[84:87]
  ds_read_b128 v[196:199], v77 offset:2688
  v_accvgpr_read_b32 v45, a53
  v_mfma_f32_16x16x32_bf16 v[88:91], a[180:183], v[224:227], v[88:91]
  ds_read_b64 a[156:157], v76 offset:1664
  v_accvgpr_read_b32 v46, a54
  v_mfma_f32_16x16x32_bf16 v[92:95], a[180:183], v[228:231], v[92:95]
  ds_read_b64 a[158:159], v76 offset:1672
  v_mfma_f32_16x16x32_bf16 v[96:99], a[180:183], v[232:235], v[96:99]
  ds_read_b128 v[200:203], v77 offset:2176
  v_accvgpr_read_b32 v47, a55
  v_mfma_f32_16x16x32_bf16 v[100:103], a[180:183], v[236:239], v[100:103]
  ds_read_b64 a[160:161], v76 offset:2176
  v_cvt_pk_bf16_f32 v48, v40, v41
  v_mfma_f32_16x16x32_bf16 v[104:107], a[180:183], v[240:243], v[104:107]
  ds_read_b64 a[162:163], v76 offset:2184
  v_mfma_f32_16x16x32_bf16 v[108:111], a[180:183], v[244:247], v[108:111]
  ds_read_b128 v[204:207], v77 offset:1664
  v_cvt_pk_bf16_f32 v49, v42, v43
  v_mfma_f32_16x16x32_bf16 v[88:91], a[184:187], v[220:223], v[88:91]
  ds_read_b64 a[164:165], v76 offset:2688
  v_cvt_pk_bf16_f32 v50, v44, v45
  v_mfma_f32_16x16x32_bf16 v[92:95], a[184:187], v[224:227], v[92:95]
  ds_read_b64 a[166:167], v76 offset:2696
  v_mfma_f32_16x16x32_bf16 v[96:99], a[184:187], v[228:231], v[96:99]
  ds_read_b128 v[208:211], v77 offset:1152
  v_cvt_pk_bf16_f32 v51, v46, v47
  v_mfma_f32_16x16x32_bf16 v[100:103], a[184:187], v[232:235], v[100:103]
  ds_read_b64 a[168:169], v76 offset:3200
  v_mfma_f32_16x16x32_bf16 v[104:107], a[184:187], v[236:239], v[104:107]
  ds_read_b64 a[170:171], v76 offset:3208
  v_mfma_f32_16x16x32_bf16 v[108:111], a[184:187], v[240:243], v[108:111]
  ds_read_b128 v[212:215], v77 offset:640
  buffer_store_dwordx4 v[48:51], v35, s[16:19], s35 offen offset:3072 sc1
  v_mfma_f32_16x16x32_bf16 v[92:95], a[188:191], v[220:223], v[92:95]
  ds_read_b64 a[172:173], v76 offset:3712
  v_mfma_f32_16x16x32_bf16 v[96:99], a[188:191], v[224:227], v[96:99]
  ds_read_b64 a[174:175], v76 offset:3720
  v_mfma_f32_16x16x32_bf16 v[100:103], a[188:191], v[228:231], v[100:103]
  ds_read_b128 v[216:219], v77 offset:128
  v_mfma_f32_16x16x32_bf16 v[104:107], a[188:191], v[232:235], v[104:107]
  v_accvgpr_read_b32 v52, a64
  v_accvgpr_read_b32 v53, a65
  v_accvgpr_read_b32 v54, a66
  v_mfma_f32_16x16x32_bf16 v[108:111], a[188:191], v[236:239], v[108:111]
  v_accvgpr_read_b32 v55, a67
  v_accvgpr_read_b32 v56, a68
  v_accvgpr_read_b32 v57, a69
  v_mfma_f32_16x16x32_bf16 v[96:99], a[192:195], v[220:223], v[96:99]
  v_accvgpr_read_b32 v58, a70
  v_accvgpr_read_b32 v59, a71
  v_mfma_f32_16x16x32_bf16 v[100:103], a[192:195], v[224:227], v[100:103]
  v_cvt_pk_bf16_f32 v60, v52, v53
  v_cvt_pk_bf16_f32 v61, v54, v55
  v_cvt_pk_bf16_f32 v62, v56, v57
  v_mfma_f32_16x16x32_bf16 v[104:107], a[192:195], v[228:231], v[104:107]
  v_cvt_pk_bf16_f32 v63, v58, v59
  v_mfma_f32_16x16x32_bf16 v[108:111], a[192:195], v[232:235], v[108:111]
  s_add_u32 s35, s31, 4096
  buffer_store_dwordx4 v[60:63], v35, s[16:19], s35 offen sc1
  v_mfma_f32_16x16x32_bf16 v[100:103], a[196:199], v[220:223], v[100:103]
  v_accvgpr_read_b32 v64, a80
  v_accvgpr_read_b32 v65, a81
  v_mfma_f32_16x16x32_bf16 v[104:107], a[196:199], v[224:227], v[104:107]
  v_accvgpr_read_b32 v66, a82
  v_accvgpr_read_b32 v67, a83
  v_accvgpr_read_b32 v68, a84
  v_mfma_f32_16x16x32_bf16 v[108:111], a[196:199], v[228:231], v[108:111]
  v_accvgpr_read_b32 v69, a85
  v_accvgpr_read_b32 v70, a86
  v_accvgpr_read_b32 v71, a87
  v_mfma_f32_16x16x32_bf16 v[104:107], a[200:203], v[220:223], v[104:107]
  v_cvt_pk_bf16_f32 v72, v64, v65
  v_cvt_pk_bf16_f32 v73, v66, v67
  v_mfma_f32_16x16x32_bf16 v[108:111], a[200:203], v[224:227], v[108:111]
  v_cvt_pk_bf16_f32 v74, v68, v69
  v_cvt_pk_bf16_f32 v75, v70, v71
  v_mfma_f32_16x16x32_bf16 v[108:111], a[204:207], v[220:223], v[108:111]
  buffer_store_dwordx4 v[72:75], v35, s[16:19], s35 offen offset:1024 sc1
  s_waitcnt lgkmcnt(0)
  v_mfma_f32_16x16x32_bf16 v[80:83], a[144:147], v[188:191], v[80:83]
  ds_read_b64 a[176:177], v76 offset:192
  v_accvgpr_read_b32 v40, a96
  v_mfma_f32_16x16x32_bf16 v[84:87], a[144:147], v[192:195], v[84:87]
  ds_read_b64 a[178:179], v76 offset:200
  v_mfma_f32_16x16x32_bf16 v[88:91], a[144:147], v[196:199], v[88:91]
  ds_read_b128 v[220:223], v77 offset:3776
  v_accvgpr_read_b32 v41, a97
  v_mfma_f32_16x16x32_bf16 v[92:95], a[144:147], v[200:203], v[92:95]
  ds_read_b64 a[180:181], v76 offset:704
  v_accvgpr_read_b32 v42, a98
  v_mfma_f32_16x16x32_bf16 v[96:99], a[144:147], v[204:207], v[96:99]
  ds_read_b64 a[182:183], v76 offset:712
  v_mfma_f32_16x16x32_bf16 v[100:103], a[144:147], v[208:211], v[100:103]
  ds_read_b128 v[224:227], v77 offset:3264
  v_accvgpr_read_b32 v43, a99
  v_mfma_f32_16x16x32_bf16 v[104:107], a[144:147], v[212:215], v[104:107]
  ds_read_b64 a[184:185], v76 offset:1216
  v_accvgpr_read_b32 v44, a100
  v_mfma_f32_16x16x32_bf16 v[108:111], a[144:147], v[216:219], v[108:111]
  ds_read_b64 a[186:187], v76 offset:1224
  v_mfma_f32_16x16x32_bf16 v[84:87], a[148:151], v[188:191], v[84:87]
  ds_read_b128 v[228:231], v77 offset:2752
  v_accvgpr_read_b32 v45, a101
  v_mfma_f32_16x16x32_bf16 v[88:91], a[148:151], v[192:195], v[88:91]
  ds_read_b64 a[188:189], v76 offset:1728
  v_accvgpr_read_b32 v46, a102
  v_mfma_f32_16x16x32_bf16 v[92:95], a[148:151], v[196:199], v[92:95]
  ds_read_b64 a[190:191], v76 offset:1736
  v_mfma_f32_16x16x32_bf16 v[96:99], a[148:151], v[200:203], v[96:99]
  ds_read_b128 v[232:235], v77 offset:2240
  v_accvgpr_read_b32 v47, a103
  v_mfma_f32_16x16x32_bf16 v[100:103], a[148:151], v[204:207], v[100:103]
  ds_read_b64 a[192:193], v76 offset:2240
  v_cvt_pk_bf16_f32 v48, v40, v41
  v_mfma_f32_16x16x32_bf16 v[104:107], a[148:151], v[208:211], v[104:107]
  ds_read_b64 a[194:195], v76 offset:2248
  v_mfma_f32_16x16x32_bf16 v[108:111], a[148:151], v[212:215], v[108:111]
  ds_read_b128 v[236:239], v77 offset:1728
  v_cvt_pk_bf16_f32 v49, v42, v43
  v_mfma_f32_16x16x32_bf16 v[88:91], a[152:155], v[188:191], v[88:91]
  ds_read_b64 a[196:197], v76 offset:2752
  v_cvt_pk_bf16_f32 v50, v44, v45
  v_mfma_f32_16x16x32_bf16 v[92:95], a[152:155], v[192:195], v[92:95]
  ds_read_b64 a[198:199], v76 offset:2760
  v_mfma_f32_16x16x32_bf16 v[96:99], a[152:155], v[196:199], v[96:99]
  ds_read_b128 v[240:243], v77 offset:1216
  v_cvt_pk_bf16_f32 v51, v46, v47
  v_mfma_f32_16x16x32_bf16 v[100:103], a[152:155], v[200:203], v[100:103]
  ds_read_b64 a[200:201], v76 offset:3264
  v_mfma_f32_16x16x32_bf16 v[104:107], a[152:155], v[204:207], v[104:107]
  ds_read_b64 a[202:203], v76 offset:3272
  v_mfma_f32_16x16x32_bf16 v[108:111], a[152:155], v[208:211], v[108:111]
  ds_read_b128 v[244:247], v77 offset:704
  buffer_store_dwordx4 v[48:51], v35, s[16:19], s35 offen offset:2048 sc1
  v_mfma_f32_16x16x32_bf16 v[92:95], a[156:159], v[188:191], v[92:95]
  ds_read_b64 a[204:205], v76 offset:3776
  v_mfma_f32_16x16x32_bf16 v[96:99], a[156:159], v[192:195], v[96:99]
  ds_read_b64 a[206:207], v76 offset:3784
  v_mfma_f32_16x16x32_bf16 v[100:103], a[156:159], v[196:199], v[100:103]
  ds_read_b128 v[248:251], v77 offset:192
  v_mfma_f32_16x16x32_bf16 v[104:107], a[156:159], v[200:203], v[104:107]
  v_accvgpr_read_b32 v52, a112
  v_accvgpr_read_b32 v53, a113
  v_accvgpr_read_b32 v54, a114
  v_mfma_f32_16x16x32_bf16 v[108:111], a[156:159], v[204:207], v[108:111]
  v_accvgpr_read_b32 v55, a115
  v_accvgpr_read_b32 v56, a116
  v_accvgpr_read_b32 v57, a117
  v_mfma_f32_16x16x32_bf16 v[96:99], a[160:163], v[188:191], v[96:99]
  v_accvgpr_read_b32 v58, a118
  v_accvgpr_read_b32 v59, a119
  v_mfma_f32_16x16x32_bf16 v[100:103], a[160:163], v[192:195], v[100:103]
  v_cvt_pk_bf16_f32 v60, v52, v53
  v_cvt_pk_bf16_f32 v61, v54, v55
  v_cvt_pk_bf16_f32 v62, v56, v57
  v_mfma_f32_16x16x32_bf16 v[104:107], a[160:163], v[196:199], v[104:107]
  v_cvt_pk_bf16_f32 v63, v58, v59
  v_mfma_f32_16x16x32_bf16 v[108:111], a[160:163], v[200:203], v[108:111]
  buffer_store_dwordx4 v[60:63], v35, s[16:19], s35 offen offset:3072 sc1
  v_accvgpr_read_b32 v64, a128
  v_mfma_f32_16x16x32_bf16 v[100:103], a[164:167], v[188:191], v[100:103]
  v_accvgpr_read_b32 v65, a129
  v_accvgpr_read_b32 v66, a130
  v_mfma_f32_16x16x32_bf16 v[104:107], a[164:167], v[192:195], v[104:107]
  v_accvgpr_read_b32 v67, a131
  v_accvgpr_read_b32 v68, a132
  v_accvgpr_read_b32 v69, a133
  v_mfma_f32_16x16x32_bf16 v[108:111], a[164:167], v[196:199], v[108:111]
  v_accvgpr_read_b32 v70, a134
  v_accvgpr_read_b32 v71, a135
  v_cvt_pk_bf16_f32 v72, v64, v65
  v_mfma_f32_16x16x32_bf16 v[104:107], a[168:171], v[188:191], v[104:107]
  v_cvt_pk_bf16_f32 v73, v66, v67
  v_cvt_pk_bf16_f32 v74, v68, v69
  v_mfma_f32_16x16x32_bf16 v[108:111], a[168:171], v[192:195], v[108:111]
  v_cvt_pk_bf16_f32 v75, v70, v71
  v_mfma_f32_16x16x32_bf16 v[108:111], a[172:175], v[188:191], v[108:111]
  s_add_u32 s35, s31, 8192
  buffer_store_dwordx4 v[72:75], v35, s[16:19], s35 offen sc1
  s_waitcnt lgkmcnt(0)
  v_mfma_f32_16x16x32_bf16 v[80:83], a[176:179], v[220:223], v[80:83]
  ds_read_b64 a[144:145], v76 offset:256
  v_accvgpr_read_b32 v40, a8
  v_mfma_f32_16x16x32_bf16 v[84:87], a[176:179], v[224:227], v[84:87]
  ds_read_b64 a[146:147], v76 offset:264
  v_mfma_f32_16x16x32_bf16 v[88:91], a[176:179], v[228:231], v[88:91]
  ds_read_b128 v[188:191], v77 offset:3840
  v_accvgpr_read_b32 v41, a9
  v_mfma_f32_16x16x32_bf16 v[92:95], a[176:179], v[232:235], v[92:95]
  ds_read_b64 a[148:149], v76 offset:768
  v_accvgpr_read_b32 v42, a10
  v_mfma_f32_16x16x32_bf16 v[96:99], a[176:179], v[236:239], v[96:99]
  ds_read_b64 a[150:151], v76 offset:776
  v_mfma_f32_16x16x32_bf16 v[100:103], a[176:179], v[240:243], v[100:103]
  ds_read_b128 v[192:195], v77 offset:3328
  v_accvgpr_read_b32 v43, a11
  v_mfma_f32_16x16x32_bf16 v[104:107], a[176:179], v[244:247], v[104:107]
  ds_read_b64 a[152:153], v76 offset:1280
  v_accvgpr_read_b32 v44, a12
  v_mfma_f32_16x16x32_bf16 v[108:111], a[176:179], v[248:251], v[108:111]
  ds_read_b64 a[154:155], v76 offset:1288
  v_mfma_f32_16x16x32_bf16 v[84:87], a[180:183], v[220:223], v[84:87]
  ds_read_b128 v[196:199], v77 offset:2816
  v_accvgpr_read_b32 v45, a13
  v_mfma_f32_16x16x32_bf16 v[88:91], a[180:183], v[224:227], v[88:91]
  ds_read_b64 a[156:157], v76 offset:1792
  v_accvgpr_read_b32 v46, a14
  v_mfma_f32_16x16x32_bf16 v[92:95], a[180:183], v[228:231], v[92:95]
  ds_read_b64 a[158:159], v76 offset:1800
  v_mfma_f32_16x16x32_bf16 v[96:99], a[180:183], v[232:235], v[96:99]
  ds_read_b128 v[200:203], v77 offset:2304
  v_accvgpr_read_b32 v47, a15
  v_mfma_f32_16x16x32_bf16 v[100:103], a[180:183], v[236:239], v[100:103]
  ds_read_b64 a[160:161], v76 offset:2304
  v_cvt_pk_bf16_f32 v48, v40, v41
  v_mfma_f32_16x16x32_bf16 v[104:107], a[180:183], v[240:243], v[104:107]
  ds_read_b64 a[162:163], v76 offset:2312
  v_mfma_f32_16x16x32_bf16 v[108:111], a[180:183], v[244:247], v[108:111]
  ds_read_b128 v[204:207], v77 offset:1792
  v_cvt_pk_bf16_f32 v49, v42, v43
  v_mfma_f32_16x16x32_bf16 v[88:91], a[184:187], v[220:223], v[88:91]
  ds_read_b64 a[164:165], v76 offset:2816
  v_cvt_pk_bf16_f32 v50, v44, v45
  v_mfma_f32_16x16x32_bf16 v[92:95], a[184:187], v[224:227], v[92:95]
  ds_read_b64 a[166:167], v76 offset:2824
  v_mfma_f32_16x16x32_bf16 v[96:99], a[184:187], v[228:231], v[96:99]
  ds_read_b128 v[208:211], v77 offset:1280
  v_cvt_pk_bf16_f32 v51, v46, v47
  v_mfma_f32_16x16x32_bf16 v[100:103], a[184:187], v[232:235], v[100:103]
  ds_read_b64 a[168:169], v76 offset:3328
  v_mfma_f32_16x16x32_bf16 v[104:107], a[184:187], v[236:239], v[104:107]
  ds_read_b64 a[170:171], v76 offset:3336
  v_mfma_f32_16x16x32_bf16 v[108:111], a[184:187], v[240:243], v[108:111]
  ds_read_b128 v[212:215], v77 offset:768
  buffer_store_dwordx4 v[48:51], v35, s[16:19], s35 offen offset:1024 sc1
  v_mfma_f32_16x16x32_bf16 v[92:95], a[188:191], v[220:223], v[92:95]
  ds_read_b64 a[172:173], v76 offset:3840
  v_mfma_f32_16x16x32_bf16 v[96:99], a[188:191], v[224:227], v[96:99]
  ds_read_b64 a[174:175], v76 offset:3848
  v_mfma_f32_16x16x32_bf16 v[100:103], a[188:191], v[228:231], v[100:103]
  ds_read_b128 v[216:219], v77 offset:256
  v_mfma_f32_16x16x32_bf16 v[104:107], a[188:191], v[232:235], v[104:107]
  v_accvgpr_read_b32 v52, a24
  v_accvgpr_read_b32 v53, a25
  v_accvgpr_read_b32 v54, a26
  v_mfma_f32_16x16x32_bf16 v[108:111], a[188:191], v[236:239], v[108:111]
  v_accvgpr_read_b32 v55, a27
  v_accvgpr_read_b32 v56, a28
  v_accvgpr_read_b32 v57, a29
  v_mfma_f32_16x16x32_bf16 v[96:99], a[192:195], v[220:223], v[96:99]
  v_accvgpr_read_b32 v58, a30
  v_accvgpr_read_b32 v59, a31
  v_mfma_f32_16x16x32_bf16 v[100:103], a[192:195], v[224:227], v[100:103]
  v_cvt_pk_bf16_f32 v60, v52, v53
  v_cvt_pk_bf16_f32 v61, v54, v55
  v_cvt_pk_bf16_f32 v62, v56, v57
  v_mfma_f32_16x16x32_bf16 v[104:107], a[192:195], v[228:231], v[104:107]
  v_cvt_pk_bf16_f32 v63, v58, v59
  v_mfma_f32_16x16x32_bf16 v[108:111], a[192:195], v[232:235], v[108:111]
  buffer_store_dwordx4 v[60:63], v35, s[16:19], s35 offen offset:2048 sc1
  v_accvgpr_read_b32 v64, a40
  v_mfma_f32_16x16x32_bf16 v[100:103], a[196:199], v[220:223], v[100:103]
  v_accvgpr_read_b32 v65, a41
  v_accvgpr_read_b32 v66, a42
  v_mfma_f32_16x16x32_bf16 v[104:107], a[196:199], v[224:227], v[104:107]
  v_accvgpr_read_b32 v67, a43
  v_accvgpr_read_b32 v68, a44
  v_accvgpr_read_b32 v69, a45
  v_mfma_f32_16x16x32_bf16 v[108:111], a[196:199], v[228:231], v[108:111]
  v_accvgpr_read_b32 v70, a46
  v_accvgpr_read_b32 v71, a47
  v_cvt_pk_bf16_f32 v72, v64, v65
  v_mfma_f32_16x16x32_bf16 v[104:107], a[200:203], v[220:223], v[104:107]
  v_cvt_pk_bf16_f32 v73, v66, v67
  v_cvt_pk_bf16_f32 v74, v68, v69
  v_mfma_f32_16x16x32_bf16 v[108:111], a[200:203], v[224:227], v[108:111]
  v_cvt_pk_bf16_f32 v75, v70, v71
  v_accvgpr_read_b32 v40, a56
  v_mfma_f32_16x16x32_bf16 v[108:111], a[204:207], v[220:223], v[108:111]
  buffer_store_dwordx4 v[72:75], v35, s[16:19], s35 offen offset:3072 sc1
  s_waitcnt lgkmcnt(0)
  v_mfma_f32_16x16x32_bf16 v[80:83], a[144:147], v[188:191], v[80:83]
  ds_read_b64 a[176:177], v76 offset:320
  v_accvgpr_read_b32 v41, a57
  v_mfma_f32_16x16x32_bf16 v[84:87], a[144:147], v[192:195], v[84:87]
  ds_read_b64 a[178:179], v76 offset:328
  v_mfma_f32_16x16x32_bf16 v[88:91], a[144:147], v[196:199], v[88:91]
  ds_read_b128 v[220:223], v77 offset:3904
  v_accvgpr_read_b32 v42, a58
  v_mfma_f32_16x16x32_bf16 v[92:95], a[144:147], v[200:203], v[92:95]
  ds_read_b64 a[180:181], v76 offset:832
  v_accvgpr_read_b32 v43, a59
  v_mfma_f32_16x16x32_bf16 v[96:99], a[144:147], v[204:207], v[96:99]
  ds_read_b64 a[182:183], v76 offset:840
  v_mfma_f32_16x16x32_bf16 v[100:103], a[144:147], v[208:211], v[100:103]
  ds_read_b128 v[224:227], v77 offset:3392
  v_accvgpr_read_b32 v44, a60
  v_mfma_f32_16x16x32_bf16 v[104:107], a[144:147], v[212:215], v[104:107]
  ds_read_b64 a[184:185], v76 offset:1344
  v_accvgpr_read_b32 v45, a61
  v_mfma_f32_16x16x32_bf16 v[108:111], a[144:147], v[216:219], v[108:111]
  ds_read_b64 a[186:187], v76 offset:1352
  v_mfma_f32_16x16x32_bf16 v[84:87], a[148:151], v[188:191], v[84:87]
  ds_read_b128 v[228:231], v77 offset:2880
  v_accvgpr_read_b32 v46, a62
  v_mfma_f32_16x16x32_bf16 v[88:91], a[148:151], v[192:195], v[88:91]
  ds_read_b64 a[188:189], v76 offset:1856
  v_accvgpr_read_b32 v47, a63
  v_mfma_f32_16x16x32_bf16 v[92:95], a[148:151], v[196:199], v[92:95]
  ds_read_b64 a[190:191], v76 offset:1864
  v_mfma_f32_16x16x32_bf16 v[96:99], a[148:151], v[200:203], v[96:99]
  ds_read_b128 v[232:235], v77 offset:2368
  v_cvt_pk_bf16_f32 v48, v40, v41
  v_mfma_f32_16x16x32_bf16 v[100:103], a[148:151], v[204:207], v[100:103]
  ds_read_b64 a[192:193], v76 offset:2368
  v_cvt_pk_bf16_f32 v49, v42, v43
  v_mfma_f32_16x16x32_bf16 v[104:107], a[148:151], v[208:211], v[104:107]
  ds_read_b64 a[194:195], v76 offset:2376
  v_mfma_f32_16x16x32_bf16 v[108:111], a[148:151], v[212:215], v[108:111]
  ds_read_b128 v[236:239], v77 offset:1856
  v_cvt_pk_bf16_f32 v50, v44, v45
  v_mfma_f32_16x16x32_bf16 v[88:91], a[152:155], v[188:191], v[88:91]
  ds_read_b64 a[196:197], v76 offset:2880
  v_cvt_pk_bf16_f32 v51, v46, v47
  v_mfma_f32_16x16x32_bf16 v[92:95], a[152:155], v[192:195], v[92:95]
  ds_read_b64 a[198:199], v76 offset:2888
  v_mfma_f32_16x16x32_bf16 v[96:99], a[152:155], v[196:199], v[96:99]
  ds_read_b128 v[240:243], v77 offset:1344
  s_add_u32 s35, s31, 12288
  v_mfma_f32_16x16x32_bf16 v[100:103], a[152:155], v[200:203], v[100:103]
  ds_read_b64 a[200:201], v76 offset:3392
  v_mfma_f32_16x16x32_bf16 v[104:107], a[152:155], v[204:207], v[104:107]
  ds_read_b64 a[202:203], v76 offset:3400
  v_mfma_f32_16x16x32_bf16 v[108:111], a[152:155], v[208:211], v[108:111]
  ds_read_b128 v[244:247], v77 offset:832
  buffer_store_dwordx4 v[48:51], v35, s[16:19], s35 offen sc1
  v_mfma_f32_16x16x32_bf16 v[92:95], a[156:159], v[188:191], v[92:95]
  ds_read_b64 a[204:205], v76 offset:3904
  v_mfma_f32_16x16x32_bf16 v[96:99], a[156:159], v[192:195], v[96:99]
  ds_read_b64 a[206:207], v76 offset:3912
  v_mfma_f32_16x16x32_bf16 v[100:103], a[156:159], v[196:199], v[100:103]
  ds_read_b128 v[248:251], v77 offset:320
  v_mfma_f32_16x16x32_bf16 v[104:107], a[156:159], v[200:203], v[104:107]
  v_accvgpr_read_b32 v52, a72
  v_accvgpr_read_b32 v53, a73
  v_accvgpr_read_b32 v54, a74
  v_mfma_f32_16x16x32_bf16 v[108:111], a[156:159], v[204:207], v[108:111]
  v_accvgpr_read_b32 v55, a75
  v_accvgpr_read_b32 v56, a76
  v_accvgpr_read_b32 v57, a77
  v_mfma_f32_16x16x32_bf16 v[96:99], a[160:163], v[188:191], v[96:99]
  v_accvgpr_read_b32 v58, a78
  v_accvgpr_read_b32 v59, a79
  v_mfma_f32_16x16x32_bf16 v[100:103], a[160:163], v[192:195], v[100:103]
  v_cvt_pk_bf16_f32 v60, v52, v53
  v_cvt_pk_bf16_f32 v61, v54, v55
  v_cvt_pk_bf16_f32 v62, v56, v57
  v_mfma_f32_16x16x32_bf16 v[104:107], a[160:163], v[196:199], v[104:107]
  v_cvt_pk_bf16_f32 v63, v58, v59
  v_mfma_f32_16x16x32_bf16 v[108:111], a[160:163], v[200:203], v[108:111]
  buffer_store_dwordx4 v[60:63], v35, s[16:19], s35 offen offset:1024 sc1
  v_accvgpr_read_b32 v64, a88
  v_mfma_f32_16x16x32_bf16 v[100:103], a[164:167], v[188:191], v[100:103]
  v_accvgpr_read_b32 v65, a89
  v_accvgpr_read_b32 v66, a90
  v_mfma_f32_16x16x32_bf16 v[104:107], a[164:167], v[192:195], v[104:107]
  v_accvgpr_read_b32 v67, a91
  v_accvgpr_read_b32 v68, a92
  v_accvgpr_read_b32 v69, a93
  v_mfma_f32_16x16x32_bf16 v[108:111], a[164:167], v[196:199], v[108:111]
  v_accvgpr_read_b32 v70, a94
  v_accvgpr_read_b32 v71, a95
  v_cvt_pk_bf16_f32 v72, v64, v65
  v_mfma_f32_16x16x32_bf16 v[104:107], a[168:171], v[188:191], v[104:107]
  v_cvt_pk_bf16_f32 v73, v66, v67
  v_cvt_pk_bf16_f32 v74, v68, v69
  v_mfma_f32_16x16x32_bf16 v[108:111], a[168:171], v[192:195], v[108:111]
  v_cvt_pk_bf16_f32 v75, v70, v71
  v_accvgpr_read_b32 v40, a104
  v_mfma_f32_16x16x32_bf16 v[108:111], a[172:175], v[188:191], v[108:111]
  buffer_store_dwordx4 v[72:75], v35, s[16:19], s35 offen offset:2048 sc1
  s_waitcnt lgkmcnt(0)
  v_mfma_f32_16x16x32_bf16 v[80:83], a[176:179], v[220:223], v[80:83]
  ds_read_b64 a[144:145], v76 offset:384
  v_accvgpr_read_b32 v41, a105
  v_mfma_f32_16x16x32_bf16 v[84:87], a[176:179], v[224:227], v[84:87]
  ds_read_b64 a[146:147], v76 offset:392
  v_mfma_f32_16x16x32_bf16 v[88:91], a[176:179], v[228:231], v[88:91]
  ds_read_b128 v[188:191], v77 offset:3968
  v_accvgpr_read_b32 v42, a106
  v_mfma_f32_16x16x32_bf16 v[92:95], a[176:179], v[232:235], v[92:95]
  ds_read_b64 a[148:149], v76 offset:896
  v_accvgpr_read_b32 v43, a107
  v_mfma_f32_16x16x32_bf16 v[96:99], a[176:179], v[236:239], v[96:99]
  ds_read_b64 a[150:151], v76 offset:904
  v_mfma_f32_16x16x32_bf16 v[100:103], a[176:179], v[240:243], v[100:103]
  ds_read_b128 v[192:195], v77 offset:3456
  v_accvgpr_read_b32 v44, a108
  v_mfma_f32_16x16x32_bf16 v[104:107], a[176:179], v[244:247], v[104:107]
  ds_read_b64 a[152:153], v76 offset:1408
  v_accvgpr_read_b32 v45, a109
  v_mfma_f32_16x16x32_bf16 v[108:111], a[176:179], v[248:251], v[108:111]
  ds_read_b64 a[154:155], v76 offset:1416
  v_mfma_f32_16x16x32_bf16 v[84:87], a[180:183], v[220:223], v[84:87]
  ds_read_b128 v[196:199], v77 offset:2944
  v_accvgpr_read_b32 v46, a110
  v_mfma_f32_16x16x32_bf16 v[88:91], a[180:183], v[224:227], v[88:91]
  ds_read_b64 a[156:157], v76 offset:1920
  v_mfma_f32_16x16x32_bf16 v[92:95], a[180:183], v[228:231], v[92:95]
  ds_read_b64 a[158:159], v76 offset:1928
  v_accvgpr_read_b32 v47, a111
  v_mfma_f32_16x16x32_bf16 v[96:99], a[180:183], v[232:235], v[96:99]
  ds_read_b128 v[200:203], v77 offset:2432
  v_cvt_pk_bf16_f32 v48, v40, v41
  v_mfma_f32_16x16x32_bf16 v[100:103], a[180:183], v[236:239], v[100:103]
  ds_read_b64 a[160:161], v76 offset:2432
  v_mfma_f32_16x16x32_bf16 v[104:107], a[180:183], v[240:243], v[104:107]
  ds_read_b64 a[162:163], v76 offset:2440
  v_cvt_pk_bf16_f32 v49, v42, v43
  v_mfma_f32_16x16x32_bf16 v[108:111], a[180:183], v[244:247], v[108:111]
  ds_read_b128 v[204:207], v77 offset:1920
  v_cvt_pk_bf16_f32 v50, v44, v45
  v_mfma_f32_16x16x32_bf16 v[88:91], a[184:187], v[220:223], v[88:91]
  ds_read_b64 a[164:165], v76 offset:2944
  v_mfma_f32_16x16x32_bf16 v[92:95], a[184:187], v[224:227], v[92:95]
  ds_read_b64 a[166:167], v76 offset:2952
  v_cvt_pk_bf16_f32 v51, v46, v47
  v_mfma_f32_16x16x32_bf16 v[96:99], a[184:187], v[228:231], v[96:99]
  ds_read_b128 v[208:211], v77 offset:1408
  v_mfma_f32_16x16x32_bf16 v[100:103], a[184:187], v[232:235], v[100:103]
  ds_read_b64 a[168:169], v76 offset:3456
  v_mfma_f32_16x16x32_bf16 v[104:107], a[184:187], v[236:239], v[104:107]
  ds_read_b64 a[170:171], v76 offset:3464
  buffer_store_dwordx4 v[48:51], v35, s[16:19], s35 offen offset:3072 sc1
  v_mfma_f32_16x16x32_bf16 v[108:111], a[184:187], v[240:243], v[108:111]
  ds_read_b128 v[212:215], v77 offset:896
  v_mfma_f32_16x16x32_bf16 v[92:95], a[188:191], v[220:223], v[92:95]
  ds_read_b64 a[172:173], v76 offset:3968
  v_mfma_f32_16x16x32_bf16 v[96:99], a[188:191], v[224:227], v[96:99]
  ds_read_b64 a[174:175], v76 offset:3976
  v_mfma_f32_16x16x32_bf16 v[100:103], a[188:191], v[228:231], v[100:103]
  ds_read_b128 v[216:219], v77 offset:384
  v_accvgpr_read_b32 v52, a120
  v_mfma_f32_16x16x32_bf16 v[104:107], a[188:191], v[232:235], v[104:107]
  v_accvgpr_read_b32 v53, a121
  v_accvgpr_read_b32 v54, a122
  v_mfma_f32_16x16x32_bf16 v[108:111], a[188:191], v[236:239], v[108:111]
  v_accvgpr_read_b32 v55, a123
  v_accvgpr_read_b32 v56, a124
  v_accvgpr_read_b32 v57, a125
  v_mfma_f32_16x16x32_bf16 v[96:99], a[192:195], v[220:223], v[96:99]
  v_accvgpr_read_b32 v58, a126
  v_accvgpr_read_b32 v59, a127
  v_cvt_pk_bf16_f32 v60, v52, v53
  v_mfma_f32_16x16x32_bf16 v[100:103], a[192:195], v[224:227], v[100:103]
  v_cvt_pk_bf16_f32 v61, v54, v55
  v_cvt_pk_bf16_f32 v62, v56, v57
  v_mfma_f32_16x16x32_bf16 v[104:107], a[192:195], v[228:231], v[104:107]
  v_cvt_pk_bf16_f32 v63, v58, v59
  v_accvgpr_read_b32 v64, a136
  v_accvgpr_read_b32 v65, a137
  v_mfma_f32_16x16x32_bf16 v[108:111], a[192:195], v[232:235], v[108:111]
  s_add_u32 s35, s31, 16384
  buffer_store_dwordx4 v[60:63], v35, s[16:19], s35 offen sc1
  v_mfma_f32_16x16x32_bf16 v[100:103], a[196:199], v[220:223], v[100:103]
  v_accvgpr_read_b32 v66, a138
  v_mfma_f32_16x16x32_bf16 v[104:107], a[196:199], v[224:227], v[104:107]
  v_accvgpr_read_b32 v67, a139
  v_accvgpr_read_b32 v68, a140
  v_mfma_f32_16x16x32_bf16 v[108:111], a[196:199], v[228:231], v[108:111]
  v_accvgpr_read_b32 v69, a141
  v_accvgpr_read_b32 v70, a142
  v_accvgpr_read_b32 v71, a143
  v_mfma_f32_16x16x32_bf16 v[104:107], a[200:203], v[220:223], v[104:107]
  v_cvt_pk_bf16_f32 v72, v64, v65
  v_cvt_pk_bf16_f32 v73, v66, v67
  v_mfma_f32_16x16x32_bf16 v[108:111], a[200:203], v[224:227], v[108:111]
  v_cvt_pk_bf16_f32 v74, v68, v69
  v_cvt_pk_bf16_f32 v75, v70, v71
  v_mfma_f32_16x16x32_bf16 v[108:111], a[204:207], v[220:223], v[108:111]
  buffer_store_dwordx4 v[72:75], v35, s[16:19], s35 offen offset:1024 sc1
  s_waitcnt lgkmcnt(0)
  v_mfma_f32_16x16x32_bf16 v[80:83], a[144:147], v[188:191], v[80:83]
  ds_read_b64 a[176:177], v76 offset:448
  v_mfma_f32_16x16x32_bf16 v[84:87], a[144:147], v[192:195], v[84:87]
  ds_read_b64 a[178:179], v76 offset:456
  v_mfma_f32_16x16x32_bf16 v[88:91], a[144:147], v[196:199], v[88:91]
  ds_read_b128 v[220:223], v77 offset:4032
  v_mfma_f32_16x16x32_bf16 v[92:95], a[144:147], v[200:203], v[92:95]
  ds_read_b64 a[180:181], v76 offset:960
  v_mfma_f32_16x16x32_bf16 v[96:99], a[144:147], v[204:207], v[96:99]
  ds_read_b64 a[182:183], v76 offset:968
  v_mfma_f32_16x16x32_bf16 v[100:103], a[144:147], v[208:211], v[100:103]
  ds_read_b128 v[224:227], v77 offset:3520
  v_mfma_f32_16x16x32_bf16 v[104:107], a[144:147], v[212:215], v[104:107]
  ds_read_b64 a[184:185], v76 offset:1472
  v_mfma_f32_16x16x32_bf16 v[108:111], a[144:147], v[216:219], v[108:111]
  ds_read_b64 a[186:187], v76 offset:1480
  v_mfma_f32_16x16x32_bf16 v[84:87], a[148:151], v[188:191], v[84:87]
  ds_read_b128 v[228:231], v77 offset:3008
  v_mfma_f32_16x16x32_bf16 v[88:91], a[148:151], v[192:195], v[88:91]
  ds_read_b64 a[188:189], v76 offset:1984
  v_mfma_f32_16x16x32_bf16 v[92:95], a[148:151], v[196:199], v[92:95]
  ds_read_b64 a[190:191], v76 offset:1992
  v_mfma_f32_16x16x32_bf16 v[96:99], a[148:151], v[200:203], v[96:99]
  ds_read_b128 v[232:235], v77 offset:2496
  v_mfma_f32_16x16x32_bf16 v[100:103], a[148:151], v[204:207], v[100:103]
  ds_read_b64 a[192:193], v76 offset:2496
  v_mfma_f32_16x16x32_bf16 v[104:107], a[148:151], v[208:211], v[104:107]
  ds_read_b64 a[194:195], v76 offset:2504
  v_mfma_f32_16x16x32_bf16 v[108:111], a[148:151], v[212:215], v[108:111]
  ds_read_b128 v[236:239], v77 offset:1984
  v_mfma_f32_16x16x32_bf16 v[88:91], a[152:155], v[188:191], v[88:91]
  ds_read_b64 a[196:197], v76 offset:3008
  v_mfma_f32_16x16x32_bf16 v[92:95], a[152:155], v[192:195], v[92:95]
  ds_read_b64 a[198:199], v76 offset:3016
  v_mfma_f32_16x16x32_bf16 v[96:99], a[152:155], v[196:199], v[96:99]
  ds_read_b128 v[240:243], v77 offset:1472
  v_mfma_f32_16x16x32_bf16 v[100:103], a[152:155], v[200:203], v[100:103]
  ds_read_b64 a[200:201], v76 offset:3520
  v_mfma_f32_16x16x32_bf16 v[104:107], a[152:155], v[204:207], v[104:107]
  ds_read_b64 a[202:203], v76 offset:3528
  v_mfma_f32_16x16x32_bf16 v[108:111], a[152:155], v[208:211], v[108:111]
  ds_read_b128 v[244:247], v77 offset:960
  v_mfma_f32_16x16x32_bf16 v[92:95], a[156:159], v[188:191], v[92:95]
  ds_read_b64 a[204:205], v76 offset:4032
  v_mfma_f32_16x16x32_bf16 v[96:99], a[156:159], v[192:195], v[96:99]
  ds_read_b64 a[206:207], v76 offset:4040
  v_mfma_f32_16x16x32_bf16 v[100:103], a[156:159], v[196:199], v[100:103]
  ds_read_b128 v[248:251], v77 offset:448
  v_mfma_f32_16x16x32_bf16 v[104:107], a[156:159], v[200:203], v[104:107]
  v_mfma_f32_16x16x32_bf16 v[108:111], a[156:159], v[204:207], v[108:111]
  v_mfma_f32_16x16x32_bf16 v[96:99], a[160:163], v[188:191], v[96:99]
  v_mfma_f32_16x16x32_bf16 v[100:103], a[160:163], v[192:195], v[100:103]
  v_mfma_f32_16x16x32_bf16 v[104:107], a[160:163], v[196:199], v[104:107]
  v_mfma_f32_16x16x32_bf16 v[108:111], a[160:163], v[200:203], v[108:111]
  v_mfma_f32_16x16x32_bf16 v[100:103], a[164:167], v[188:191], v[100:103]
  v_mfma_f32_16x16x32_bf16 v[104:107], a[164:167], v[192:195], v[104:107]
  v_mfma_f32_16x16x32_bf16 v[108:111], a[164:167], v[196:199], v[108:111]
  v_mfma_f32_16x16x32_bf16 v[104:107], a[168:171], v[188:191], v[104:107]
  v_mfma_f32_16x16x32_bf16 v[108:111], a[168:171], v[192:195], v[108:111]
  v_mfma_f32_16x16x32_bf16 v[108:111], a[172:175], v[188:191], v[108:111]
  s_waitcnt lgkmcnt(0)
  v_mfma_f32_16x16x32_bf16 v[80:83], a[176:179], v[220:223], v[80:83]
  v_mfma_f32_16x16x32_bf16 v[84:87], a[176:179], v[224:227], v[84:87]
  v_mfma_f32_16x16x32_bf16 v[88:91], a[176:179], v[228:231], v[88:91]
  v_mfma_f32_16x16x32_bf16 v[92:95], a[176:179], v[232:235], v[92:95]
  v_mfma_f32_16x16x32_bf16 v[96:99], a[176:179], v[236:239], v[96:99]
  v_mfma_f32_16x16x32_bf16 v[100:103], a[176:179], v[240:243], v[100:103]
  v_mfma_f32_16x16x32_bf16 v[104:107], a[176:179], v[244:247], v[104:107]
  v_mfma_f32_16x16x32_bf16 v[108:111], a[176:179], v[248:251], v[108:111]
  v_mfma_f32_16x16x32_bf16 v[84:87], a[180:183], v[220:223], v[84:87]
  v_mfma_f32_16x16x32_bf16 v[88:91], a[180:183], v[224:227], v[88:91]
  v_mfma_f32_16x16x32_bf16 v[92:95], a[180:183], v[228:231], v[92:95]
  v_mfma_f32_16x16x32_bf16 v[96:99], a[180:183], v[232:235], v[96:99]
  v_mfma_f32_16x16x32_bf16 v[100:103], a[180:183], v[236:239], v[100:103]
  v_mfma_f32_16x16x32_bf16 v[104:107], a[180:183], v[240:243], v[104:107]
  v_mfma_f32_16x16x32_bf16 v[108:111], a[180:183], v[244:247], v[108:111]
  v_mfma_f32_16x16x32_bf16 v[88:91], a[184:187], v[220:223], v[88:91]
  v_mfma_f32_16x16x32_bf16 v[92:95], a[184:187], v[224:227], v[92:95]
  v_mfma_f32_16x16x32_bf16 v[96:99], a[184:187], v[228:231], v[96:99]
  v_mfma_f32_16x16x32_bf16 v[100:103], a[184:187], v[232:235], v[100:103]
  v_mfma_f32_16x16x32_bf16 v[104:107], a[184:187], v[236:239], v[104:107]
  v_mfma_f32_16x16x32_bf16 v[108:111], a[184:187], v[240:243], v[108:111]
  v_mfma_f32_16x16x32_bf16 v[92:95], a[188:191], v[220:223], v[92:95]
  v_mfma_f32_16x16x32_bf16 v[96:99], a[188:191], v[224:227], v[96:99]
  v_mfma_f32_16x16x32_bf16 v[100:103], a[188:191], v[228:231], v[100:103]
  v_mfma_f32_16x16x32_bf16 v[104:107], a[188:191], v[232:235], v[104:107]
  v_mfma_f32_16x16x32_bf16 v[108:111], a[188:191], v[236:239], v[108:111]
  v_mfma_f32_16x16x32_bf16 v[96:99], a[192:195], v[220:223], v[96:99]
  v_mfma_f32_16x16x32_bf16 v[100:103], a[192:195], v[224:227], v[100:103]
  v_mfma_f32_16x16x32_bf16 v[104:107], a[192:195], v[228:231], v[104:107]
  v_mfma_f32_16x16x32_bf16 v[108:111], a[192:195], v[232:235], v[108:111]
  v_mfma_f32_16x16x32_bf16 v[100:103], a[196:199], v[220:223], v[100:103]
  v_mfma_f32_16x16x32_bf16 v[104:107], a[196:199], v[224:227], v[104:107]
  v_mfma_f32_16x16x32_bf16 v[108:111], a[196:199], v[228:231], v[108:111]
  v_mfma_f32_16x16x32_bf16 v[104:107], a[200:203], v[220:223], v[104:107]
  v_mfma_f32_16x16x32_bf16 v[108:111], a[200:203], v[224:227], v[108:111]
  v_mfma_f32_16x16x32_bf16 v[108:111], a[204:207], v[220:223], v[108:111]
  s_waitcnt lgkmcnt(0)
  s_and_b32 s43, s40, 1
  s_lshl_b32 s43, s43, 4
  s_lshr_b32 s44, s44, s43
  s_lshl_b32 s44, s44, 16
  v_lshlrev_b32 v58, 5, v37
  v_lshl_add_u32 v58, v36, 3, v58
  s_add_u32 s46, s45, 21240
  v_sub_u32 v59, s46, v58
  ds_read_b64 v[112:113], v59 offset:3584
  ds_read_b64 v[114:115], v59 offset:3072
  ds_read_b64 v[116:117], v59 offset:2560
  ds_read_b64 v[118:119], v59 offset:2048
  ds_read_b64 v[120:121], v59 offset:1536
  ds_read_b64 v[122:123], v59 offset:1024
  ds_read_b64 v[124:125], v59 offset:512
  ds_read_b64 v[126:127], v59 offset:0
  s_mul_i32 s46, s24, 4160
  s_add_u32 s46, s46, 103424
  v_add_u32 v59, s46, v58
  s_nop 7
  s_waitcnt lgkmcnt(0)
  v_and_b32 v64, 0xffff0000, v113
  v_lshlrev_b32 v65, 16, v113
  v_and_b32 v66, 0xffff0000, v112
  v_lshlrev_b32 v67, 16, v112
  v_fma_f32 v80, v64, s44, v80
  v_fma_f32 v81, v65, s44, v81
  v_fma_f32 v82, v66, s44, v82
  v_fma_f32 v83, v67, s44, v83
  v_cvt_pk_bf16_f32 v68, v80, v81
  v_cvt_pk_bf16_f32 v69, v82, v83
  ds_write_b64 v59, v[68:69] offset:0
  v_and_b32 v64, 0xffff0000, v115
  v_lshlrev_b32 v65, 16, v115
  v_and_b32 v66, 0xffff0000, v114
  v_lshlrev_b32 v67, 16, v114
  v_fma_f32 v84, v64, s44, v84
  v_fma_f32 v85, v65, s44, v85
  v_fma_f32 v86, v66, s44, v86
  v_fma_f32 v87, v67, s44, v87
  v_cvt_pk_bf16_f32 v70, v84, v85
  v_cvt_pk_bf16_f32 v71, v86, v87
  ds_write_b64 v59, v[70:71] offset:512
  v_and_b32 v64, 0xffff0000, v117
  v_lshlrev_b32 v65, 16, v117
  v_and_b32 v66, 0xffff0000, v116
  v_lshlrev_b32 v67, 16, v116
  v_fma_f32 v88, v64, s44, v88
  v_fma_f32 v89, v65, s44, v89
  v_fma_f32 v90, v66, s44, v90
  v_fma_f32 v91, v67, s44, v91
  v_cvt_pk_bf16_f32 v68, v88, v89
  v_cvt_pk_bf16_f32 v69, v90, v91
  ds_write_b64 v59, v[68:69] offset:1024
  v_and_b32 v64, 0xffff0000, v119
  v_lshlrev_b32 v65, 16, v119
  v_and_b32 v66, 0xffff0000, v118
  v_lshlrev_b32 v67, 16, v118
  v_fma_f32 v92, v64, s44, v92
  v_fma_f32 v93, v65, s44, v93
  v_fma_f32 v94, v66, s44, v94
  v_fma_f32 v95, v67, s44, v95
  v_cvt_pk_bf16_f32 v70, v92, v93
  v_cvt_pk_bf16_f32 v71, v94, v95
  ds_write_b64 v59, v[70:71] offset:1536
  v_and_b32 v64, 0xffff0000, v121
  v_lshlrev_b32 v65, 16, v121
  v_and_b32 v66, 0xffff0000, v120
  v_lshlrev_b32 v67, 16, v120
  v_fma_f32 v96, v64, s44, v96
  v_fma_f32 v97, v65, s44, v97
  v_fma_f32 v98, v66, s44, v98
  v_fma_f32 v99, v67, s44, v99
  v_cvt_pk_bf16_f32 v68, v96, v97
  v_cvt_pk_bf16_f32 v69, v98, v99
  ds_write_b64 v59, v[68:69] offset:2048
  v_and_b32 v64, 0xffff0000, v123
  v_lshlrev_b32 v65, 16, v123
  v_and_b32 v66, 0xffff0000, v122
  v_lshlrev_b32 v67, 16, v122
  v_fma_f32 v100, v64, s44, v100
  v_fma_f32 v101, v65, s44, v101
  v_fma_f32 v102, v66, s44, v102
  v_fma_f32 v103, v67, s44, v103
  v_cvt_pk_bf16_f32 v70, v100, v101
  v_cvt_pk_bf16_f32 v71, v102, v103
  ds_write_b64 v59, v[70:71] offset:2560
  v_and_b32 v64, 0xffff0000, v125
  v_lshlrev_b32 v65, 16, v125
  v_and_b32 v66, 0xffff0000, v124
  v_lshlrev_b32 v67, 16, v124
  v_fma_f32 v104, v64, s44, v104
  v_fma_f32 v105, v65, s44, v105
  v_fma_f32 v106, v66, s44, v106
  v_fma_f32 v107, v67, s44, v107
  v_cvt_pk_bf16_f32 v68, v104, v105
  v_cvt_pk_bf16_f32 v69, v106, v107
  ds_write_b64 v59, v[68:69] offset:3072
  v_and_b32 v64, 0xffff0000, v127
  v_lshlrev_b32 v65, 16, v127
  v_and_b32 v66, 0xffff0000, v126
  v_lshlrev_b32 v67, 16, v126
  v_fma_f32 v108, v64, s44, v108
  v_fma_f32 v109, v65, s44, v109
  v_fma_f32 v110, v66, s44, v110
  v_fma_f32 v111, v67, s44, v111
  v_cvt_pk_bf16_f32 v70, v108, v109
  v_cvt_pk_bf16_f32 v71, v110, v111
  ds_write_b64 v59, v[70:71] offset:3584
  v_lshrrev_b32 v58, 2, v37
  v_mul_u32_u24 v58, 4160, v58
  v_and_b32 v59, 3, v2
  v_lshl_add_u32 v58, v59, 3, v58
  v_lshl_add_u32 v58, v36, 5, v58
  s_lshl_b32 s46, s24, 10
  s_add_u32 s46, s46, 103424
  v_add_u32 v58, s46, v58
  v_lshlrev_b32 v59, 3, v2
  s_lshl_b32 s46, s2, 14
  s_lshl_b32 s47, s24, 12
  s_add_u32 s46, s46, s47
  s_add_u32 s46, s46, 2359296
  s_waitcnt lgkmcnt(0)
  s_barrier
  ds_read_b64_tr_b16 v[112:113], v58 offset:0
  ds_read_b64_tr_b16 v[114:115], v58 offset:128
  ds_read_b64_tr_b16 v[116:117], v58 offset:256
  ds_read_b64_tr_b16 v[118:119], v58 offset:384
  ds_read_b64_tr_b16 v[120:121], v58 offset:512
  ds_read_b64_tr_b16 v[122:123], v58 offset:640
  ds_read_b64_tr_b16 v[124:125], v58 offset:768
  ds_read_b64_tr_b16 v[126:127], v58 offset:896
  s_waitcnt lgkmcnt(7)
  buffer_store_dwordx2 v[112:113], v59, s[16:19], s46 offen offset:0 sc1
  s_waitcnt lgkmcnt(6)
  buffer_store_dwordx2 v[114:115], v59, s[16:19], s46 offen offset:512 sc1
  s_waitcnt lgkmcnt(5)
  buffer_store_dwordx2 v[116:117], v59, s[16:19], s46 offen offset:1024 sc1
  s_waitcnt lgkmcnt(4)
  buffer_store_dwordx2 v[118:119], v59, s[16:19], s46 offen offset:1536 sc1
  s_waitcnt lgkmcnt(3)
  buffer_store_dwordx2 v[120:121], v59, s[16:19], s46 offen offset:2048 sc1
  s_waitcnt lgkmcnt(2)
  buffer_store_dwordx2 v[122:123], v59, s[16:19], s46 offen offset:2560 sc1
  s_waitcnt lgkmcnt(1)
  buffer_store_dwordx2 v[124:125], v59, s[16:19], s46 offen offset:3072 sc1
  s_waitcnt lgkmcnt(0)
  buffer_store_dwordx2 v[126:127], v59, s[16:19], s46 offen offset:3584 sc1
K_NOCONV:
  s_waitcnt vmcnt(0) lgkmcnt(0)
  s_barrier
  s_cmp_lg_u32 s24, 0
  s_cbranch_scc1 K_NOFL2
  s_lshl_b32 s34, s26, 7
  s_lshl_b32 s35, s25, 2
  s_add_u32 s34, s34, s35
  s_add_u32 s34, s34, 4719616
  v_mov_b32 v38, s94
  v_mov_b32 v39, 0
  s_mov_b64 exec, 1
  buffer_store_dword v38, v39, s[16:19], s34 offen sc1
  s_cmp_ge_u32 s2, 144
  s_cbranch_scc1 K_NOFL2Y
  s_lshl_b32 s34, s2, 2
  s_add_u32 s34, s34, 4723712
  buffer_store_dword v38, v39, s[16:19], s34 offen sc1
K_NOFL2Y:
  s_mov_b64 exec, -1
K_NOFL2:
  s_mov_b32 s52, s4
  s_mov_b32 s53, s5
  s_mov_b32 s54, 2359296
  s_mov_b32 s55, 0x00020000
  s_mov_b32 s56, s48
  s_mov_b32 s57, s49
  s_mov_b32 s58, 2359296
  s_mov_b32 s59, 0x00020000
  s_lshr_b32 s60, s25, 1
  s_and_b32 s61, s25, 1
  s_lshl_b32 s62, s26, 7
  s_add_u32 s62, s62, 1024
  v_lshlrev_b32 v40, 2, v2
  v_add_u32 v41, s62, v40
  s_lshl_b32 s63, s60, 7
  s_add_u32 s63, s63, 5088
  v_add_u32 v42, s63, v40
  s_lshl_b32 s63, s60, 4
  s_add_u32 s63, s63, 5472
  v_add_u32 v43, s63, v40
  v_cmp_gt_u32 vcc, 8, v2
  s_nop 1
  v_cndmask_b32 v42, v42, v41, vcc
  v_cmp_lt_u32 vcc, 39, v2
  s_nop 1
  v_cndmask_b32 v42, v42, v43, vcc
  v_mov_b32 v43, s62
  v_cmp_lt_u32 vcc, 43, v2
  s_nop 1
  v_cndmask_b32 v42, v42, v43, vcc
  s_mov_b32 s63, 4718592
  s_lshl_b32 s34, s26, 6
  s_lshl_b32 s35, s61, 5
  s_add_u32 s34, s34, s35
  v_add_u32 v6, s34, v37
  s_lshl_b32 s35, s61, 8
  s_add_u32 s35, s35, 159744
  v_lshl_add_u32 v7, v37, 3, s35
  ds_read_b64 v[60:61], v7
  ds_read_b64 v[62:63], v7 offset:128
  s_lshl_b32 s34, s26, 3
  s_add_u32 s34, s34, s25
  s_mul_i32 s34, s34, 9216
  s_add_u32 s34, s34, 4784128
  s_add_u32 s64, s24, 0
  s_min_u32 s64, s64, 8
  s_lshl_b32 s35, s60, 7
  s_lshl_b32 s40, s64, 4
  s_add_u32 s35, s35, s40
  s_lshl_b32 s40, s60, 4
  s_add_u32 s40, s40, 512
  s_cmp_lt_u32 s64, 8
  s_cselect_b32 s35, s35, s40
  v_lshl_add_u32 v8, v36, 2, s35
  v_mul_u32_u24 v12, 1152, v6
  v_lshl_add_u32 v12, v8, 1, v12
  v_add_u32 v16, 18432, v12
  buffer_load_dwordx2 v[112:113], v12, s[52:55], 0 offen
  buffer_load_dwordx2 v[114:115], v16, s[52:55], 0 offen
  v_lshrrev_b32 v20, 2, v8
  v_lshlrev_b32 v20, 14, v20
  v_lshl_add_u32 v20, v6, 3, v20
  s_add_u32 s65, s24, 4
  s_min_u32 s65, s65, 8
  s_lshl_b32 s35, s60, 7
  s_lshl_b32 s40, s65, 4
  s_add_u32 s35, s35, s40
  s_lshl_b32 s40, s60, 4
  s_add_u32 s40, s40, 512
  s_cmp_lt_u32 s65, 8
  s_cselect_b32 s35, s35, s40
  v_lshl_add_u32 v9, v36, 2, s35
  v_mul_u32_u24 v13, 1152, v6
  v_lshl_add_u32 v13, v9, 1, v13
  v_add_u32 v17, 18432, v13
  buffer_load_dwordx2 v[116:117], v13, s[52:55], 0 offen
  buffer_load_dwordx2 v[118:119], v17, s[52:55], 0 offen
  v_lshrrev_b32 v21, 2, v9
  v_lshlrev_b32 v21, 14, v21
  v_lshl_add_u32 v21, v6, 3, v21
  s_add_u32 s66, s24, 8
  s_min_u32 s66, s66, 8
  s_lshl_b32 s35, s60, 7
  s_lshl_b32 s40, s66, 4
  s_add_u32 s35, s35, s40
  s_lshl_b32 s40, s60, 4
  s_add_u32 s40, s40, 512
  s_cmp_lt_u32 s66, 8
  s_cselect_b32 s35, s35, s40
  v_lshl_add_u32 v10, v36, 2, s35
  v_mul_u32_u24 v14, 1152, v6
  v_lshl_add_u32 v14, v10, 1, v14
  v_add_u32 v18, 18432, v14
  buffer_load_dwordx2 v[120:121], v14, s[52:55], 0 offen
  buffer_load_dwordx2 v[122:123], v18, s[52:55], 0 offen
  v_lshrrev_b32 v22, 2, v10
  v_lshlrev_b32 v22, 14, v22
  v_lshl_add_u32 v22, v6, 3, v22
  s_cmp_lg_u32 s24, 0
  s_cbranch_scc1 K_FIN_GO
  s_mov_b32 s47, 1048576
POLL2_FIN:
  buffer_load_dword v44, v42, s[16:19], s63 offen sc1
  s_waitcnt vmcnt(0)
  v_cmp_ne_u32 vcc, s94, v44
  s_nop 3
  s_cmp_eq_u64 vcc, 0
  s_cbranch_scc1 POLL2_FIN_X
  s_sub_u32 s47, s47, 1
  s_cbranch_scc1 POLL2_FIN_X
  s_sleep 1
  s_branch POLL2_FIN
POLL2_FIN_X:
K_FIN_GO:
  s_barrier
  s_mov_b32 s41, 2359296
  s_lshl_b32 s35, s24, 1
  s_mul_i32 s35, s35, 2359296
  s_add_u32 s35, s35, s34
  s_add_u32 s35, s35, 8192
  buffer_load_dwordx4 v[200:203], v35, s[16:19], s35 offen sc1
  s_add_u32 s35, s35, 2359296
  buffer_load_dwordx4 v[204:207], v35, s[16:19], s35 offen sc1
  s_lshl_b32 s35, s64, 10
  s_add_u32 s35, s35, s34
  buffer_load_dwordx4 v[136:139], v35, s[16:19], s35 offen sc1
  s_add_u32 s35, s35, 2359296
  buffer_load_dwordx4 v[140:143], v35, s[16:19], s35 offen sc1
  s_add_u32 s35, s35, 2359296
  buffer_load_dwordx4 v[144:147], v35, s[16:19], s35 offen sc1
  s_add_u32 s35, s35, 2359296
  buffer_load_dwordx4 v[148:151], v35, s[16:19], s35 offen sc1
  s_add_u32 s35, s35, 2359296
  buffer_load_dwordx4 v[152:155], v35, s[16:19], s35 offen sc1
  s_add_u32 s35, s35, 2359296
  buffer_load_dwordx4 v[156:159], v35, s[16:19], s35 offen sc1
  s_add_u32 s35, s35, 2359296
  buffer_load_dwordx4 v[160:163], v35, s[16:19], s35 offen sc1
  s_add_u32 s35, s35, 2359296
  buffer_load_dwordx4 v[164:167], v35, s[16:19], s35 offen sc1
  buffer_load_dwordx2 v[124:125], v20, s[16:19], s41 offen sc1
  buffer_load_dwordx2 v[126:127], v20, s[16:19], s41 offen offset:128 sc1
  s_lshl_b32 s35, s65, 10
  s_add_u32 s35, s35, s34
  buffer_load_dwordx4 v[168:171], v35, s[16:19], s35 offen sc1
  s_add_u32 s35, s35, 2359296
  buffer_load_dwordx4 v[172:175], v35, s[16:19], s35 offen sc1
  s_add_u32 s35, s35, 2359296
  buffer_load_dwordx4 v[176:179], v35, s[16:19], s35 offen sc1
  s_add_u32 s35, s35, 2359296
  buffer_load_dwordx4 v[180:183], v35, s[16:19], s35 offen sc1
  s_add_u32 s35, s35, 2359296
  buffer_load_dwordx4 v[184:187], v35, s[16:19], s35 offen sc1
  s_add_u32 s35, s35, 2359296
  buffer_load_dwordx4 v[188:191], v35, s[16:19], s35 offen sc1
  s_add_u32 s35, s35, 2359296
  buffer_load_dwordx4 v[192:195], v35, s[16:19], s35 offen sc1
  s_add_u32 s35, s35, 2359296
  buffer_load_dwordx4 v[196:199], v35, s[16:19], s35 offen sc1
  buffer_load_dwordx2 v[128:129], v21, s[16:19], s41 offen sc1
  buffer_load_dwordx2 v[130:131], v21, s[16:19], s41 offen offset:128 sc1
  s_cmp_lg_u32 s24, 3
  s_cbranch_scc1 K_FIN_L2
  buffer_load_dwordx2 v[132:133], v22, s[16:19], s41 offen sc1
  buffer_load_dwordx2 v[134:135], v22, s[16:19], s41 offen offset:128 sc1
K_FIN_L2:
  s_mov_b32 s40, 0x00003f80
  s_mov_b32 s41, 0x3f800000
  s_waitcnt lgkmcnt(0)
  v_mul_f32 v60, 0xbf317218, v60
  v_mul_f32 v61, 0xbf317218, v61
  v_mul_f32 v62, 0xbf317218, v62
  v_mul_f32 v63, 0xbf317218, v63
  s_lshl_b32 s35, s24, 11
  v_add_u32 v23, s35, v35
  s_waitcnt vmcnt(21)
  v_lshlrev_b32 v208, 16, v200
  v_and_b32 v209, 0xffff0000, v200
  v_lshlrev_b32 v210, 16, v201
  v_and_b32 v211, 0xffff0000, v201
  v_lshlrev_b32 v212, 16, v202
  v_and_b32 v213, 0xffff0000, v202
  v_lshlrev_b32 v214, 16, v203
  v_and_b32 v215, 0xffff0000, v203
  s_waitcnt vmcnt(20)
  v_dot2_f32_bf16 v208, v204, s40, v208
  v_dot2_f32_bf16 v209, v204, s41, v209
  v_dot2_f32_bf16 v210, v205, s40, v210
  v_dot2_f32_bf16 v211, v205, s41, v211
  v_dot2_f32_bf16 v212, v206, s40, v212
  v_dot2_f32_bf16 v213, v206, s41, v213
  v_dot2_f32_bf16 v214, v207, s40, v214
  v_dot2_f32_bf16 v215, v207, s41, v215
  s_nop 2
  ds_write_b128 v23, v[208:211]
  ds_write_b128 v23, v[212:215] offset:1024
  s_waitcnt vmcnt(19)
  v_lshlrev_b32 v64, 16, v136
  v_and_b32 v65, 0xffff0000, v136
  v_lshlrev_b32 v66, 16, v137
  v_and_b32 v67, 0xffff0000, v137
  v_lshlrev_b32 v68, 16, v138
  v_and_b32 v69, 0xffff0000, v138
  v_lshlrev_b32 v70, 16, v139
  v_and_b32 v71, 0xffff0000, v139
  s_waitcnt vmcnt(18)
  v_dot2_f32_bf16 v64, v140, s40, v64
  v_dot2_f32_bf16 v65, v140, s41, v65
  v_dot2_f32_bf16 v66, v141, s40, v66
  v_dot2_f32_bf16 v67, v141, s41, v67
  v_dot2_f32_bf16 v68, v142, s40, v68
  v_dot2_f32_bf16 v69, v142, s41, v69
  v_dot2_f32_bf16 v70, v143, s40, v70
  v_dot2_f32_bf16 v71, v143, s41, v71
  s_waitcnt vmcnt(17)
  v_dot2_f32_bf16 v64, v144, s40, v64
  v_dot2_f32_bf16 v65, v144, s41, v65
  v_dot2_f32_bf16 v66, v145, s40, v66
  v_dot2_f32_bf16 v67, v145, s41, v67
  v_dot2_f32_bf16 v68, v146, s40, v68
  v_dot2_f32_bf16 v69, v146, s41, v69
  v_dot2_f32_bf16 v70, v147, s40, v70
  v_dot2_f32_bf16 v71, v147, s41, v71
  s_waitcnt vmcnt(16)
  v_dot2_f32_bf16 v64, v148, s40, v64
  v_dot2_f32_bf16 v65, v148, s41, v65
  v_dot2_f32_bf16 v66, v149, s40, v66
  v_dot2_f32_bf16 v67, v149, s41, v67
  v_dot2_f32_bf16 v68, v150, s40, v68
  v_dot2_f32_bf16 v69, v150, s41, v69
  v_dot2_f32_bf16 v70, v151, s40, v70
  v_dot2_f32_bf16 v71, v151, s41, v71
  s_waitcnt vmcnt(15)
  v_dot2_f32_bf16 v64, v152, s40, v64
  v_dot2_f32_bf16 v65, v152, s41, v65
  v_dot2_f32_bf16 v66, v153, s40, v66
  v_dot2_f32_bf16 v67, v153, s41, v67
  v_dot2_f32_bf16 v68, v154, s40, v68
  v_dot2_f32_bf16 v69, v154, s41, v69
  v_dot2_f32_bf16 v70, v155, s40, v70
  v_dot2_f32_bf16 v71, v155, s41, v71
  s_waitcnt vmcnt(14)
  v_dot2_f32_bf16 v64, v156, s40, v64
  v_dot2_f32_bf16 v65, v156, s41, v65
  v_dot2_f32_bf16 v66, v157, s40, v66
  v_dot2_f32_bf16 v67, v157, s41, v67
  v_dot2_f32_bf16 v68, v158, s40, v68
  v_dot2_f32_bf16 v69, v158, s41, v69
  v_dot2_f32_bf16 v70, v159, s40, v70
  v_dot2_f32_bf16 v71, v159, s41, v71
  s_waitcnt vmcnt(13)
  v_dot2_f32_bf16 v64, v160, s40, v64
  v_dot2_f32_bf16 v65, v160, s41, v65
  v_dot2_f32_bf16 v66, v161, s40, v66
  v_dot2_f32_bf16 v67, v161, s41, v67
  v_dot2_f32_bf16 v68, v162, s40, v68
  v_dot2_f32_bf16 v69, v162, s41, v69
  v_dot2_f32_bf16 v70, v163, s40, v70
  v_dot2_f32_bf16 v71, v163, s41, v71
  s_waitcnt vmcnt(12)
  v_dot2_f32_bf16 v64, v164, s40, v64
  v_dot2_f32_bf16 v65, v164, s41, v65
  v_dot2_f32_bf16 v66, v165, s40, v66
  v_dot2_f32_bf16 v67, v165, s41, v67
  v_dot2_f32_bf16 v68, v166, s40, v68
  v_dot2_f32_bf16 v69, v166, s41, v69
  v_dot2_f32_bf16 v70, v167, s40, v70
  v_dot2_f32_bf16 v71, v167, s41, v71
  s_nop 2
  v_exp_f32 v74, v64
  v_exp_f32 v75, v65
  v_exp_f32 v76, v66
  v_exp_f32 v77, v67
  v_exp_f32 v78, v68
  v_exp_f32 v79, v69
  v_exp_f32 v80, v70
  v_exp_f32 v81, v71
  s_nop 0
  v_add_f32 v74, 1.0, v74
  v_add_f32 v75, 1.0, v75
  v_add_f32 v76, 1.0, v76
  v_add_f32 v77, 1.0, v77
  v_add_f32 v78, 1.0, v78
  v_add_f32 v79, 1.0, v79
  v_add_f32 v80, 1.0, v80
  v_add_f32 v81, 1.0, v81
  v_rcp_f32 v74, v74
  v_rcp_f32 v75, v75
  v_rcp_f32 v76, v76
  v_rcp_f32 v77, v77
  v_rcp_f32 v78, v78
  v_rcp_f32 v79, v79
  v_rcp_f32 v80, v80
  v_rcp_f32 v81, v81
  s_nop 0
  v_mul_f32 v64, v64, v74
  v_mul_f32 v65, v65, v75
  v_mul_f32 v66, v66, v76
  v_mul_f32 v67, v67, v77
  v_mul_f32 v68, v68, v78
  v_mul_f32 v69, v69, v79
  v_mul_f32 v70, v70, v80
  v_mul_f32 v71, v71, v81
  s_waitcnt vmcnt(10)
  v_lshlrev_b32 v82, 16, v112
  v_and_b32 v83, 0xffff0000, v112
  v_lshlrev_b32 v84, 16, v113
  v_and_b32 v85, 0xffff0000, v113
  v_lshlrev_b32 v86, 16, v124
  v_and_b32 v87, 0xffff0000, v124
  v_lshlrev_b32 v88, 16, v125
  v_and_b32 v89, 0xffff0000, v125
  v_fma_f32 v90, v82, v60, v61
  v_fma_f32 v91, v83, v60, v61
  v_fma_f32 v92, v84, v60, v61
  v_fma_f32 v93, v85, v60, v61
  v_mul_f32 v90, v90, v86
  v_mul_f32 v91, v91, v87
  v_mul_f32 v92, v92, v88
  v_mul_f32 v93, v93, v89
  v_fma_f32 v90, v90, v64, v82
  v_fma_f32 v91, v91, v65, v83
  v_fma_f32 v92, v92, v66, v84
  v_fma_f32 v93, v93, v67, v85
  v_cvt_pk_bf16_f32 v94, v90, v91
  v_cvt_pk_bf16_f32 v95, v92, v93
  buffer_store_dwordx2 v[94:95], v12, s[56:59], 0 offen
  v_lshlrev_b32 v82, 16, v114
  v_and_b32 v83, 0xffff0000, v114
  v_lshlrev_b32 v84, 16, v115
  v_and_b32 v85, 0xffff0000, v115
  v_lshlrev_b32 v86, 16, v126
  v_and_b32 v87, 0xffff0000, v126
  v_lshlrev_b32 v88, 16, v127
  v_and_b32 v89, 0xffff0000, v127
  v_fma_f32 v90, v82, v62, v63
  v_fma_f32 v91, v83, v62, v63
  v_fma_f32 v92, v84, v62, v63
  v_fma_f32 v93, v85, v62, v63
  v_mul_f32 v90, v90, v86
  v_mul_f32 v91, v91, v87
  v_mul_f32 v92, v92, v88
  v_mul_f32 v93, v93, v89
  v_fma_f32 v90, v90, v68, v82
  v_fma_f32 v91, v91, v69, v83
  v_fma_f32 v92, v92, v70, v84
  v_fma_f32 v93, v93, v71, v85
  v_cvt_pk_bf16_f32 v96, v90, v91
  v_cvt_pk_bf16_f32 v97, v92, v93
  buffer_store_dwordx2 v[96:97], v16, s[56:59], 0 offen
  s_waitcnt vmcnt(9)
  v_lshlrev_b32 v64, 16, v168
  v_and_b32 v65, 0xffff0000, v168
  v_lshlrev_b32 v66, 16, v169
  v_and_b32 v67, 0xffff0000, v169
  v_lshlrev_b32 v68, 16, v170
  v_and_b32 v69, 0xffff0000, v170
  v_lshlrev_b32 v70, 16, v171
  v_and_b32 v71, 0xffff0000, v171
  s_waitcnt vmcnt(8)
  v_dot2_f32_bf16 v64, v172, s40, v64
  v_dot2_f32_bf16 v65, v172, s41, v65
  v_dot2_f32_bf16 v66, v173, s40, v66
  v_dot2_f32_bf16 v67, v173, s41, v67
  v_dot2_f32_bf16 v68, v174, s40, v68
  v_dot2_f32_bf16 v69, v174, s41, v69
  v_dot2_f32_bf16 v70, v175, s40, v70
  v_dot2_f32_bf16 v71, v175, s41, v71
  s_waitcnt vmcnt(7)
  v_dot2_f32_bf16 v64, v176, s40, v64
  v_dot2_f32_bf16 v65, v176, s41, v65
  v_dot2_f32_bf16 v66, v177, s40, v66
  v_dot2_f32_bf16 v67, v177, s41, v67
  v_dot2_f32_bf16 v68, v178, s40, v68
  v_dot2_f32_bf16 v69, v178, s41, v69
  v_dot2_f32_bf16 v70, v179, s40, v70
  v_dot2_f32_bf16 v71, v179, s41, v71
  s_waitcnt vmcnt(6)
  v_dot2_f32_bf16 v64, v180, s40, v64
  v_dot2_f32_bf16 v65, v180, s41, v65
  v_dot2_f32_bf16 v66, v181, s40, v66
  v_dot2_f32_bf16 v67, v181, s41, v67
  v_dot2_f32_bf16 v68, v182, s40, v68
  v_dot2_f32_bf16 v69, v182, s41, v69
  v_dot2_f32_bf16 v70, v183, s40, v70
  v_dot2_f32_bf16 v71, v183, s41, v71
  s_waitcnt vmcnt(5)
  v_dot2_f32_bf16 v64, v184, s40, v64
  v_dot2_f32_bf16 v65, v184, s41, v65
  v_dot2_f32_bf16 v66, v185, s40, v66
  v_dot2_f32_bf16 v67, v185, s41, v67
  v_dot2_f32_bf16 v68, v186, s40, v68
  v_dot2_f32_bf16 v69, v186, s41, v69
  v_dot2_f32_bf16 v70, v187, s40, v70
  v_dot2_f32_bf16 v71, v187, s41, v71
  s_waitcnt vmcnt(4)
  v_dot2_f32_bf16 v64, v188, s40, v64
  v_dot2_f32_bf16 v65, v188, s41, v65
  v_dot2_f32_bf16 v66, v189, s40, v66
  v_dot2_f32_bf16 v67, v189, s41, v67
  v_dot2_f32_bf16 v68, v190, s40, v68
  v_dot2_f32_bf16 v69, v190, s41, v69
  v_dot2_f32_bf16 v70, v191, s40, v70
  v_dot2_f32_bf16 v71, v191, s41, v71
  s_waitcnt vmcnt(3)
  v_dot2_f32_bf16 v64, v192, s40, v64
  v_dot2_f32_bf16 v65, v192, s41, v65
  v_dot2_f32_bf16 v66, v193, s40, v66
  v_dot2_f32_bf16 v67, v193, s41, v67
  v_dot2_f32_bf16 v68, v194, s40, v68
  v_dot2_f32_bf16 v69, v194, s41, v69
  v_dot2_f32_bf16 v70, v195, s40, v70
  v_dot2_f32_bf16 v71, v195, s41, v71
  s_waitcnt vmcnt(2)
  v_dot2_f32_bf16 v64, v196, s40, v64
  v_dot2_f32_bf16 v65, v196, s41, v65
  v_dot2_f32_bf16 v66, v197, s40, v66
  v_dot2_f32_bf16 v67, v197, s41, v67
  v_dot2_f32_bf16 v68, v198, s40, v68
  v_dot2_f32_bf16 v69, v198, s41, v69
  v_dot2_f32_bf16 v70, v199, s40, v70
  v_dot2_f32_bf16 v71, v199, s41, v71
  s_nop 2
  v_exp_f32 v74, v64
  v_exp_f32 v75, v65
  v_exp_f32 v76, v66
  v_exp_f32 v77, v67
  v_exp_f32 v78, v68
  v_exp_f32 v79, v69
  v_exp_f32 v80, v70
  v_exp_f32 v81, v71
  s_nop 0
  v_add_f32 v74, 1.0, v74
  v_add_f32 v75, 1.0, v75
  v_add_f32 v76, 1.0, v76
  v_add_f32 v77, 1.0, v77
  v_add_f32 v78, 1.0, v78
  v_add_f32 v79, 1.0, v79
  v_add_f32 v80, 1.0, v80
  v_add_f32 v81, 1.0, v81
  v_rcp_f32 v74, v74
  v_rcp_f32 v75, v75
  v_rcp_f32 v76, v76
  v_rcp_f32 v77, v77
  v_rcp_f32 v78, v78
  v_rcp_f32 v79, v79
  v_rcp_f32 v80, v80
  v_rcp_f32 v81, v81
  s_nop 0
  v_mul_f32 v64, v64, v74
  v_mul_f32 v65, v65, v75
  v_mul_f32 v66, v66, v76
  v_mul_f32 v67, v67, v77
  v_mul_f32 v68, v68, v78
  v_mul_f32 v69, v69, v79
  v_mul_f32 v70, v70, v80
  v_mul_f32 v71, v71, v81
  s_waitcnt vmcnt(0)
  v_lshlrev_b32 v82, 16, v116
  v_and_b32 v83, 0xffff0000, v116
  v_lshlrev_b32 v84, 16, v117
  v_and_b32 v85, 0xffff0000, v117
  v_lshlrev_b32 v86, 16, v128
  v_and_b32 v87, 0xffff0000, v128
  v_lshlrev_b32 v88, 16, v129
  v_and_b32 v89, 0xffff0000, v129
  v_fma_f32 v90, v82, v60, v61
  v_fma_f32 v91, v83, v60, v61
  v_fma_f32 v92, v84, v60, v61
  v_fma_f32 v93, v85, v60, v61
  v_mul_f32 v90, v90, v86
  v_mul_f32 v91, v91, v87
  v_mul_f32 v92, v92, v88
  v_mul_f32 v93, v93, v89
  v_fma_f32 v90, v90, v64, v82
  v_fma_f32 v91, v91, v65, v83
  v_fma_f32 v92, v92, v66, v84
  v_fma_f32 v93, v93, v67, v85
  v_cvt_pk_bf16_f32 v94, v90, v91
  v_cvt_pk_bf16_f32 v95, v92, v93
  buffer_store_dwordx2 v[94:95], v13, s[56:59], 0 offen
  v_lshlrev_b32 v82, 16, v118
  v_and_b32 v83, 0xffff0000, v118
  v_lshlrev_b32 v84, 16, v119
  v_and_b32 v85, 0xffff0000, v119
  v_lshlrev_b32 v86, 16, v130
  v_and_b32 v87, 0xffff0000, v130
  v_lshlrev_b32 v88, 16, v131
  v_and_b32 v89, 0xffff0000, v131
  v_fma_f32 v90, v82, v62, v63
  v_fma_f32 v91, v83, v62, v63
  v_fma_f32 v92, v84, v62, v63
  v_fma_f32 v93, v85, v62, v63
  v_mul_f32 v90, v90, v86
  v_mul_f32 v91, v91, v87
  v_mul_f32 v92, v92, v88
  v_mul_f32 v93, v93, v89
  v_fma_f32 v90, v90, v68, v82
  v_fma_f32 v91, v91, v69, v83
  v_fma_f32 v92, v92, v70, v84
  v_fma_f32 v93, v93, v71, v85
  v_cvt_pk_bf16_f32 v96, v90, v91
  v_cvt_pk_bf16_f32 v97, v92, v93
  buffer_store_dwordx2 v[96:97], v17, s[56:59], 0 offen
  s_waitcnt lgkmcnt(0)
  s_barrier
  s_cmp_lg_u32 s24, 3
  s_cbranch_scc1 K_FIN_DONE
  ds_read_b128 v[136:139], v35 offset:0
  ds_read_b128 v[140:143], v35 offset:1024
  ds_read_b128 v[144:147], v35 offset:2048
  ds_read_b128 v[148:151], v35 offset:3072
  ds_read_b128 v[152:155], v35 offset:4096
  ds_read_b128 v[156:159], v35 offset:5120
  ds_read_b128 v[160:163], v35 offset:6144
  ds_read_b128 v[164:167], v35 offset:7168
  s_waitcnt vmcnt(0) lgkmcnt(0)
  v_add_f32 v64, v136, v144
  v_add_f32 v74, v152, v160
  v_add_f32 v65, v137, v145
  v_add_f32 v75, v153, v161
  v_add_f32 v66, v138, v146
  v_add_f32 v76, v154, v162
  v_add_f32 v67, v139, v147
  v_add_f32 v77, v155, v163
  v_add_f32 v68, v140, v148
  v_add_f32 v78, v156, v164
  v_add_f32 v69, v141, v149
  v_add_f32 v79, v157, v165
  v_add_f32 v70, v142, v150
  v_add_f32 v80, v158, v166
  v_add_f32 v71, v143, v151
  v_add_f32 v81, v159, v167
  v_add_f32 v64, v64, v74
  v_add_f32 v65, v65, v75
  v_add_f32 v66, v66, v76
  v_add_f32 v67, v67, v77
  v_add_f32 v68, v68, v78
  v_add_f32 v69, v69, v79
  v_add_f32 v70, v70, v80
  v_add_f32 v71, v71, v81
  v_exp_f32 v74, v64
  v_exp_f32 v75, v65
  v_exp_f32 v76, v66
  v_exp_f32 v77, v67
  v_exp_f32 v78, v68
  v_exp_f32 v79, v69
  v_exp_f32 v80, v70
  v_exp_f32 v81, v71
  s_nop 0
  v_add_f32 v74, 1.0, v74
  v_add_f32 v75, 1.0, v75
  v_add_f32 v76, 1.0, v76
  v_add_f32 v77, 1.0, v77
  v_add_f32 v78, 1.0, v78
  v_add_f32 v79, 1.0, v79
  v_add_f32 v80, 1.0, v80
  v_add_f32 v81, 1.0, v81
  v_rcp_f32 v74, v74
  v_rcp_f32 v75, v75
  v_rcp_f32 v76, v76
  v_rcp_f32 v77, v77
  v_rcp_f32 v78, v78
  v_rcp_f32 v79, v79
  v_rcp_f32 v80, v80
  v_rcp_f32 v81, v81
  s_nop 0
  v_mul_f32 v64, v64, v74
  v_mul_f32 v65, v65, v75
  v_mul_f32 v66, v66, v76
  v_mul_f32 v67, v67, v77
  v_mul_f32 v68, v68, v78
  v_mul_f32 v69, v69, v79
  v_mul_f32 v70, v70, v80
  v_mul_f32 v71, v71, v81
  v_lshlrev_b32 v82, 16, v120
  v_and_b32 v83, 0xffff0000, v120
  v_lshlrev_b32 v84, 16, v121
  v_and_b32 v85, 0xffff0000, v121
  v_lshlrev_b32 v86, 16, v132
  v_and_b32 v87, 0xffff0000, v132
  v_lshlrev_b32 v88, 16, v133
  v_and_b32 v89, 0xffff0000, v133
  v_fma_f32 v90, v82, v60, v61
  v_fma_f32 v91, v83, v60, v61
  v_fma_f32 v92, v84, v60, v61
  v_fma_f32 v93, v85, v60, v61
  v_mul_f32 v90, v90, v86
  v_mul_f32 v91, v91, v87
  v_mul_f32 v92, v92, v88
  v_mul_f32 v93, v93, v89
  v_fma_f32 v90, v90, v64, v82
  v_fma_f32 v91, v91, v65, v83
  v_fma_f32 v92, v92, v66, v84
  v_fma_f32 v93, v93, v67, v85
  v_cvt_pk_bf16_f32 v94, v90, v91
  v_cvt_pk_bf16_f32 v95, v92, v93
  buffer_store_dwordx2 v[94:95], v14, s[56:59], 0 offen
  v_lshlrev_b32 v82, 16, v122
  v_and_b32 v83, 0xffff0000, v122
  v_lshlrev_b32 v84, 16, v123
  v_and_b32 v85, 0xffff0000, v123
  v_lshlrev_b32 v86, 16, v134
  v_and_b32 v87, 0xffff0000, v134
  v_lshlrev_b32 v88, 16, v135
  v_and_b32 v89, 0xffff0000, v135
  v_fma_f32 v90, v82, v62, v63
  v_fma_f32 v91, v83, v62, v63
  v_fma_f32 v92, v84, v62, v63
  v_fma_f32 v93, v85, v62, v63
  v_mul_f32 v90, v90, v86
  v_mul_f32 v91, v91, v87
  v_mul_f32 v92, v92, v88
  v_mul_f32 v93, v93, v89
  v_fma_f32 v90, v90, v68, v82
  v_fma_f32 v91, v91, v69, v83
  v_fma_f32 v92, v92, v70, v84
  v_fma_f32 v93, v93, v71, v85
  v_cvt_pk_bf16_f32 v96, v90, v91
  v_cvt_pk_bf16_f32 v97, v92, v93
  buffer_store_dwordx2 v[96:97], v18, s[56:59], 0 offen
K_FIN_DONE:
K_END:
  s_endpgm
K_CODE_END:

.section .rodata,"a"
.p2align 6
.amdhsa_kernel recurrent_scan__ssm_conv_h3__dense_activation_silu__prompt_kernel
  .amdhsa_next_free_vgpr 512
  .amdhsa_next_free_sgpr 102
  .amdhsa_accum_offset 256
  .amdhsa_group_segment_fixed_size 0
  .amdhsa_kernarg_size 96
  .amdhsa_user_sgpr_count 2
  .amdhsa_user_sgpr_kernarg_segment_ptr 1
  .amdhsa_system_sgpr_workgroup_id_x 1
.end_amdhsa_kernel
```
